```python
import torch

def _softmax(x, axis=-1):
    return torch.softmax(x, dim=axis)
def _gelu(x):
    return torch.nn.functional.gelu(x, approximate="tanh")
def _silu(x):
    return torch.nn.functional.silu(x)
def _sigmoid(x):
    return torch.sigmoid(x)
def _layernorm(x, axis=-1, eps=1e-5):
    m = x.mean(dim=axis, keepdim=True)
    v = x.var(dim=axis, keepdim=True, unbiased=False)
    return (x - m) / torch.sqrt(v + eps)
def _scatter_add(tgt, idx, src, axis=0):
    return tgt.clone().index_add_(axis, idx, src)
def _segment_sum(src, seg, n):
    out = torch.zeros((n,) + src.shape[1:], dtype=src.dtype)
    return out.index_add_(0, seg, src)
def _pad(x, pw):
    flat = tuple(v for pair in reversed(pw) for v in pair)
    return torch.nn.functional.pad(x, flat)

kernel_name = 'concat_heads__mha_block_cached__mha_block_cached__near_ridge'

def setup_inputs():

    _w = (lambda a: (lambda t: t.to(torch.bfloat16) if t.is_floating_point() else t)(torch.as_tensor(a)))
    def _A_setup():
        B, Sq, D = 8, 240, 512
        H, Sk, Dh = 32, 512, 128
        return {
            "x": _w((lambda *s: torch.randn(*s, dtype=torch.bfloat16) * 0.8)(B, Sq, D)),
            "k_cache": _w((lambda *s: torch.randn(*s, dtype=torch.bfloat16) * 0.8)(B, H, Sk, Dh)),
            "v_cache": _w((lambda *s: torch.randn(*s, dtype=torch.bfloat16) * 0.05)(B, H, Sk, Dh)),
            "wq": _w((lambda *s: torch.randn(*s, dtype=torch.bfloat16) * 0.8)(D, H * Dh) * (D ** -0.5)),
            "wo": _w((lambda *s: torch.randn(*s, dtype=torch.bfloat16) * 0.05)(H * Dh, D) * ((H * Dh) ** -0.5)),
        }
    _A_in = _A_setup()

    def _B_setup():
        B, Sq, D = 8, 240, 512
        H, Sk, Dh = 32, 512, 128
        return {
            "x": _w((lambda *s: torch.randn(*s, dtype=torch.bfloat16) * 0.8)(B, Sq, D)),
            "k_cache": _w((lambda *s: torch.randn(*s, dtype=torch.bfloat16) * 0.8)(B, H, Sk, Dh)),
            "v_cache": _w((lambda *s: torch.randn(*s, dtype=torch.bfloat16) * 0.05)(B, H, Sk, Dh)),
            "wq": _w((lambda *s: torch.randn(*s, dtype=torch.bfloat16) * 0.8)(D, H * Dh) * (D ** -0.5)),
            "wo": _w((lambda *s: torch.randn(*s, dtype=torch.bfloat16) * 0.05)(H * Dh, D) * ((H * Dh) ** -0.5)),
        }
    _B_in = _B_setup()

    return {
        "A_x": _A_in["x"],
        "A_k_cache": _A_in["k_cache"],
        "A_v_cache": _A_in["v_cache"],
        "A_wq": _A_in["wq"],
        "A_wo": _A_in["wo"],
        "B_x": _B_in["x"],
        "B_k_cache": _B_in["k_cache"],
        "B_v_cache": _B_in["v_cache"],
        "B_wq": _B_in["wq"],
        "B_wo": _B_in["wo"],
    }

def reference(A_x, A_k_cache, A_v_cache, A_wq, A_wo, B_x, B_k_cache, B_v_cache, B_wq, B_wo):
    def _A_ref(x, k_cache, v_cache, wq, wo):
        B, Sq, D = x.shape
        H, Dh = 32, 128
        q = (lambda x, *d: x.permute(*d))((x @ wq).reshape(B, Sq, H, Dh), 0, 2, 1, 3)
        scores = torch.einsum("bhqd,bhkd->bhqk", q, k_cache) * (Dh ** -0.5)
        p = _softmax(scores, axis=-1)
        o = torch.einsum("bhqk,bhkd->bhqd", p, v_cache)
        return (lambda x, *d: x.permute(*d))(o, 0, 2, 1, 3).reshape(B, Sq, H * Dh) @ wo

    def _B_ref(x, k_cache, v_cache, wq, wo):
        B, Sq, D = x.shape
        H, Dh = 32, 128
        q = (lambda x, *d: x.permute(*d))((x @ wq).reshape(B, Sq, H, Dh), 0, 2, 1, 3)
        scores = torch.einsum("bhqd,bhkd->bhqk", q, k_cache) * (Dh ** -0.5)
        p = _softmax(scores, axis=-1)
        o = torch.einsum("bhqk,bhkd->bhqd", p, v_cache)
        return (lambda x, *d: x.permute(*d))(o, 0, 2, 1, 3).reshape(B, Sq, H * Dh) @ wo

    a = _A_ref(A_x, A_k_cache, A_v_cache, A_wq, A_wo)
    b = _B_ref(B_x, B_k_cache, B_v_cache, B_wq, B_wo)
    return torch.concatenate([a, b], axis=-1)
```

```asm
; @launch grid=(256,1,1) block=(256,1,1) lds=163840
.amdgcn_target "amdgcn-amd-amdhsa--gfx950"
.text
.globl concat_heads__mha_block_cached__mha_block_cached__near_ridge_kernel
.p2align 8
.type concat_heads__mha_block_cached__mha_block_cached__near_ridge_kernel,@function
concat_heads__mha_block_cached__mha_block_cached__near_ridge_kernel:
s_cmp_ge_u32 s2, 256
s_cbranch_scc1 L1_end
s_lshr_b32 s3, s2, 5
s_xor_b32 s3, s3, s2
s_and_b32 s3, s3, 1
s_mul_i32 s3, s3, 33
s_xor_b32 s2, s2, s3
s_mov_b32 s25, 0
L1_again:
s_load_dwordx16 s[36:51], s[0:1], 0
s_load_dwordx4 s[52:55], s[0:1], 64
s_load_dwordx2 s[56:57], s[0:1], 96
s_load_dwordx4 s[88:91], s[0:1], 80
v_and_b32 v36, 63, v0
v_lshrrev_b32 v39, 6, v0
v_lshrrev_b32 v37, 4, v36
v_readfirstlane_b32 s24, v39
v_and_b32 v38, 15, v36
s_lshr_b32 s3, s2, 3
s_and_b32 s62, s3, 3
s_and_b32 s63, s2, 1
s_lshl_b32 s63, s63, 2
s_add_u32 s62, s62, s63
s_lshr_b32 s63, s3, 2
s_and_b32 s64, s2, 2
s_lshl_b32 s64, s64, 2
s_add_u32 s78, s63, s64
s_lshl_b32 s27, s24, 11
s_add_u32 s28, s27, 8192
s_add_u32 s30, s27, 65536
s_add_u32 s29, s30, 8192
s_lshl_b32 s31, s24, 12
s_lshl_b32 s32, s24, 13
s_add_u32 s32, s32, 65536
s_mov_b32 s61, 163840
v_lshlrev_b32 v39, 2, v37
v_xor_b32 v39, v38, v39
v_lshlrev_b32 v39, 4, v39
s_and_b32 s63, s24, 1
s_lshl_b32 s63, s63, 17
s_lshr_b32 s64, s24, 1
s_lshl_b32 s64, s64, 8
s_add_u32 s63, s63, s64
v_lshl_add_u32 v40, v37, 13, v39
v_add_u32 v25, s63, v40
v_add_u32 v26, 31744, v25
v_add_u32 v27, 63488, v25
v_add_u32 v28, 95232, v25
v_lshl_add_u32 v40, v37, 8, v39
v_add_u32 v24, s27, v40
v_and_b32 v39, 7, v36
v_xor_b32 v39, v39, v37
v_lshlrev_b32 v39, 4, v39
v_lshrrev_b32 v40, 3, v36
v_lshl_add_u32 v40, v40, 10, v39
s_lshl_b32 s63, s24, 16
v_add_u32 v29, s63, v40
v_xor_b32 v41, 64, v29
v_add_u32 v30, 7168, v41
v_add_u32 v31, 14336, v29
v_add_u32 v32, 21504, v41
s_waitcnt lgkmcnt(0)
s_bitcmp1_b32 s2, 2
s_cselect_b64 s[36:37], s[46:47], s[36:37]
s_cselect_b64 s[38:39], s[48:49], s[38:39]
s_cselect_b64 s[40:41], s[50:51], s[40:41]
s_cselect_b64 s[42:43], s[52:53], s[42:43]
s_cselect_b32 s65, 8, 0
s_and_b32 s46, s78, 1
s_lshl_b32 s46, s46, 15
s_add_u32 s92, s65, s62
s_lshl_b32 s92, s92, 4
s_add_u32 s92, s92, s78
s_and_b32 s93, s92, 0xf9
s_lshl_b32 s63, s92, 7
s_add_u32 s63, s63, 0x6000000
v_mov_b32 v60, s63
v_mov_b32 v61, 0
s_mov_b64 exec, 1
global_store_dword v60, v61, s[56:57] sc1
s_mov_b64 exec, -1
s_lshl_b32 s63, s78, 9
s_add_u32 s8, s42, s63
s_addc_u32 s9, s43, 0
s_sub_u32 s10, 4194304, s63
s_mov_b32 s11, 0x20000
s_mul_i32 s63, s62, 245760
s_add_u32 s4, s36, s63
s_addc_u32 s5, s37, 0
s_mov_b32 s6, 245760
s_mov_b32 s7, 0x20000
s_add_u32 m0, s31, 131072
s_mov_b32 s66, 0
buffer_load_dwordx4 v25, s[8:11], s66 offen lds
buffer_load_dwordx4 v26, s[8:11], s66 offen offset:1024 lds
buffer_load_dwordx4 v27, s[8:11], s66 offen offset:2048 lds
buffer_load_dwordx4 v28, s[8:11], s66 offen offset:3072 lds
s_add_u32 m0, s32, 0
s_xor_b32 s63, s46, 0
buffer_load_dwordx4 v29, s[4:7], s63 offen lds
buffer_load_dwordx4 v30, s[4:7], s63 offen offset:1024 lds
buffer_load_dwordx4 v31, s[4:7], s63 offen offset:2048 lds
buffer_load_dwordx4 v32, s[4:7], s63 offen offset:3072 lds
s_add_u32 m0, s32, 4096
s_xor_b32 s63, s46, 32768
buffer_load_dwordx4 v29, s[4:7], s63 offen lds
buffer_load_dwordx4 v30, s[4:7], s63 offen offset:1024 lds
buffer_load_dwordx4 v31, s[4:7], s63 offen offset:2048 lds
buffer_load_dwordx4 v32, s[4:7], s63 offen offset:3072 lds
s_lshl_b32 s63, s62, 5
s_lshl_b32 s64, s78, 1
s_add_u32 s63, s63, s64
s_lshl_b32 s63, s63, 17
s_add_u32 s12, s38, s63
s_addc_u32 s13, s39, 0
s_mov_b32 s14, 262144
s_mov_b32 s15, 0x20000
s_add_u32 s16, s40, s63
s_addc_u32 s17, s41, 0
s_mov_b32 s18, 262144
s_mov_b32 s19, 0x20000
s_add_u32 s63, s65, s62
s_lshl_b32 s63, s63, 21
s_add_u32 s20, s56, s63
s_addc_u32 s21, s57, 0
s_mov_b32 s22, 2097152
s_mov_b32 s23, 0x20000
s_bitcmp1_b32 s2, 2
s_cselect_b64 s[44:45], s[54:55], s[44:45]
s_mov_b32 s84, s44
s_mov_b32 s85, s45
s_mov_b32 s86, 4194304
s_mov_b32 s87, 0x20000
s_and_b32 s63, s2, 3
s_lshl_b32 s63, s63, 5
s_lshr_b32 s64, s2, 3
s_add_u32 s63, s63, s64
s_lshl_b32 s63, s63, 2
s_add_u32 s63, s63, s24
s_lshl_b32 s83, s63, 13
s_and_b32 s63, s24, 1
s_lshl_b32 s63, s63, 3
v_or_b32 v39, s63, v37
v_xor_b32 v39, v38, v39
v_lshlrev_b32 v39, 4, v39
v_lshl_add_u32 v39, v37, 8, v39
v_add_u32 v22, s27, v39
v_xor_b32 v23, 64, v22
v_and_b32 v39, 0x13, v36
v_and_b32 v40, 4, v36
v_lshl_or_b32 v39, v40, 1, v39
v_and_b32 v40, 8, v36
v_lshrrev_b32 v40, 1, v40
v_or_b32 v39, v39, v40
v_and_b32 v40, 15, v39
v_lshrrev_b32 v41, 5, v36
v_xor_b32 v40, v40, v41
v_lshlrev_b32 v40, 4, v40
v_lshl_or_b32 v2, v39, 8, v40
v_xor_b32 v3, 32, v2
v_xor_b32 v4, 64, v2
v_xor_b32 v5, 96, v2
v_xor_b32 v6, 128, v2
v_xor_b32 v7, 160, v2
v_xor_b32 v8, 192, v2
v_xor_b32 v9, 224, v2
v_bfe_u32 v39, v36, 2, 2
v_lshl_add_u32 v40, v41, 3, v39
v_lshlrev_b32 v40, 8, v40
v_lshl_or_b32 v40, v39, 6, v40
v_bfe_u32 v39, v36, 4, 1
v_lshl_or_b32 v40, v39, 5, v40
v_and_b32 v39, 1, v36
v_lshl_or_b32 v40, v39, 4, v40
v_bfe_u32 v39, v36, 1, 1
v_lshl_or_b32 v40, v39, 3, v40
v_add_u32 v10, 65536, v40
v_add_u32 v14, 131072, v40
v_add_u32 v48, 32768, v40
v_xor_b32 v11, 64, v10
v_xor_b32 v15, 64, v14
v_xor_b32 v49, 64, v48
v_xor_b32 v12, 128, v10
v_xor_b32 v16, 128, v14
v_xor_b32 v50, 128, v48
v_xor_b32 v13, 192, v10
v_xor_b32 v17, 192, v14
v_xor_b32 v51, 192, v48
v_bfe_u32 v39, v36, 1, 3
v_xor_b32 v39, v39, v41
v_lshlrev_b32 v39, 4, v39
v_and_b32 v40, 31, v36
v_lshl_or_b32 v39, v40, 7, v39
v_add_u32 v18, s32, v39
v_xor_b32 v19, 32, v18
v_xor_b32 v20, 64, v18
v_xor_b32 v21, 96, v18
v_lshlrev_b32 v33, 4, v36
v_mov_b32 v52, 0
v_mov_b32 v53, 0
v_mov_b32 v54, 0
v_mov_b32 v55, 0
s_mov_b32 s26, 0
s_mov_b64 s[74:75], 0
v_mfma_f32_32x32x16_bf16 v[128:143], v[52:55], v[52:55], 0
v_mfma_f32_32x32x16_bf16 v[144:159], v[52:55], v[52:55], 0
v_mfma_f32_32x32x16_bf16 v[160:175], v[52:55], v[52:55], 0
v_mfma_f32_32x32x16_bf16 v[176:191], v[52:55], v[52:55], 0
v_mfma_f32_32x32x16_bf16 v[192:207], v[52:55], v[52:55], 0
v_mfma_f32_32x32x16_bf16 v[208:223], v[52:55], v[52:55], 0
v_mfma_f32_32x32x16_bf16 v[224:239], v[52:55], v[52:55], 0
v_mfma_f32_32x32x16_bf16 v[240:255], v[52:55], v[52:55], 0
v_mfma_f32_32x32x16_bf16 a[128:143], v[52:55], v[52:55], 0
v_mfma_f32_32x32x16_bf16 a[144:159], v[52:55], v[52:55], 0
v_mfma_f32_32x32x16_bf16 a[160:175], v[52:55], v[52:55], 0
v_mfma_f32_32x32x16_bf16 a[176:191], v[52:55], v[52:55], 0
v_mfma_f32_32x32x16_bf16 a[192:207], v[52:55], v[52:55], 0
v_mfma_f32_32x32x16_bf16 a[208:223], v[52:55], v[52:55], 0
v_mfma_f32_32x32x16_bf16 a[224:239], v[52:55], v[52:55], 0
v_mfma_f32_32x32x16_bf16 a[240:255], v[52:55], v[52:55], 0
v_mfma_f32_32x32x16_bf16 v[96:111], v[52:55], v[52:55], 0
v_mfma_f32_32x32x16_bf16 v[112:127], v[52:55], v[52:55], 0
s_add_u32 m0, s31, 147456
s_mov_b32 s66, 262144
buffer_load_dwordx4 v25, s[8:11], s66 offen lds
buffer_load_dwordx4 v26, s[8:11], s66 offen offset:1024 lds
buffer_load_dwordx4 v27, s[8:11], s66 offen offset:2048 lds
buffer_load_dwordx4 v28, s[8:11], s66 offen offset:3072 lds
s_add_u32 m0, s32, 32768
s_xor_b32 s63, s46, 128
buffer_load_dwordx4 v29, s[4:7], s63 offen lds
buffer_load_dwordx4 v30, s[4:7], s63 offen offset:1024 lds
buffer_load_dwordx4 v31, s[4:7], s63 offen offset:2048 lds
buffer_load_dwordx4 v32, s[4:7], s63 offen offset:3072 lds
s_add_u32 m0, s32, 36864
s_xor_b32 s63, s46, 32896
buffer_load_dwordx4 v29, s[4:7], s63 offen lds
buffer_load_dwordx4 v30, s[4:7], s63 offen offset:1024 lds
buffer_load_dwordx4 v31, s[4:7], s63 offen offset:2048 lds
buffer_load_dwordx4 v32, s[4:7], s63 offen offset:3072 lds
s_add_u32 m0, s31, 49152
s_mov_b32 s66, 524288
buffer_load_dwordx4 v25, s[8:11], s66 offen lds
buffer_load_dwordx4 v26, s[8:11], s66 offen offset:1024 lds
buffer_load_dwordx4 v27, s[8:11], s66 offen offset:2048 lds
buffer_load_dwordx4 v28, s[8:11], s66 offen offset:3072 lds
s_add_u32 m0, s31, 32768
s_mov_b32 s66, 786432
buffer_load_dwordx4 v25, s[8:11], s66 offen lds
buffer_load_dwordx4 v26, s[8:11], s66 offen offset:1024 lds
buffer_load_dwordx4 v27, s[8:11], s66 offen offset:2048 lds
buffer_load_dwordx4 v28, s[8:11], s66 offen offset:3072 lds
s_lshr_b32 s94, s2, 5
s_xor_b32 s94, s94, s2
s_and_b32 s94, s94, 1
s_mul_i32 s94, s94, 33
s_xor_b32 s63, s2, s94
s_getpc_b64 s[94:95]
Lpc_a:
s_add_u32 s94, s94, L1_qloop-Lpc_a
s_addc_u32 s95, s95, 0
s_bfe_u32 s63, s63, 0x40003
s_lshl_b32 s63, s63, 2
s_add_u32 s63, s63, s24
s_mul_i32 s63, s63, 4
v_and_b32 v64, 63, v0
v_add_u32 v64, s63, v64
v_lshlrev_b32 v64, 7, v64
s_mov_b32 s63, L1_oepi0-L1_qloop-4
v_min_u32 v64, s63, v64
s_mov_b64 exec, 15
global_load_dword v47, v64, s[94:95]
s_mov_b64 exec, -1
s_mov_b32 s66, 1048576
s_waitcnt vmcnt(21)
s_barrier
ds_read_b128 a[0:3], v18 offset:0
ds_read_b128 a[4:7], v18 offset:4096
ds_read_b128 a[8:11], v19 offset:0
ds_read_b128 a[12:15], v19 offset:4096
ds_read_b128 a[16:19], v20 offset:0
ds_read_b128 a[20:23], v20 offset:4096
ds_read_b128 a[24:27], v21 offset:0
ds_read_b128 a[28:31], v21 offset:4096
ds_read_b64_tr_b16 a[64:65], v14 offset:0
ds_read_b64_tr_b16 a[66:67], v14 offset:1024
ds_read_b64_tr_b16 a[68:69], v15 offset:0
ds_read_b64_tr_b16 a[70:71], v15 offset:1024
ds_read_b64_tr_b16 a[72:73], v16 offset:0
ds_read_b64_tr_b16 a[74:75], v16 offset:1024
ds_read_b64_tr_b16 a[76:77], v17 offset:0
ds_read_b64_tr_b16 a[78:79], v17 offset:1024
ds_read_b64_tr_b16 a[80:81], v14 offset:8192
ds_read_b64_tr_b16 a[82:83], v14 offset:9216
ds_read_b64_tr_b16 a[84:85], v15 offset:8192
ds_read_b64_tr_b16 a[86:87], v15 offset:9216
ds_read_b64_tr_b16 a[88:89], v16 offset:8192
ds_read_b64_tr_b16 a[90:91], v16 offset:9216
ds_read_b64_tr_b16 a[92:93], v17 offset:8192
ds_read_b64_tr_b16 a[94:95], v17 offset:9216
s_xor_b32 s67, s46, 256
s_xor_b32 s68, s46, 33024
s_mov_b32 s69, 0
s_mov_b32 s73, 0
s_mov_b32 s60, 3
s_add_u32 m0, s32, 0
s_waitcnt lgkmcnt(15)
buffer_load_dwordx4 v29, s[4:7], s67 offen lds
buffer_load_dwordx4 v30, s[4:7], s67 offen offset:1024 lds
buffer_load_dwordx4 v31, s[4:7], s67 offen offset:2048 lds
buffer_load_dwordx4 v32, s[4:7], s67 offen offset:3072 lds
s_add_u32 m0, s32, 4096
s_add_u32 s67, s67, 128
buffer_load_dwordx4 v29, s[4:7], s68 offen lds
buffer_load_dwordx4 v30, s[4:7], s68 offen offset:1024 lds
buffer_load_dwordx4 v31, s[4:7], s68 offen offset:2048 lds
buffer_load_dwordx4 v32, s[4:7], s68 offen offset:3072 lds
s_add_u32 s68, s68, 128
L1_qloop:
s_waitcnt lgkmcnt(0)
v_mfma_f32_32x32x16_bf16 v[128:143], a[64:67], a[0:3], v[128:143]
ds_read_b64_tr_b16 a[96:97], v14 offset:4096
ds_read_b64_tr_b16 a[98:99], v14 offset:5120
s_cmp_eq_u32 s60, 1
s_cselect_b32 s62, s61, s27
v_mfma_f32_32x32x16_bf16 v[144:159], a[64:67], a[4:7], v[144:159]
ds_read_b64_tr_b16 a[100:101], v15 offset:4096
s_cselect_b32 s63, s61, s28
s_cselect_b32 s73, 1073741824, s73
v_mfma_f32_32x32x16_bf16 v[160:175], a[68:71], a[0:3], v[160:175]
ds_read_b64_tr_b16 a[102:103], v15 offset:5120
s_add_u32 m0, s69, s62
v_mfma_f32_32x32x16_bf16 v[176:191], a[68:71], a[4:7], v[176:191]
ds_read_b64_tr_b16 a[104:105], v16 offset:4096
v_mfma_f32_32x32x16_bf16 v[192:207], a[72:75], a[0:3], v[192:207]
ds_read_b64_tr_b16 a[106:107], v16 offset:5120
buffer_load_dwordx4 v22, s[12:15], s73 offen nt lds
v_mfma_f32_32x32x16_bf16 v[208:223], a[72:75], a[4:7], v[208:223]
ds_read_b64_tr_b16 a[108:109], v17 offset:4096
v_mfma_f32_32x32x16_bf16 v[224:239], a[76:79], a[0:3], v[224:239]
ds_read_b64_tr_b16 a[110:111], v17 offset:5120
buffer_load_dwordx4 v23, s[12:15], s73 offen offset:1024 nt lds
v_mfma_f32_32x32x16_bf16 v[240:255], a[76:79], a[4:7], v[240:255]
ds_read_b64_tr_b16 a[112:113], v14 offset:12288
s_add_u32 m0, s69, s63
s_add_u32 s62, s73, 8192
v_mfma_f32_32x32x16_bf16 a[128:143], a[80:83], a[0:3], a[128:143]
ds_read_b64_tr_b16 a[114:115], v14 offset:13312
v_mfma_f32_32x32x16_bf16 a[144:159], a[80:83], a[4:7], a[144:159]
ds_read_b64_tr_b16 a[116:117], v15 offset:12288
buffer_load_dwordx4 v22, s[12:15], s62 offen nt lds
v_mfma_f32_32x32x16_bf16 a[160:175], a[84:87], a[0:3], a[160:175]
ds_read_b64_tr_b16 a[118:119], v15 offset:13312
v_mfma_f32_32x32x16_bf16 a[176:191], a[84:87], a[4:7], a[176:191]
ds_read_b64_tr_b16 a[120:121], v16 offset:12288
buffer_load_dwordx4 v23, s[12:15], s62 offen offset:1024 nt lds
v_mfma_f32_32x32x16_bf16 a[192:207], a[88:91], a[0:3], a[192:207]
ds_read_b64_tr_b16 a[122:123], v16 offset:13312
s_add_u32 s73, s73, 16384
s_add_u32 s69, s69, 16384
v_mfma_f32_32x32x16_bf16 a[208:223], a[88:91], a[4:7], a[208:223]
ds_read_b64_tr_b16 a[124:125], v17 offset:12288
ds_read_b64_tr_b16 a[126:127], v17 offset:13312
v_mfma_f32_32x32x16_bf16 a[224:239], a[92:95], a[0:3], a[224:239]
v_mfma_f32_32x32x16_bf16 a[240:255], a[92:95], a[4:7], a[240:255]
s_waitcnt vmcnt(20) lgkmcnt(0)
s_barrier
v_mfma_f32_32x32x16_bf16 v[128:143], a[96:99], a[8:11], v[128:143]
ds_read_b64_tr_b16 a[64:65], v14 offset:16384
ds_read_b64_tr_b16 a[66:67], v14 offset:17408
s_add_u32 m0, s31, 131072
v_mfma_f32_32x32x16_bf16 v[144:159], a[96:99], a[12:15], v[144:159]
ds_read_b64_tr_b16 a[68:69], v15 offset:16384
buffer_load_dwordx4 v25, s[8:11], s66 offen lds
v_mfma_f32_32x32x16_bf16 v[160:175], a[100:103], a[8:11], v[160:175]
ds_read_b64_tr_b16 a[70:71], v15 offset:17408
v_mfma_f32_32x32x16_bf16 v[176:191], a[100:103], a[12:15], v[176:191]
ds_read_b64_tr_b16 a[72:73], v16 offset:16384
buffer_load_dwordx4 v26, s[8:11], s66 offen offset:1024 lds
v_mfma_f32_32x32x16_bf16 v[192:207], a[104:107], a[8:11], v[192:207]
ds_read_b64_tr_b16 a[74:75], v16 offset:17408
v_mfma_f32_32x32x16_bf16 v[208:223], a[104:107], a[12:15], v[208:223]
ds_read_b64_tr_b16 a[76:77], v17 offset:16384
buffer_load_dwordx4 v27, s[8:11], s66 offen offset:2048 lds
v_mfma_f32_32x32x16_bf16 v[224:239], a[108:111], a[8:11], v[224:239]
ds_read_b64_tr_b16 a[78:79], v17 offset:17408
v_mfma_f32_32x32x16_bf16 v[240:255], a[108:111], a[12:15], v[240:255]
ds_read_b64_tr_b16 a[80:81], v14 offset:24576
s_waitcnt vmcnt(24)
buffer_load_dwordx4 v28, s[8:11], s66 offen offset:3072 lds
v_mfma_f32_32x32x16_bf16 a[128:143], a[112:115], a[8:11], a[128:143]
ds_read_b64_tr_b16 a[82:83], v14 offset:25600
ds_read_b128 a[32:35], v18 offset:32768
s_add_u32 s66, s66, 262144
v_mfma_f32_32x32x16_bf16 a[144:159], a[112:115], a[12:15], a[144:159]
ds_read_b64_tr_b16 a[84:85], v15 offset:24576
ds_read_b128 a[36:39], v18 offset:36864
v_mfma_f32_32x32x16_bf16 a[160:175], a[116:119], a[8:11], a[160:175]
ds_read_b64_tr_b16 a[86:87], v15 offset:25600
ds_read_b128 a[40:43], v19 offset:32768
v_mfma_f32_32x32x16_bf16 a[176:191], a[116:119], a[12:15], a[176:191]
ds_read_b64_tr_b16 a[88:89], v16 offset:24576
ds_read_b128 a[44:47], v19 offset:36864
v_mfma_f32_32x32x16_bf16 a[192:207], a[120:123], a[8:11], a[192:207]
ds_read_b64_tr_b16 a[90:91], v16 offset:25600
ds_read_b128 a[48:51], v20 offset:32768
v_mfma_f32_32x32x16_bf16 a[208:223], a[120:123], a[12:15], a[208:223]
ds_read_b64_tr_b16 a[92:93], v17 offset:24576
ds_read_b64_tr_b16 a[94:95], v17 offset:25600
ds_read_b128 a[52:55], v20 offset:36864
v_mfma_f32_32x32x16_bf16 a[224:239], a[124:127], a[8:11], a[224:239]
ds_read_b128 a[56:59], v21 offset:32768
v_mfma_f32_32x32x16_bf16 a[240:255], a[124:127], a[12:15], a[240:255]
ds_read_b128 a[60:63], v21 offset:36864
s_waitcnt lgkmcnt(15)
v_mfma_f32_32x32x16_bf16 v[128:143], a[64:67], a[16:19], v[128:143]
ds_read_b64_tr_b16 a[96:97], v14 offset:20480
ds_read_b64_tr_b16 a[98:99], v14 offset:21504
v_mfma_f32_32x32x16_bf16 v[144:159], a[64:67], a[20:23], v[144:159]
ds_read_b64_tr_b16 a[100:101], v15 offset:20480
v_mfma_f32_32x32x16_bf16 v[160:175], a[68:71], a[16:19], v[160:175]
ds_read_b64_tr_b16 a[102:103], v15 offset:21504
s_add_u32 m0, s32, 32768
v_mfma_f32_32x32x16_bf16 v[176:191], a[68:71], a[20:23], v[176:191]
ds_read_b64_tr_b16 a[104:105], v16 offset:20480
s_waitcnt lgkmcnt(5)
buffer_load_dwordx4 v29, s[4:7], s67 offen lds
v_mfma_f32_32x32x16_bf16 v[192:207], a[72:75], a[16:19], v[192:207]
ds_read_b64_tr_b16 a[106:107], v16 offset:21504
buffer_load_dwordx4 v30, s[4:7], s67 offen offset:1024 lds
v_mfma_f32_32x32x16_bf16 v[208:223], a[72:75], a[20:23], v[208:223]
ds_read_b64_tr_b16 a[108:109], v17 offset:20480
buffer_load_dwordx4 v31, s[4:7], s67 offen offset:2048 lds
v_mfma_f32_32x32x16_bf16 v[224:239], a[76:79], a[16:19], v[224:239]
ds_read_b64_tr_b16 a[110:111], v17 offset:21504
buffer_load_dwordx4 v32, s[4:7], s67 offen offset:3072 lds
v_mfma_f32_32x32x16_bf16 v[240:255], a[76:79], a[20:23], v[240:255]
ds_read_b64_tr_b16 a[112:113], v14 offset:28672
s_add_u32 m0, s32, 36864
v_mfma_f32_32x32x16_bf16 a[128:143], a[80:83], a[16:19], a[128:143]
ds_read_b64_tr_b16 a[114:115], v14 offset:29696
s_add_u32 s67, s67, 128
v_mfma_f32_32x32x16_bf16 a[144:159], a[80:83], a[20:23], a[144:159]
ds_read_b64_tr_b16 a[116:117], v15 offset:28672
buffer_load_dwordx4 v29, s[4:7], s68 offen lds
v_mfma_f32_32x32x16_bf16 a[160:175], a[84:87], a[16:19], a[160:175]
ds_read_b64_tr_b16 a[118:119], v15 offset:29696
buffer_load_dwordx4 v30, s[4:7], s68 offen offset:1024 lds
v_mfma_f32_32x32x16_bf16 a[176:191], a[84:87], a[20:23], a[176:191]
ds_read_b64_tr_b16 a[120:121], v16 offset:28672
buffer_load_dwordx4 v31, s[4:7], s68 offen offset:2048 lds
v_mfma_f32_32x32x16_bf16 a[192:207], a[88:91], a[16:19], a[192:207]
ds_read_b64_tr_b16 a[122:123], v16 offset:29696
buffer_load_dwordx4 v32, s[4:7], s68 offen offset:3072 lds
v_mfma_f32_32x32x16_bf16 a[208:223], a[88:91], a[20:23], a[208:223]
ds_read_b64_tr_b16 a[124:125], v17 offset:28672
ds_read_b64_tr_b16 a[126:127], v17 offset:29696
s_add_u32 s68, s68, 128
v_mfma_f32_32x32x16_bf16 a[224:239], a[92:95], a[16:19], a[224:239]
v_mfma_f32_32x32x16_bf16 a[240:255], a[92:95], a[20:23], a[240:255]
s_waitcnt vmcnt(28) lgkmcnt(0)
s_barrier
v_mfma_f32_32x32x16_bf16 v[128:143], a[96:99], a[24:27], v[128:143]
ds_read_b64_tr_b16 a[64:65], v48 offset:16384
ds_read_b64_tr_b16 a[66:67], v48 offset:17408
s_add_u32 m0, s31, 147456
v_mfma_f32_32x32x16_bf16 v[144:159], a[96:99], a[28:31], v[144:159]
ds_read_b64_tr_b16 a[68:69], v49 offset:16384
buffer_load_dwordx4 v25, s[8:11], s66 offen lds
v_mfma_f32_32x32x16_bf16 v[160:175], a[100:103], a[24:27], v[160:175]
ds_read_b64_tr_b16 a[70:71], v49 offset:17408
v_mfma_f32_32x32x16_bf16 v[176:191], a[100:103], a[28:31], v[176:191]
ds_read_b64_tr_b16 a[72:73], v50 offset:16384
buffer_load_dwordx4 v26, s[8:11], s66 offen offset:1024 lds
v_mfma_f32_32x32x16_bf16 v[192:207], a[104:107], a[24:27], v[192:207]
ds_read_b64_tr_b16 a[74:75], v50 offset:17408
v_mfma_f32_32x32x16_bf16 v[208:223], a[104:107], a[28:31], v[208:223]
ds_read_b64_tr_b16 a[76:77], v51 offset:16384
buffer_load_dwordx4 v27, s[8:11], s66 offen offset:2048 lds
v_mfma_f32_32x32x16_bf16 v[224:239], a[108:111], a[24:27], v[224:239]
ds_read_b64_tr_b16 a[78:79], v51 offset:17408
v_mfma_f32_32x32x16_bf16 v[240:255], a[108:111], a[28:31], v[240:255]
ds_read_b64_tr_b16 a[80:81], v48 offset:24576
buffer_load_dwordx4 v28, s[8:11], s66 offen offset:3072 lds
v_mfma_f32_32x32x16_bf16 a[128:143], a[112:115], a[24:27], a[128:143]
ds_read_b64_tr_b16 a[82:83], v48 offset:25600
s_add_u32 s66, s66, 262144
v_mfma_f32_32x32x16_bf16 a[144:159], a[112:115], a[28:31], a[144:159]
ds_read_b64_tr_b16 a[84:85], v49 offset:24576
v_mfma_f32_32x32x16_bf16 a[160:175], a[116:119], a[24:27], a[160:175]
ds_read_b64_tr_b16 a[86:87], v49 offset:25600
v_mfma_f32_32x32x16_bf16 a[176:191], a[116:119], a[28:31], a[176:191]
ds_read_b64_tr_b16 a[88:89], v50 offset:24576
v_mfma_f32_32x32x16_bf16 a[192:207], a[120:123], a[24:27], a[192:207]
ds_read_b64_tr_b16 a[90:91], v50 offset:25600
v_mfma_f32_32x32x16_bf16 a[208:223], a[120:123], a[28:31], a[208:223]
ds_read_b64_tr_b16 a[92:93], v51 offset:24576
ds_read_b64_tr_b16 a[94:95], v51 offset:25600
v_mfma_f32_32x32x16_bf16 a[224:239], a[124:127], a[24:27], a[224:239]
v_mfma_f32_32x32x16_bf16 a[240:255], a[124:127], a[28:31], a[240:255]
s_waitcnt lgkmcnt(0)
v_mfma_f32_32x32x16_bf16 v[128:143], a[64:67], a[32:35], v[128:143]
ds_read_b64_tr_b16 a[96:97], v48 offset:20480
ds_read_b64_tr_b16 a[98:99], v48 offset:21504
v_mfma_f32_32x32x16_bf16 v[144:159], a[64:67], a[36:39], v[144:159]
ds_read_b64_tr_b16 a[100:101], v49 offset:20480
v_mfma_f32_32x32x16_bf16 v[160:175], a[68:71], a[32:35], v[160:175]
ds_read_b64_tr_b16 a[102:103], v49 offset:21504
v_mfma_f32_32x32x16_bf16 v[176:191], a[68:71], a[36:39], v[176:191]
ds_read_b64_tr_b16 a[104:105], v50 offset:20480
v_mfma_f32_32x32x16_bf16 v[192:207], a[72:75], a[32:35], v[192:207]
ds_read_b64_tr_b16 a[106:107], v50 offset:21504
v_mfma_f32_32x32x16_bf16 v[208:223], a[72:75], a[36:39], v[208:223]
ds_read_b64_tr_b16 a[108:109], v51 offset:20480
v_mfma_f32_32x32x16_bf16 v[224:239], a[76:79], a[32:35], v[224:239]
ds_read_b64_tr_b16 a[110:111], v51 offset:21504
v_mfma_f32_32x32x16_bf16 v[240:255], a[76:79], a[36:39], v[240:255]
ds_read_b64_tr_b16 a[112:113], v48 offset:28672
v_mfma_f32_32x32x16_bf16 a[128:143], a[80:83], a[32:35], a[128:143]
ds_read_b64_tr_b16 a[114:115], v48 offset:29696
v_mfma_f32_32x32x16_bf16 a[144:159], a[80:83], a[36:39], a[144:159]
ds_read_b64_tr_b16 a[116:117], v49 offset:28672
v_mfma_f32_32x32x16_bf16 a[160:175], a[84:87], a[32:35], a[160:175]
ds_read_b64_tr_b16 a[118:119], v49 offset:29696
v_mfma_f32_32x32x16_bf16 a[176:191], a[84:87], a[36:39], a[176:191]
ds_read_b64_tr_b16 a[120:121], v50 offset:28672
v_mfma_f32_32x32x16_bf16 a[192:207], a[88:91], a[32:35], a[192:207]
ds_read_b64_tr_b16 a[122:123], v50 offset:29696
v_mfma_f32_32x32x16_bf16 a[208:223], a[88:91], a[36:39], a[208:223]
ds_read_b64_tr_b16 a[124:125], v51 offset:28672
ds_read_b64_tr_b16 a[126:127], v51 offset:29696
v_mfma_f32_32x32x16_bf16 a[224:239], a[92:95], a[32:35], a[224:239]
v_mfma_f32_32x32x16_bf16 a[240:255], a[92:95], a[36:39], a[240:255]
s_waitcnt vmcnt(20) lgkmcnt(0)
s_barrier
v_mfma_f32_32x32x16_bf16 v[128:143], a[96:99], a[40:43], v[128:143]
ds_read_b64_tr_b16 a[64:65], v48 offset:0
ds_read_b64_tr_b16 a[66:67], v48 offset:1024
s_add_u32 m0, s31, 49152
v_mfma_f32_32x32x16_bf16 v[144:159], a[96:99], a[44:47], v[144:159]
ds_read_b64_tr_b16 a[68:69], v49 offset:0
buffer_load_dwordx4 v25, s[8:11], s66 offen lds
v_mfma_f32_32x32x16_bf16 v[160:175], a[100:103], a[40:43], v[160:175]
ds_read_b64_tr_b16 a[70:71], v49 offset:1024
v_mfma_f32_32x32x16_bf16 v[176:191], a[100:103], a[44:47], v[176:191]
ds_read_b64_tr_b16 a[72:73], v50 offset:0
buffer_load_dwordx4 v26, s[8:11], s66 offen offset:1024 lds
v_mfma_f32_32x32x16_bf16 v[192:207], a[104:107], a[40:43], v[192:207]
ds_read_b64_tr_b16 a[74:75], v50 offset:1024
v_mfma_f32_32x32x16_bf16 v[208:223], a[104:107], a[44:47], v[208:223]
ds_read_b64_tr_b16 a[76:77], v51 offset:0
buffer_load_dwordx4 v27, s[8:11], s66 offen offset:2048 lds
v_mfma_f32_32x32x16_bf16 v[224:239], a[108:111], a[40:43], v[224:239]
ds_read_b64_tr_b16 a[78:79], v51 offset:1024
v_mfma_f32_32x32x16_bf16 v[240:255], a[108:111], a[44:47], v[240:255]
ds_read_b64_tr_b16 a[80:81], v48 offset:8192
s_waitcnt vmcnt(23)
buffer_load_dwordx4 v28, s[8:11], s66 offen offset:3072 lds
v_mfma_f32_32x32x16_bf16 a[128:143], a[112:115], a[40:43], a[128:143]
ds_read_b64_tr_b16 a[82:83], v48 offset:9216
ds_read_b128 a[0:3], v18 offset:0
s_add_u32 s66, s66, 262144
v_mfma_f32_32x32x16_bf16 a[144:159], a[112:115], a[44:47], a[144:159]
ds_read_b64_tr_b16 a[84:85], v49 offset:8192
ds_read_b128 a[4:7], v18 offset:4096
v_mfma_f32_32x32x16_bf16 a[160:175], a[116:119], a[40:43], a[160:175]
ds_read_b64_tr_b16 a[86:87], v49 offset:9216
ds_read_b128 a[8:11], v19 offset:0
v_mfma_f32_32x32x16_bf16 a[176:191], a[116:119], a[44:47], a[176:191]
ds_read_b64_tr_b16 a[88:89], v50 offset:8192
ds_read_b128 a[12:15], v19 offset:4096
v_mfma_f32_32x32x16_bf16 a[192:207], a[120:123], a[40:43], a[192:207]
ds_read_b64_tr_b16 a[90:91], v50 offset:9216
ds_read_b128 a[16:19], v20 offset:0
v_mfma_f32_32x32x16_bf16 a[208:223], a[120:123], a[44:47], a[208:223]
ds_read_b64_tr_b16 a[92:93], v51 offset:8192
ds_read_b64_tr_b16 a[94:95], v51 offset:9216
ds_read_b128 a[20:23], v20 offset:4096
v_mfma_f32_32x32x16_bf16 a[224:239], a[124:127], a[40:43], a[224:239]
ds_read_b128 a[24:27], v21 offset:0
v_mfma_f32_32x32x16_bf16 a[240:255], a[124:127], a[44:47], a[240:255]
ds_read_b128 a[28:31], v21 offset:4096
s_waitcnt lgkmcnt(15)
v_mfma_f32_32x32x16_bf16 v[128:143], a[64:67], a[48:51], v[128:143]
ds_read_b64_tr_b16 a[96:97], v48 offset:4096
ds_read_b64_tr_b16 a[98:99], v48 offset:5120
s_cmp_eq_u32 s60, 1
s_cselect_b32 s76, s61, s32
v_mfma_f32_32x32x16_bf16 v[144:159], a[64:67], a[52:55], v[144:159]
ds_read_b64_tr_b16 a[100:101], v49 offset:4096
s_cselect_b32 s67, 1073741824, s67
s_cselect_b32 s68, 1073741824, s68
v_mfma_f32_32x32x16_bf16 v[160:175], a[68:71], a[48:51], v[160:175]
ds_read_b64_tr_b16 a[102:103], v49 offset:5120
s_add_u32 m0, s76, 0
v_mfma_f32_32x32x16_bf16 v[176:191], a[68:71], a[52:55], v[176:191]
ds_read_b64_tr_b16 a[104:105], v50 offset:4096
s_waitcnt lgkmcnt(5)
buffer_load_dwordx4 v29, s[4:7], s67 offen lds
v_mfma_f32_32x32x16_bf16 v[192:207], a[72:75], a[48:51], v[192:207]
ds_read_b64_tr_b16 a[106:107], v50 offset:5120
buffer_load_dwordx4 v30, s[4:7], s67 offen offset:1024 lds
v_mfma_f32_32x32x16_bf16 v[208:223], a[72:75], a[52:55], v[208:223]
ds_read_b64_tr_b16 a[108:109], v51 offset:4096
buffer_load_dwordx4 v31, s[4:7], s67 offen offset:2048 lds
v_mfma_f32_32x32x16_bf16 v[224:239], a[76:79], a[48:51], v[224:239]
ds_read_b64_tr_b16 a[110:111], v51 offset:5120
buffer_load_dwordx4 v32, s[4:7], s67 offen offset:3072 lds
v_mfma_f32_32x32x16_bf16 v[240:255], a[76:79], a[52:55], v[240:255]
ds_read_b64_tr_b16 a[112:113], v48 offset:12288
s_add_u32 m0, s76, 4096
v_mfma_f32_32x32x16_bf16 a[128:143], a[80:83], a[48:51], a[128:143]
ds_read_b64_tr_b16 a[114:115], v48 offset:13312
s_add_u32 s67, s67, 128
v_mfma_f32_32x32x16_bf16 a[144:159], a[80:83], a[52:55], a[144:159]
ds_read_b64_tr_b16 a[116:117], v49 offset:12288
buffer_load_dwordx4 v29, s[4:7], s68 offen lds
v_mfma_f32_32x32x16_bf16 a[160:175], a[84:87], a[48:51], a[160:175]
ds_read_b64_tr_b16 a[118:119], v49 offset:13312
buffer_load_dwordx4 v30, s[4:7], s68 offen offset:1024 lds
v_mfma_f32_32x32x16_bf16 a[176:191], a[84:87], a[52:55], a[176:191]
ds_read_b64_tr_b16 a[120:121], v50 offset:12288
buffer_load_dwordx4 v31, s[4:7], s68 offen offset:2048 lds
v_mfma_f32_32x32x16_bf16 a[192:207], a[88:91], a[48:51], a[192:207]
ds_read_b64_tr_b16 a[122:123], v50 offset:13312
buffer_load_dwordx4 v32, s[4:7], s68 offen offset:3072 lds
v_mfma_f32_32x32x16_bf16 a[208:223], a[88:91], a[52:55], a[208:223]
ds_read_b64_tr_b16 a[124:125], v51 offset:12288
ds_read_b64_tr_b16 a[126:127], v51 offset:13312
s_add_u32 s68, s68, 128
v_mfma_f32_32x32x16_bf16 a[224:239], a[92:95], a[48:51], a[224:239]
v_mfma_f32_32x32x16_bf16 a[240:255], a[92:95], a[52:55], a[240:255]
s_waitcnt vmcnt(24) lgkmcnt(0)
s_barrier
v_mfma_f32_32x32x16_bf16 v[128:143], a[96:99], a[56:59], v[128:143]
ds_read_b64_tr_b16 a[64:65], v14 offset:0
ds_read_b64_tr_b16 a[66:67], v14 offset:1024
s_add_u32 m0, s31, 32768
v_mfma_f32_32x32x16_bf16 v[144:159], a[96:99], a[60:63], v[144:159]
ds_read_b64_tr_b16 a[68:69], v15 offset:0
buffer_load_dwordx4 v25, s[8:11], s66 offen lds
v_mfma_f32_32x32x16_bf16 v[160:175], a[100:103], a[56:59], v[160:175]
ds_read_b64_tr_b16 a[70:71], v15 offset:1024
v_mfma_f32_32x32x16_bf16 v[176:191], a[100:103], a[60:63], v[176:191]
ds_read_b64_tr_b16 a[72:73], v16 offset:0
buffer_load_dwordx4 v26, s[8:11], s66 offen offset:1024 lds
v_mfma_f32_32x32x16_bf16 v[192:207], a[104:107], a[56:59], v[192:207]
ds_read_b64_tr_b16 a[74:75], v16 offset:1024
v_mfma_f32_32x32x16_bf16 v[208:223], a[104:107], a[60:63], v[208:223]
ds_read_b64_tr_b16 a[76:77], v17 offset:0
buffer_load_dwordx4 v27, s[8:11], s66 offen offset:2048 lds
v_mfma_f32_32x32x16_bf16 v[224:239], a[108:111], a[56:59], v[224:239]
ds_read_b64_tr_b16 a[78:79], v17 offset:1024
v_mfma_f32_32x32x16_bf16 v[240:255], a[108:111], a[60:63], v[240:255]
ds_read_b64_tr_b16 a[80:81], v14 offset:8192
buffer_load_dwordx4 v28, s[8:11], s66 offen offset:3072 lds
v_mfma_f32_32x32x16_bf16 a[128:143], a[112:115], a[56:59], a[128:143]
ds_read_b64_tr_b16 a[82:83], v14 offset:9216
s_add_u32 s66, s66, 262144
v_mfma_f32_32x32x16_bf16 a[144:159], a[112:115], a[60:63], a[144:159]
ds_read_b64_tr_b16 a[84:85], v15 offset:8192
v_mfma_f32_32x32x16_bf16 a[160:175], a[116:119], a[56:59], a[160:175]
ds_read_b64_tr_b16 a[86:87], v15 offset:9216
v_mfma_f32_32x32x16_bf16 a[176:191], a[116:119], a[60:63], a[176:191]
ds_read_b64_tr_b16 a[88:89], v16 offset:8192
v_mfma_f32_32x32x16_bf16 a[192:207], a[120:123], a[56:59], a[192:207]
ds_read_b64_tr_b16 a[90:91], v16 offset:9216
v_mfma_f32_32x32x16_bf16 a[208:223], a[120:123], a[60:63], a[208:223]
ds_read_b64_tr_b16 a[92:93], v17 offset:8192
ds_read_b64_tr_b16 a[94:95], v17 offset:9216
v_mfma_f32_32x32x16_bf16 a[224:239], a[124:127], a[56:59], a[224:239]
v_mfma_f32_32x32x16_bf16 a[240:255], a[124:127], a[60:63], a[240:255]
s_sub_u32 s60, s60, 1
s_cmp_lg_u32 s60, 0
s_cbranch_scc1 L1_qloop
s_waitcnt lgkmcnt(10)
v_mfma_f32_32x32x16_bf16 v[128:143], a[64:67], a[0:3], v[128:143]
ds_read_b64_tr_b16 a[96:97], v14 offset:4096
ds_read_b64_tr_b16 a[98:99], v14 offset:5120
s_mul_i32 s62, s24, 6144
v_mfma_f32_32x32x16_bf16 v[144:159], a[64:67], a[4:7], v[144:159]
ds_read_b64_tr_b16 a[100:101], v15 offset:4096
s_mov_b32 s63, s32
v_mfma_f32_32x32x16_bf16 v[160:175], a[68:71], a[0:3], v[160:175]
ds_read_b64_tr_b16 a[102:103], v15 offset:5120
v_mfma_f32_32x32x16_bf16 v[176:191], a[68:71], a[4:7], v[176:191]
ds_read_b64_tr_b16 a[104:105], v16 offset:4096
s_mov_b32 m0, s63
s_add_u32 s64, s62, 4096
v_mfma_f32_32x32x16_bf16 v[192:207], a[72:75], a[0:3], v[192:207]
ds_read_b64_tr_b16 a[106:107], v16 offset:5120
s_waitcnt lgkmcnt(6)
buffer_load_dwordx4 v24, s[16:19], s62 offen nt lds
v_mfma_f32_32x32x16_bf16 v[208:223], a[72:75], a[4:7], v[208:223]
ds_read_b64_tr_b16 a[108:109], v17 offset:4096
buffer_load_dwordx4 v24, s[16:19], s62 offen offset:1024 nt lds
v_mfma_f32_32x32x16_bf16 v[224:239], a[76:79], a[0:3], v[224:239]
ds_read_b64_tr_b16 a[110:111], v17 offset:5120
buffer_load_dwordx4 v24, s[16:19], s62 offen offset:2048 nt lds
v_mfma_f32_32x32x16_bf16 v[240:255], a[76:79], a[4:7], v[240:255]
ds_read_b64_tr_b16 a[112:113], v14 offset:12288
buffer_load_dwordx4 v24, s[16:19], s62 offen offset:3072 nt lds
v_mfma_f32_32x32x16_bf16 a[128:143], a[80:83], a[0:3], a[128:143]
ds_read_b64_tr_b16 a[114:115], v14 offset:13312
s_add_u32 m0, s63, 4096
v_mfma_f32_32x32x16_bf16 a[144:159], a[80:83], a[4:7], a[144:159]
ds_read_b64_tr_b16 a[116:117], v15 offset:12288
buffer_load_dwordx4 v24, s[16:19], s64 offen nt lds
v_mfma_f32_32x32x16_bf16 a[160:175], a[84:87], a[0:3], a[160:175]
ds_read_b64_tr_b16 a[118:119], v15 offset:13312
buffer_load_dwordx4 v24, s[16:19], s64 offen offset:1024 nt lds
v_mfma_f32_32x32x16_bf16 a[176:191], a[84:87], a[4:7], a[176:191]
ds_read_b64_tr_b16 a[120:121], v16 offset:12288
buffer_load_dwordx4 v24, s[16:19], s64 offen offset:2048 nt lds
v_mfma_f32_32x32x16_bf16 a[192:207], a[88:91], a[0:3], a[192:207]
ds_read_b64_tr_b16 a[122:123], v16 offset:13312
buffer_load_dwordx4 v24, s[16:19], s64 offen offset:3072 nt lds
v_mfma_f32_32x32x16_bf16 a[208:223], a[88:91], a[4:7], a[208:223]
ds_read_b64_tr_b16 a[124:125], v17 offset:12288
ds_read_b64_tr_b16 a[126:127], v17 offset:13312
v_mfma_f32_32x32x16_bf16 a[224:239], a[92:95], a[0:3], a[224:239]
v_mfma_f32_32x32x16_bf16 a[240:255], a[92:95], a[4:7], a[240:255]
s_waitcnt vmcnt(24) lgkmcnt(0)
s_barrier
v_mfma_f32_32x32x16_bf16 v[128:143], a[96:99], a[8:11], v[128:143]
ds_read_b64_tr_b16 a[64:65], v14 offset:16384
ds_read_b64_tr_b16 a[66:67], v14 offset:17408
v_mfma_f32_32x32x16_bf16 v[144:159], a[96:99], a[12:15], v[144:159]
ds_read_b64_tr_b16 a[68:69], v15 offset:16384
v_mfma_f32_32x32x16_bf16 v[160:175], a[100:103], a[8:11], v[160:175]
ds_read_b64_tr_b16 a[70:71], v15 offset:17408
v_mfma_f32_32x32x16_bf16 v[176:191], a[100:103], a[12:15], v[176:191]
ds_read_b64_tr_b16 a[72:73], v16 offset:16384
v_mfma_f32_32x32x16_bf16 v[192:207], a[104:107], a[8:11], v[192:207]
ds_read_b64_tr_b16 a[74:75], v16 offset:17408
v_mfma_f32_32x32x16_bf16 v[208:223], a[104:107], a[12:15], v[208:223]
ds_read_b64_tr_b16 a[76:77], v17 offset:16384
v_mfma_f32_32x32x16_bf16 v[224:239], a[108:111], a[8:11], v[224:239]
ds_read_b64_tr_b16 a[78:79], v17 offset:17408
v_mfma_f32_32x32x16_bf16 v[240:255], a[108:111], a[12:15], v[240:255]
ds_read_b64_tr_b16 a[80:81], v14 offset:24576
s_waitcnt vmcnt(63)
v_mfma_f32_32x32x16_bf16 a[128:143], a[112:115], a[8:11], a[128:143]
ds_read_b64_tr_b16 a[82:83], v14 offset:25600
ds_read_b128 a[32:35], v18 offset:32768
v_mfma_f32_32x32x16_bf16 a[144:159], a[112:115], a[12:15], a[144:159]
ds_read_b64_tr_b16 a[84:85], v15 offset:24576
ds_read_b128 a[36:39], v18 offset:36864
v_mfma_f32_32x32x16_bf16 a[160:175], a[116:119], a[8:11], a[160:175]
ds_read_b64_tr_b16 a[86:87], v15 offset:25600
ds_read_b128 a[40:43], v19 offset:32768
v_mfma_f32_32x32x16_bf16 a[176:191], a[116:119], a[12:15], a[176:191]
ds_read_b64_tr_b16 a[88:89], v16 offset:24576
ds_read_b128 a[44:47], v19 offset:36864
v_mfma_f32_32x32x16_bf16 a[192:207], a[120:123], a[8:11], a[192:207]
ds_read_b64_tr_b16 a[90:91], v16 offset:25600
ds_read_b128 a[48:51], v20 offset:32768
v_mfma_f32_32x32x16_bf16 a[208:223], a[120:123], a[12:15], a[208:223]
ds_read_b64_tr_b16 a[92:93], v17 offset:24576
ds_read_b64_tr_b16 a[94:95], v17 offset:25600
ds_read_b128 a[52:55], v20 offset:36864
v_mfma_f32_32x32x16_bf16 a[224:239], a[124:127], a[8:11], a[224:239]
ds_read_b128 a[56:59], v21 offset:32768
v_mfma_f32_32x32x16_bf16 a[240:255], a[124:127], a[12:15], a[240:255]
ds_read_b128 a[60:63], v21 offset:36864
s_waitcnt lgkmcnt(15)
v_mfma_f32_32x32x16_bf16 v[128:143], a[64:67], a[16:19], v[128:143]
ds_read_b64_tr_b16 a[96:97], v14 offset:20480
ds_read_b64_tr_b16 a[98:99], v14 offset:21504
s_xor_b32 s62, s24, 2
s_lshl_b32 s62, s62, 13
v_mfma_f32_32x32x16_bf16 v[144:159], a[64:67], a[20:23], v[144:159]
ds_read_b64_tr_b16 a[100:101], v15 offset:20480
s_sub_u32 s62, s62, s27
s_add_u32 s62, s62, 32768
s_add_u32 s63, s32, 32768
v_mfma_f32_32x32x16_bf16 v[160:175], a[68:71], a[16:19], v[160:175]
ds_read_b64_tr_b16 a[102:103], v15 offset:21504
s_cmp_eq_u32 s24, 1
s_cselect_b32 s62, 1073741824, s62
s_cselect_b32 s63, s61, s63
v_mfma_f32_32x32x16_bf16 v[176:191], a[68:71], a[20:23], v[176:191]
ds_read_b64_tr_b16 a[104:105], v16 offset:20480
s_mov_b32 m0, s63
s_add_u32 s64, s62, 4096
v_mfma_f32_32x32x16_bf16 v[192:207], a[72:75], a[16:19], v[192:207]
ds_read_b64_tr_b16 a[106:107], v16 offset:21504
s_waitcnt lgkmcnt(6)
buffer_load_dwordx4 v24, s[16:19], s62 offen nt lds
v_mfma_f32_32x32x16_bf16 v[208:223], a[72:75], a[20:23], v[208:223]
ds_read_b64_tr_b16 a[108:109], v17 offset:20480
buffer_load_dwordx4 v24, s[16:19], s62 offen offset:1024 nt lds
v_mfma_f32_32x32x16_bf16 v[224:239], a[76:79], a[16:19], v[224:239]
ds_read_b64_tr_b16 a[110:111], v17 offset:21504
buffer_load_dwordx4 v24, s[16:19], s62 offen offset:2048 nt lds
v_mfma_f32_32x32x16_bf16 v[240:255], a[76:79], a[20:23], v[240:255]
ds_read_b64_tr_b16 a[112:113], v14 offset:28672
buffer_load_dwordx4 v24, s[16:19], s62 offen offset:3072 nt lds
v_mfma_f32_32x32x16_bf16 a[128:143], a[80:83], a[16:19], a[128:143]
ds_read_b64_tr_b16 a[114:115], v14 offset:29696
s_add_u32 m0, s63, 4096
v_mfma_f32_32x32x16_bf16 a[144:159], a[80:83], a[20:23], a[144:159]
ds_read_b64_tr_b16 a[116:117], v15 offset:28672
buffer_load_dwordx4 v24, s[16:19], s64 offen nt lds
v_mfma_f32_32x32x16_bf16 a[160:175], a[84:87], a[16:19], a[160:175]
ds_read_b64_tr_b16 a[118:119], v15 offset:29696
buffer_load_dwordx4 v24, s[16:19], s64 offen offset:1024 nt lds
v_mfma_f32_32x32x16_bf16 a[176:191], a[84:87], a[20:23], a[176:191]
ds_read_b64_tr_b16 a[120:121], v16 offset:28672
buffer_load_dwordx4 v24, s[16:19], s64 offen offset:2048 nt lds
v_mfma_f32_32x32x16_bf16 a[192:207], a[88:91], a[16:19], a[192:207]
ds_read_b64_tr_b16 a[122:123], v16 offset:29696
buffer_load_dwordx4 v24, s[16:19], s64 offen offset:3072 nt lds
v_mfma_f32_32x32x16_bf16 a[208:223], a[88:91], a[20:23], a[208:223]
ds_read_b64_tr_b16 a[124:125], v17 offset:28672
ds_read_b64_tr_b16 a[126:127], v17 offset:29696
v_mfma_f32_32x32x16_bf16 a[224:239], a[92:95], a[16:19], a[224:239]
v_mfma_f32_32x32x16_bf16 a[240:255], a[92:95], a[20:23], a[240:255]
s_waitcnt vmcnt(28) lgkmcnt(0)
s_barrier
v_mfma_f32_32x32x16_bf16 v[128:143], a[96:99], a[24:27], v[128:143]
ds_read_b64_tr_b16 a[64:65], v48 offset:16384
ds_read_b64_tr_b16 a[66:67], v48 offset:17408
v_mfma_f32_32x32x16_bf16 v[144:159], a[96:99], a[28:31], v[144:159]
ds_read_b64_tr_b16 a[68:69], v49 offset:16384
v_mfma_f32_32x32x16_bf16 v[160:175], a[100:103], a[24:27], v[160:175]
ds_read_b64_tr_b16 a[70:71], v49 offset:17408
v_mfma_f32_32x32x16_bf16 v[176:191], a[100:103], a[28:31], v[176:191]
ds_read_b64_tr_b16 a[72:73], v50 offset:16384
v_mfma_f32_32x32x16_bf16 v[192:207], a[104:107], a[24:27], v[192:207]
ds_read_b64_tr_b16 a[74:75], v50 offset:17408
v_mfma_f32_32x32x16_bf16 v[208:223], a[104:107], a[28:31], v[208:223]
ds_read_b64_tr_b16 a[76:77], v51 offset:16384
v_mfma_f32_32x32x16_bf16 v[224:239], a[108:111], a[24:27], v[224:239]
ds_read_b64_tr_b16 a[78:79], v51 offset:17408
v_mfma_f32_32x32x16_bf16 v[240:255], a[108:111], a[28:31], v[240:255]
ds_read_b64_tr_b16 a[80:81], v48 offset:24576
v_mfma_f32_32x32x16_bf16 a[128:143], a[112:115], a[24:27], a[128:143]
ds_read_b64_tr_b16 a[82:83], v48 offset:25600
v_mfma_f32_32x32x16_bf16 a[144:159], a[112:115], a[28:31], a[144:159]
ds_read_b64_tr_b16 a[84:85], v49 offset:24576
v_mfma_f32_32x32x16_bf16 a[160:175], a[116:119], a[24:27], a[160:175]
ds_read_b64_tr_b16 a[86:87], v49 offset:25600
v_mfma_f32_32x32x16_bf16 a[176:191], a[116:119], a[28:31], a[176:191]
ds_read_b64_tr_b16 a[88:89], v50 offset:24576
v_mfma_f32_32x32x16_bf16 a[192:207], a[120:123], a[24:27], a[192:207]
ds_read_b64_tr_b16 a[90:91], v50 offset:25600
v_mfma_f32_32x32x16_bf16 a[208:223], a[120:123], a[28:31], a[208:223]
ds_read_b64_tr_b16 a[92:93], v51 offset:24576
ds_read_b64_tr_b16 a[94:95], v51 offset:25600
v_mfma_f32_32x32x16_bf16 a[224:239], a[124:127], a[24:27], a[224:239]
v_mfma_f32_32x32x16_bf16 a[240:255], a[124:127], a[28:31], a[240:255]
s_waitcnt lgkmcnt(0)
v_mfma_f32_32x32x16_bf16 v[128:143], a[64:67], a[32:35], v[128:143]
ds_read_b64_tr_b16 a[96:97], v48 offset:20480
ds_read_b64_tr_b16 a[98:99], v48 offset:21504
v_mfma_f32_32x32x16_bf16 v[144:159], a[64:67], a[36:39], v[144:159]
ds_read_b64_tr_b16 a[100:101], v49 offset:20480
v_mfma_f32_32x32x16_bf16 v[160:175], a[68:71], a[32:35], v[160:175]
ds_read_b64_tr_b16 a[102:103], v49 offset:21504
v_mfma_f32_32x32x16_bf16 v[176:191], a[68:71], a[36:39], v[176:191]
ds_read_b64_tr_b16 a[104:105], v50 offset:20480
v_mfma_f32_32x32x16_bf16 v[192:207], a[72:75], a[32:35], v[192:207]
ds_read_b64_tr_b16 a[106:107], v50 offset:21504
v_mfma_f32_32x32x16_bf16 v[208:223], a[72:75], a[36:39], v[208:223]
ds_read_b64_tr_b16 a[108:109], v51 offset:20480
v_mfma_f32_32x32x16_bf16 v[224:239], a[76:79], a[32:35], v[224:239]
ds_read_b64_tr_b16 a[110:111], v51 offset:21504
v_mfma_f32_32x32x16_bf16 v[240:255], a[76:79], a[36:39], v[240:255]
ds_read_b64_tr_b16 a[112:113], v48 offset:28672
v_mfma_f32_32x32x16_bf16 a[128:143], a[80:83], a[32:35], a[128:143]
ds_read_b64_tr_b16 a[114:115], v48 offset:29696
v_mfma_f32_32x32x16_bf16 a[144:159], a[80:83], a[36:39], a[144:159]
ds_read_b64_tr_b16 a[116:117], v49 offset:28672
v_mfma_f32_32x32x16_bf16 a[160:175], a[84:87], a[32:35], a[160:175]
ds_read_b64_tr_b16 a[118:119], v49 offset:29696
v_mfma_f32_32x32x16_bf16 a[176:191], a[84:87], a[36:39], a[176:191]
ds_read_b64_tr_b16 a[120:121], v50 offset:28672
v_mfma_f32_32x32x16_bf16 a[192:207], a[88:91], a[32:35], a[192:207]
ds_read_b64_tr_b16 a[122:123], v50 offset:29696
v_mfma_f32_32x32x16_bf16 a[208:223], a[88:91], a[36:39], a[208:223]
ds_read_b64_tr_b16 a[124:125], v51 offset:28672
ds_read_b64_tr_b16 a[126:127], v51 offset:29696
v_mfma_f32_32x32x16_bf16 a[224:239], a[92:95], a[32:35], a[224:239]
v_mfma_f32_32x32x16_bf16 a[240:255], a[92:95], a[36:39], a[240:255]
s_waitcnt vmcnt(16) lgkmcnt(0)
s_barrier
v_mfma_f32_32x32x16_bf16 v[128:143], a[96:99], a[40:43], v[128:143]
ds_read_b64_tr_b16 a[64:65], v48 offset:0
ds_read_b64_tr_b16 a[66:67], v48 offset:1024
s_add_u32 m0, s27, 49152
s_mov_b32 s62, 32768
v_mfma_f32_32x32x16_bf16 v[144:159], a[96:99], a[44:47], v[144:159]
ds_read_b64_tr_b16 a[68:69], v49 offset:0
buffer_load_dwordx4 v22, s[12:15], s62 offen nt lds
v_mfma_f32_32x32x16_bf16 v[160:175], a[100:103], a[40:43], v[160:175]
ds_read_b64_tr_b16 a[70:71], v49 offset:1024
v_mfma_f32_32x32x16_bf16 v[176:191], a[100:103], a[44:47], v[176:191]
ds_read_b64_tr_b16 a[72:73], v50 offset:0
buffer_load_dwordx4 v23, s[12:15], s62 offen offset:1024 nt lds
v_mfma_f32_32x32x16_bf16 v[192:207], a[104:107], a[40:43], v[192:207]
ds_read_b64_tr_b16 a[74:75], v50 offset:1024
ds_read_b64_tr_b16 a[96:97], v48 offset:4096
s_add_u32 m0, s28, 49152
s_mov_b32 s62, 40960
v_mfma_f32_32x32x16_bf16 v[208:223], a[104:107], a[44:47], v[208:223]
ds_read_b64_tr_b16 a[76:77], v51 offset:0
ds_read_b64_tr_b16 a[98:99], v48 offset:5120
buffer_load_dwordx4 v22, s[12:15], s62 offen nt lds
v_mfma_f32_32x32x16_bf16 v[224:239], a[108:111], a[40:43], v[224:239]
ds_read_b64_tr_b16 a[78:79], v51 offset:1024
ds_read_b64_tr_b16 a[100:101], v49 offset:4096
v_mfma_f32_32x32x16_bf16 v[240:255], a[108:111], a[44:47], v[240:255]
ds_read_b64_tr_b16 a[80:81], v48 offset:8192
ds_read_b64_tr_b16 a[102:103], v49 offset:5120
buffer_load_dwordx4 v23, s[12:15], s62 offen offset:1024 nt lds
v_mfma_f32_32x32x16_bf16 a[128:143], a[112:115], a[40:43], a[128:143]
ds_read_b64_tr_b16 a[82:83], v48 offset:9216
ds_read_b64_tr_b16 a[104:105], v50 offset:4096
v_mfma_f32_32x32x16_bf16 a[144:159], a[112:115], a[44:47], a[144:159]
ds_read_b64_tr_b16 a[84:85], v49 offset:8192
ds_read_b64_tr_b16 a[106:107], v50 offset:5120
v_mfma_f32_32x32x16_bf16 a[160:175], a[116:119], a[40:43], a[160:175]
ds_read_b64_tr_b16 a[86:87], v49 offset:9216
ds_read_b64_tr_b16 a[108:109], v51 offset:4096
v_mfma_f32_32x32x16_bf16 a[176:191], a[116:119], a[44:47], a[176:191]
ds_read_b64_tr_b16 a[88:89], v50 offset:8192
ds_read_b64_tr_b16 a[110:111], v51 offset:5120
v_mfma_f32_32x32x16_bf16 a[192:207], a[120:123], a[40:43], a[192:207]
ds_read_b64_tr_b16 a[90:91], v50 offset:9216
v_mfma_f32_32x32x16_bf16 a[208:223], a[120:123], a[44:47], a[208:223]
ds_read_b64_tr_b16 a[92:93], v51 offset:8192
ds_read_b64_tr_b16 a[94:95], v51 offset:9216
v_mfma_f32_32x32x16_bf16 a[224:239], a[124:127], a[40:43], a[224:239]
v_mfma_f32_32x32x16_bf16 a[240:255], a[124:127], a[44:47], a[240:255]
s_waitcnt lgkmcnt(3)
v_mfma_f32_32x32x16_bf16 v[128:143], a[64:67], a[48:51], v[128:143]
ds_read_b64_tr_b16 a[112:113], v48 offset:12288
s_add_u32 s40, s56, 0x4000000
s_addc_u32 s41, s57, 0
s_mov_b32 s42, 8388608
s_mov_b32 s43, 0x20000
s_mov_b32 s35, 0x3e0293ee
v_mfma_f32_32x32x16_bf16 v[160:175], a[68:71], a[48:51], v[160:175]
ds_read_b64_tr_b16 a[114:115], v48 offset:13312
s_mov_b32 s33, 0x37800000
s_mov_b32 s34, 0x5f800000
s_mov_b32 s58, 65536
s_mov_b32 s59, 57344
v_mov_b32 v14, 0
v_mfma_f32_32x32x16_bf16 v[192:207], a[72:75], a[48:51], v[192:207]
ds_read_b64_tr_b16 a[116:117], v49 offset:12288
v_mov_b32 v15, 0
v_mov_b32 v16, 0x3e0293ee
v_mov_b32 v17, 0x3e0293ee
v_mfma_f32_32x32x16_bf16 v[224:239], a[76:79], a[48:51], v[224:239]
ds_read_b64_tr_b16 a[118:119], v49 offset:13312
v_mfma_f32_32x32x16_bf16 v[128:143], a[96:99], a[56:59], v[128:143]
ds_read_b64_tr_b16 a[120:121], v50 offset:12288
s_nop 1
v_mfma_f32_32x32x16_bf16 v[160:175], a[100:103], a[56:59], v[160:175]
ds_read_b64_tr_b16 a[122:123], v50 offset:13312
s_nop 1
v_mfma_f32_32x32x16_bf16 v[192:207], a[104:107], a[56:59], v[192:207]
ds_read_b64_tr_b16 a[124:125], v51 offset:12288
s_nop 1
v_mfma_f32_32x32x16_bf16 v[224:239], a[108:111], a[56:59], v[224:239]
ds_read_b64_tr_b16 a[126:127], v51 offset:13312
v_mul_f32 v80, s35, v128
v_mul_f32 v81, s35, v129
v_mul_f32 v82, s35, v130
v_mul_f32 v83, s35, v131
v_mul_f32 v84, s35, v132
v_mfma_f32_32x32x16_bf16 v[144:159], a[64:67], a[52:55], v[144:159]
v_mul_f32 v85, s35, v133
v_mul_f32 v86, s35, v134
v_mul_f32 v87, s35, v135
v_mul_f32 v88, s35, v136
v_mul_f32 v89, s35, v137
v_mul_f32 v90, s35, v138
v_mfma_f32_32x32x16_bf16 v[176:191], a[68:71], a[52:55], v[176:191]
v_mul_f32 v91, s35, v139
v_mul_f32 v92, s35, v140
v_mul_f32 v93, s35, v141
v_mul_f32 v94, s35, v142
v_mul_f32 v95, s35, v143
v_cvt_pk_bf16_f32 v80, v80, v81
v_mfma_f32_32x32x16_bf16 v[208:223], a[72:75], a[52:55], v[208:223]
v_cvt_pk_bf16_f32 v81, v82, v83
v_cvt_pk_bf16_f32 v82, v84, v85
v_cvt_pk_bf16_f32 v83, v86, v87
v_cvt_pk_bf16_f32 v84, v88, v89
v_cvt_pk_bf16_f32 v85, v90, v91
v_cvt_pk_bf16_f32 v86, v92, v93
v_mfma_f32_32x32x16_bf16 v[240:255], a[76:79], a[52:55], v[240:255]
v_cvt_pk_bf16_f32 v87, v94, v95
v_accvgpr_write_b32 a0, v80
v_accvgpr_write_b32 a1, v81
v_accvgpr_write_b32 a2, v82
v_accvgpr_write_b32 a3, v83
v_accvgpr_write_b32 a8, v84
v_mfma_f32_32x32x16_bf16 v[144:159], a[96:99], a[60:63], v[144:159]
v_accvgpr_write_b32 a9, v85
v_accvgpr_write_b32 a10, v86
v_accvgpr_write_b32 a11, v87
v_mul_f32 v48, s35, v160
v_mul_f32 v49, s35, v161
v_mul_f32 v50, s35, v162
v_mfma_f32_32x32x16_bf16 v[176:191], a[100:103], a[60:63], v[176:191]
v_mul_f32 v51, s35, v163
v_mul_f32 v52, s35, v164
v_mul_f32 v53, s35, v165
v_mul_f32 v54, s35, v166
v_mul_f32 v55, s35, v167
v_mul_f32 v56, s35, v168
v_mfma_f32_32x32x16_bf16 v[208:223], a[104:107], a[60:63], v[208:223]
v_mul_f32 v57, s35, v169
v_mul_f32 v58, s35, v170
v_mul_f32 v59, s35, v171
v_mul_f32 v60, s35, v172
v_mul_f32 v61, s35, v173
v_mul_f32 v62, s35, v174
v_mfma_f32_32x32x16_bf16 v[240:255], a[108:111], a[60:63], v[240:255]
v_mul_f32 v63, s35, v175
v_cvt_pk_bf16_f32 v48, v48, v49
v_cvt_pk_bf16_f32 v49, v50, v51
v_cvt_pk_bf16_f32 v50, v52, v53
v_cvt_pk_bf16_f32 v51, v54, v55
v_cvt_pk_bf16_f32 v52, v56, v57
s_waitcnt lgkmcnt(0)
s_waitcnt vmcnt(63)
s_barrier
v_mfma_f32_32x32x16_bf16 a[128:143], a[80:83], a[48:51], a[128:143]
s_add_u32 m0, s27, 32768
s_mov_b32 s62, 49152
ds_read_b128 a[64:67], v2
v_cvt_pk_bf16_f32 v53, v58, v59
v_cvt_pk_bf16_f32 v54, v60, v61
v_cvt_pk_bf16_f32 v55, v62, v63
v_mfma_f32_32x32x16_bf16 a[144:159], a[80:83], a[52:55], a[144:159]
buffer_load_dwordx4 v22, s[12:15], s62 offen nt lds
ds_read_b128 a[68:71], v3
v_accvgpr_write_b32 a16, v48
v_accvgpr_write_b32 a17, v49
v_accvgpr_write_b32 a18, v50
v_mfma_f32_32x32x16_bf16 a[160:175], a[84:87], a[48:51], a[160:175]
ds_read_b128 a[72:75], v4
v_accvgpr_write_b32 a19, v51
v_accvgpr_write_b32 a24, v52
v_accvgpr_write_b32 a25, v53
v_accvgpr_write_b32 a26, v54
v_accvgpr_write_b32 a27, v55
v_mfma_f32_32x32x16_bf16 a[176:191], a[84:87], a[52:55], a[176:191]
buffer_load_dwordx4 v23, s[12:15], s62 offen offset:1024 nt lds
ds_read_b128 a[76:79], v5
v_mul_f32 v80, s35, v192
v_mul_f32 v81, s35, v193
v_mul_f32 v82, s35, v194
v_mfma_f32_32x32x16_bf16 a[192:207], a[88:91], a[48:51], a[192:207]
s_add_u32 m0, s28, 32768
s_mov_b32 s62, 57344
v_mul_f32 v83, s35, v195
v_mul_f32 v84, s35, v196
v_mul_f32 v85, s35, v197
v_mul_f32 v86, s35, v198
v_mfma_f32_32x32x16_bf16 a[208:223], a[88:91], a[52:55], a[208:223]
buffer_load_dwordx4 v22, s[12:15], s62 offen nt lds
v_mul_f32 v87, s35, v199
v_mul_f32 v88, s35, v200
v_mul_f32 v89, s35, v201
v_mul_f32 v90, s35, v202
v_mfma_f32_32x32x16_bf16 a[224:239], a[92:95], a[48:51], a[224:239]
v_mul_f32 v91, s35, v203
v_mul_f32 v92, s35, v204
v_mul_f32 v93, s35, v205
v_mul_f32 v94, s35, v206
v_mul_f32 v95, s35, v207
v_cvt_pk_bf16_f32 v80, v80, v81
v_mfma_f32_32x32x16_bf16 a[240:255], a[92:95], a[52:55], a[240:255]
buffer_load_dwordx4 v23, s[12:15], s62 offen offset:1024 nt lds
v_cvt_pk_bf16_f32 v81, v82, v83
v_cvt_pk_bf16_f32 v82, v84, v85
v_cvt_pk_bf16_f32 v83, v86, v87
v_cvt_pk_bf16_f32 v84, v88, v89
v_mfma_f32_32x32x16_bf16 a[128:143], a[112:115], a[56:59], a[128:143]
ds_read_b128 a[80:83], v6
v_cvt_pk_bf16_f32 v85, v90, v91
v_cvt_pk_bf16_f32 v86, v92, v93
v_cvt_pk_bf16_f32 v87, v94, v95
v_accvgpr_write_b32 a32, v80
v_accvgpr_write_b32 a33, v81
v_mfma_f32_32x32x16_bf16 a[144:159], a[112:115], a[60:63], a[144:159]
ds_read_b128 a[84:87], v7
v_accvgpr_write_b32 a34, v82
v_accvgpr_write_b32 a35, v83
v_accvgpr_write_b32 a40, v84
v_accvgpr_write_b32 a41, v85
v_accvgpr_write_b32 a42, v86
v_mfma_f32_32x32x16_bf16 a[160:175], a[116:119], a[56:59], a[160:175]
ds_read_b128 a[88:91], v8
v_accvgpr_write_b32 a43, v87
v_mul_f32 v48, s35, v224
v_mul_f32 v49, s35, v225
v_mul_f32 v50, s35, v226
v_mul_f32 v51, s35, v227
v_mfma_f32_32x32x16_bf16 a[176:191], a[116:119], a[60:63], a[176:191]
ds_read_b128 a[92:95], v9
v_mul_f32 v52, s35, v228
v_mul_f32 v53, s35, v229
v_mul_f32 v54, s35, v230
v_mul_f32 v55, s35, v231
v_mul_f32 v56, s35, v232
v_mfma_f32_32x32x16_bf16 a[192:207], a[120:123], a[56:59], a[192:207]
v_mul_f32 v57, s35, v233
v_mul_f32 v58, s35, v234
v_mul_f32 v59, s35, v235
v_mul_f32 v60, s35, v236
v_mul_f32 v61, s35, v237
v_mul_f32 v62, s35, v238
v_mfma_f32_32x32x16_bf16 a[208:223], a[120:123], a[60:63], a[208:223]
v_mul_f32 v63, s35, v239
v_cvt_pk_bf16_f32 v48, v48, v49
v_cvt_pk_bf16_f32 v49, v50, v51
v_cvt_pk_bf16_f32 v50, v52, v53
v_cvt_pk_bf16_f32 v51, v54, v55
v_cvt_pk_bf16_f32 v52, v56, v57
v_mfma_f32_32x32x16_bf16 a[224:239], a[124:127], a[56:59], a[224:239]
v_cvt_pk_bf16_f32 v53, v58, v59
v_cvt_pk_bf16_f32 v54, v60, v61
v_cvt_pk_bf16_f32 v55, v62, v63
v_accvgpr_write_b32 a48, v48
v_accvgpr_write_b32 a49, v49
v_accvgpr_write_b32 a50, v50
v_mfma_f32_32x32x16_bf16 a[240:255], a[124:127], a[60:63], a[240:255]
v_accvgpr_write_b32 a51, v51
v_accvgpr_write_b32 a56, v52
v_accvgpr_write_b32 a57, v53
v_accvgpr_write_b32 a58, v54
v_accvgpr_write_b32 a59, v55
s_waitcnt vmcnt(16)
s_barrier
s_cmp_lg_u32 s25, 0
s_cbranch_scc1 L1_slow
L1_fast:
s_waitcnt lgkmcnt(0)
v_mfma_f32_32x32x16_bf16 v[48:63], a[64:67], a[0:3], v[96:111]
ds_read_b64_tr_b16 a[96:97], v10 offset:0
ds_read_b64_tr_b16 a[98:99], v10 offset:1024
v_mul_f32 v64, s35, v144
v_mul_f32 v65, s35, v145
v_mul_f32 v66, s35, v146
v_mul_f32 v67, s35, v147
v_mul_f32 v68, s35, v148
v_mul_f32 v69, s35, v149
v_mul_f32 v70, s35, v150
v_mul_f32 v71, s35, v151
v_mul_f32 v72, s35, v152
v_mul_f32 v73, s35, v153
v_mul_f32 v74, s35, v154
v_mul_f32 v75, s35, v155
v_mul_f32 v76, s35, v156
v_mul_f32 v77, s35, v157
v_mfma_f32_32x32x16_bf16 v[48:63], a[68:71], a[8:11], v[48:63]
ds_read_b64_tr_b16 a[100:101], v11 offset:0
ds_read_b64_tr_b16 a[102:103], v11 offset:1024
v_mul_f32 v78, s35, v158
v_mul_f32 v79, s35, v159
v_cvt_pk_bf16_f32 v64, v64, v65
v_cvt_pk_bf16_f32 v65, v66, v67
v_cvt_pk_bf16_f32 v66, v68, v69
v_cvt_pk_bf16_f32 v67, v70, v71
v_cvt_pk_bf16_f32 v68, v72, v73
v_cvt_pk_bf16_f32 v69, v74, v75
v_cvt_pk_bf16_f32 v70, v76, v77
v_cvt_pk_bf16_f32 v71, v78, v79
v_accvgpr_write_b32 a4, v64
v_accvgpr_write_b32 a5, v65
v_accvgpr_write_b32 a6, v66
v_accvgpr_write_b32 a7, v67
v_mfma_f32_32x32x16_bf16 v[48:63], a[72:75], a[16:19], v[48:63]
ds_read_b64_tr_b16 a[104:105], v12 offset:0
ds_read_b64_tr_b16 a[106:107], v12 offset:1024
v_accvgpr_write_b32 a12, v68
v_accvgpr_write_b32 a13, v69
v_accvgpr_write_b32 a14, v70
v_accvgpr_write_b32 a15, v71
v_mul_f32 v64, s35, v176
v_mul_f32 v65, s35, v177
v_mul_f32 v66, s35, v178
v_mul_f32 v67, s35, v179
v_mul_f32 v68, s35, v180
v_mul_f32 v69, s35, v181
v_mul_f32 v70, s35, v182
v_mul_f32 v71, s35, v183
v_mul_f32 v72, s35, v184
v_mul_f32 v73, s35, v185
v_mfma_f32_32x32x16_bf16 v[48:63], a[76:79], a[24:27], v[48:63]
ds_read_b64_tr_b16 a[108:109], v13 offset:0
ds_read_b64_tr_b16 a[110:111], v13 offset:1024
v_mul_f32 v74, s35, v186
v_mul_f32 v75, s35, v187
v_mul_f32 v76, s35, v188
v_mul_f32 v77, s35, v189
v_mul_f32 v78, s35, v190
v_mul_f32 v79, s35, v191
v_cvt_pk_bf16_f32 v64, v64, v65
v_cvt_pk_bf16_f32 v65, v66, v67
v_cvt_pk_bf16_f32 v66, v68, v69
v_cvt_pk_bf16_f32 v67, v70, v71
v_cvt_pk_bf16_f32 v68, v72, v73
v_cvt_pk_bf16_f32 v69, v74, v75
v_cvt_pk_bf16_f32 v70, v76, v77
v_cvt_pk_bf16_f32 v71, v78, v79
v_mfma_f32_32x32x16_bf16 v[48:63], a[80:83], a[32:35], v[48:63]
ds_read_b64_tr_b16 a[112:113], v10 offset:4096
ds_read_b64_tr_b16 a[114:115], v10 offset:5120
v_accvgpr_write_b32 a20, v64
v_accvgpr_write_b32 a21, v65
v_accvgpr_write_b32 a22, v66
v_accvgpr_write_b32 a23, v67
v_accvgpr_write_b32 a28, v68
v_accvgpr_write_b32 a29, v69
v_accvgpr_write_b32 a30, v70
v_accvgpr_write_b32 a31, v71
v_mul_f32 v64, s35, v208
v_mul_f32 v65, s35, v209
v_mul_f32 v66, s35, v210
v_mul_f32 v67, s35, v211
v_mul_f32 v68, s35, v212
v_mul_f32 v69, s35, v213
v_mfma_f32_32x32x16_bf16 v[48:63], a[84:87], a[40:43], v[48:63]
ds_read_b64_tr_b16 a[116:117], v11 offset:4096
ds_read_b64_tr_b16 a[118:119], v11 offset:5120
v_mul_f32 v70, s35, v214
v_mul_f32 v71, s35, v215
v_mul_f32 v72, s35, v216
v_mul_f32 v73, s35, v217
v_mul_f32 v74, s35, v218
v_mul_f32 v75, s35, v219
v_mul_f32 v76, s35, v220
v_mul_f32 v77, s35, v221
v_mul_f32 v78, s35, v222
v_mul_f32 v79, s35, v223
v_cvt_pk_bf16_f32 v64, v64, v65
v_cvt_pk_bf16_f32 v65, v66, v67
v_cvt_pk_bf16_f32 v66, v68, v69
v_cvt_pk_bf16_f32 v67, v70, v71
v_mfma_f32_32x32x16_bf16 v[48:63], a[88:91], a[48:51], v[48:63]
ds_read_b64_tr_b16 a[120:121], v12 offset:4096
ds_read_b64_tr_b16 a[122:123], v12 offset:5120
v_cvt_pk_bf16_f32 v68, v72, v73
v_cvt_pk_bf16_f32 v69, v74, v75
v_cvt_pk_bf16_f32 v70, v76, v77
v_cvt_pk_bf16_f32 v71, v78, v79
v_accvgpr_write_b32 a36, v64
v_accvgpr_write_b32 a37, v65
v_accvgpr_write_b32 a38, v66
v_accvgpr_write_b32 a39, v67
v_accvgpr_write_b32 a44, v68
v_accvgpr_write_b32 a45, v69
v_accvgpr_write_b32 a46, v70
v_accvgpr_write_b32 a47, v71
v_mul_f32 v64, s35, v240
v_mul_f32 v65, s35, v241
v_mfma_f32_32x32x16_bf16 v[48:63], a[92:95], a[56:59], v[48:63]
ds_read_b64_tr_b16 a[124:125], v13 offset:4096
ds_read_b64_tr_b16 a[126:127], v13 offset:5120
v_mul_f32 v66, s35, v242
v_mul_f32 v67, s35, v243
v_mul_f32 v68, s35, v244
v_mul_f32 v69, s35, v245
v_mul_f32 v70, s35, v246
v_mul_f32 v71, s35, v247
v_mul_f32 v72, s35, v248
v_mul_f32 v73, s35, v249
v_mul_f32 v74, s35, v250
v_mul_f32 v75, s35, v251
v_mul_f32 v76, s35, v252
v_mul_f32 v77, s35, v253
v_mul_f32 v78, s35, v254
v_mul_f32 v79, s35, v255
v_cvt_pk_bf16_f32 v64, v64, v65
v_cvt_pk_bf16_f32 v65, v66, v67
v_cvt_pk_bf16_f32 v66, v68, v69
v_cvt_pk_bf16_f32 v67, v70, v71
v_cvt_pk_bf16_f32 v68, v72, v73
v_cvt_pk_bf16_f32 v69, v74, v75
v_cvt_pk_bf16_f32 v70, v76, v77
v_cvt_pk_bf16_f32 v71, v78, v79
v_accvgpr_write_b32 a52, v64
v_accvgpr_write_b32 a53, v65
v_accvgpr_write_b32 a54, v66
v_accvgpr_write_b32 a55, v67
v_accvgpr_write_b32 a60, v68
v_accvgpr_write_b32 a61, v69
v_accvgpr_write_b32 a62, v70
v_accvgpr_write_b32 a63, v71
s_lshr_b32 s94, s2, 5
s_xor_b32 s94, s94, s2
s_and_b32 s94, s94, 1
s_mul_i32 s94, s94, 33
s_xor_b32 s63, s2, s94
s_getpc_b64 s[94:95]
Lpc_p0:
s_add_u32 s94, s94, L1_oepi0-Lpc_p0
s_addc_u32 s95, s95, 0
s_bfe_u32 s63, s63, 0x40003
s_lshl_b32 s63, s63, 2
s_add_u32 s63, s63, s24
s_mul_i32 s63, s63, 4
v_and_b32 v47, 63, v0
v_add_u32 v47, s63, v47
v_lshlrev_b32 v47, 7, v47
s_mov_b32 s63, L1_pf1-L1_oepi0-4
v_min_u32 v47, s63, v47
s_mov_b64 exec, 15
global_load_dword v47, v47, s[94:95]
s_mov_b64 exec, -1
s_waitcnt vmcnt(17)
s_barrier
v_mfma_f32_32x32x16_bf16 v[64:79], a[64:67], a[4:7], v[112:127]
ds_read_b128 a[64:67], v2 offset:8192
v_mfma_f32_32x32x16_bf16 v[64:79], a[68:71], a[12:15], v[64:79]
ds_read_b128 a[68:71], v3 offset:8192
v_mfma_f32_32x32x16_bf16 v[64:79], a[72:75], a[20:23], v[64:79]
ds_read_b128 a[72:75], v4 offset:8192
v_exp_f32 v48, v48
v_exp_f32 v49, v49
v_mov_b32 v34, v48
v_mfma_f32_32x32x16_bf16 v[64:79], a[76:79], a[28:31], v[64:79]
ds_read_b128 a[76:79], v5 offset:8192
v_exp_f32 v50, v50
v_add_f32 v34, v34, v49
v_cvt_pk_bf16_f32 v80, v48, v49
v_exp_f32 v51, v51
v_add_f32 v34, v34, v50
v_exp_f32 v52, v52
v_add_f32 v34, v34, v51
v_cvt_pk_bf16_f32 v81, v50, v51
v_mfma_f32_32x32x16_bf16 v[64:79], a[80:83], a[36:39], v[64:79]
ds_read_b128 a[80:83], v6 offset:8192
v_exp_f32 v53, v53
v_add_f32 v34, v34, v52
v_exp_f32 v54, v54
v_add_f32 v34, v34, v53
v_cvt_pk_bf16_f32 v82, v52, v53
v_mfma_f32_32x32x16_bf16 v[64:79], a[84:87], a[44:47], v[64:79]
ds_read_b128 a[84:87], v7 offset:8192
v_exp_f32 v55, v55
v_add_f32 v34, v34, v54
v_exp_f32 v56, v56
v_add_f32 v34, v34, v55
v_cvt_pk_bf16_f32 v83, v54, v55
v_exp_f32 v57, v57
v_add_f32 v34, v34, v56
v_mfma_f32_32x32x16_bf16 v[64:79], a[88:91], a[52:55], v[64:79]
ds_read_b128 a[88:91], v8 offset:8192
v_exp_f32 v58, v58
v_add_f32 v34, v34, v57
v_cvt_pk_bf16_f32 v84, v56, v57
v_exp_f32 v59, v59
v_add_f32 v34, v34, v58
v_mfma_f32_32x32x16_bf16 v[64:79], a[92:95], a[60:63], v[64:79]
ds_read_b128 a[92:95], v9 offset:8192
v_exp_f32 v60, v60
v_add_f32 v34, v34, v59
v_cvt_pk_bf16_f32 v85, v58, v59
v_exp_f32 v61, v61
v_add_f32 v34, v34, v60
s_waitcnt lgkmcnt(8)
v_mfma_f32_32x32x16_bf16 v[128:143], a[96:99], v[80:83], 0
v_exp_f32 v62, v62
v_add_f32 v34, v34, v61
v_cvt_pk_bf16_f32 v86, v60, v61
s_lshr_b32 s3, s2, 3
s_and_b32 s62, s3, 3
v_mfma_f32_32x32x16_bf16 v[160:175], a[100:103], v[80:83], 0
v_exp_f32 v63, v63
v_add_f32 v34, v34, v62
s_add_u32 m0, s27, 0
s_and_b32 s63, s2, 1
s_lshl_b32 s63, s63, 2
v_mfma_f32_32x32x16_bf16 v[192:207], a[104:107], v[80:83], 0
v_exp_f32 v64, v64
v_add_f32 v34, v34, v63
v_cvt_pk_bf16_f32 v87, v62, v63
s_add_u32 s62, s62, s63
s_bfe_u32 s63, s2, 0x10002
v_mfma_f32_32x32x16_bf16 v[224:239], a[108:111], v[80:83], 0
buffer_load_dwordx4 v22, s[12:15], s58 offen nt lds
v_exp_f32 v65, v65
v_mov_b32 v35, v64
s_lshl_b32 s63, s63, 3
v_mfma_f32_32x32x16_bf16 v[128:143], a[112:115], v[84:87], v[128:143]
v_exp_f32 v66, v66
v_add_f32 v35, v35, v65
v_cvt_pk_bf16_f32 v88, v64, v65
s_add_u32 s62, s62, s63
s_and_b32 s63, s78, 1
v_mfma_f32_32x32x16_bf16 v[160:175], a[116:119], v[84:87], v[160:175]
buffer_load_dwordx4 v23, s[12:15], s58 offen offset:1024 nt lds
v_exp_f32 v67, v67
v_add_f32 v35, v35, v66
s_bfe_u32 s64, s78, 0x20001
v_mfma_f32_32x32x16_bf16 v[192:207], a[120:123], v[84:87], v[192:207]
v_exp_f32 v68, v68
v_add_f32 v35, v35, v67
v_cvt_pk_bf16_f32 v89, v66, v67
s_add_u32 s58, s58, 8192
s_lshr_b32 s65, s78, 3
v_mfma_f32_32x32x16_bf16 v[224:239], a[124:127], v[84:87], v[224:239]
v_exp_f32 v69, v69
v_add_f32 v35, v35, v68
s_add_u32 m0, s30, 40960
s_lshl_b32 s94, s24, 1
s_add_u32 s94, s94, s63
s_waitcnt lgkmcnt(0)
v_mfma_f32_32x32x16_bf16 v[48:63], a[64:67], a[0:3], v[96:111]
v_exp_f32 v70, v70
v_add_f32 v35, v35, v69
v_cvt_pk_bf16_f32 v90, v68, v69
s_lshl_b32 s94, s94, 13
s_lshl_b32 s95, s62, 21
v_mfma_f32_32x32x16_bf16 v[48:63], a[68:71], a[8:11], v[48:63]
buffer_load_dwordx4 v24, s[16:19], s59 offen nt lds
v_exp_f32 v71, v71
v_add_f32 v35, v35, v70
s_add_u32 s95, s95, s94
v_mfma_f32_32x32x16_bf16 v[48:63], a[72:75], a[16:19], v[48:63]
v_exp_f32 v72, v72
v_add_f32 v35, v35, v71
v_cvt_pk_bf16_f32 v91, v70, v71
s_add_u32 s4, s56, s95
s_addc_u32 s5, s57, 0
v_mfma_f32_32x32x16_bf16 v[48:63], a[76:79], a[24:27], v[48:63]
buffer_load_dwordx4 v24, s[16:19], s59 offen offset:1024 nt lds
v_exp_f32 v73, v73
v_add_f32 v35, v35, v72
s_sub_u32 s6, 0x200000, s94
v_mfma_f32_32x32x16_bf16 v[48:63], a[80:83], a[32:35], v[48:63]
v_exp_f32 v74, v74
v_add_f32 v35, v35, v73
v_cvt_pk_bf16_f32 v92, v72, v73
s_add_u32 s59, s59, 8192
s_mov_b32 s7, 0x20000
v_mfma_f32_32x32x16_bf16 v[48:63], a[84:87], a[40:43], v[48:63]
v_exp_f32 v75, v75
v_add_f32 v35, v35, v74
s_lshl_b32 s95, s65, 20
s_and_b32 s94, s78, 7
s_lshl_b32 s94, s94, 17
v_mfma_f32_32x32x16_bf16 v[48:63], a[88:91], a[48:51], v[48:63]
v_exp_f32 v76, v76
v_add_f32 v35, v35, v75
v_cvt_pk_bf16_f32 v93, v74, v75
s_add_u32 s54, s94, s95
s_lshl_b32 s94, s63, 17
v_mfma_f32_32x32x16_bf16 v[48:63], a[92:95], a[56:59], v[48:63]
v_exp_f32 v77, v77
v_add_f32 v35, v35, v76
s_add_u32 s95, s95, s94
s_cmp_le_u32 s64, 0
s_addc_u32 s47, 0, 0
v_mfma_f32_32x32x16_bf16 v[144:159], a[96:99], v[88:91], 0
ds_read_b64_tr_b16 a[96:97], v10 offset:8192
ds_read_b64_tr_b16 a[98:99], v10 offset:9216
v_exp_f32 v78, v78
v_add_f32 v35, v35, v77
v_cvt_pk_bf16_f32 v94, v76, v77
v_mfma_f32_32x32x16_bf16 v[176:191], a[100:103], v[88:91], 0
ds_read_b64_tr_b16 a[100:101], v11 offset:8192
ds_read_b64_tr_b16 a[102:103], v11 offset:9216
v_exp_f32 v79, v79
v_add_f32 v35, v35, v78
s_lshl_b32 s47, s47, 18
v_mfma_f32_32x32x16_bf16 v[208:223], a[104:107], v[88:91], 0
ds_read_b64_tr_b16 a[104:105], v12 offset:8192
ds_read_b64_tr_b16 a[106:107], v12 offset:9216
v_exp_f32 v48, v48
v_add_f32 v35, v35, v79
v_cvt_pk_bf16_f32 v95, v78, v79
v_mfma_f32_32x32x16_bf16 v[240:255], a[108:111], v[88:91], 0
ds_read_b64_tr_b16 a[108:109], v13 offset:8192
ds_read_b64_tr_b16 a[110:111], v13 offset:9216
v_exp_f32 v49, v49
v_add_f32 v34, v34, v48
s_add_u32 s47, s47, s95
v_mfma_f32_32x32x16_bf16 v[144:159], a[112:115], v[92:95], v[144:159]
ds_read_b64_tr_b16 a[112:113], v10 offset:12288
ds_read_b64_tr_b16 a[114:115], v10 offset:13312
v_exp_f32 v50, v50
v_add_f32 v34, v34, v49
v_cvt_pk_bf16_f32 v80, v48, v49
v_mfma_f32_32x32x16_bf16 v[176:191], a[116:119], v[92:95], v[176:191]
ds_read_b64_tr_b16 a[116:117], v11 offset:12288
ds_read_b64_tr_b16 a[118:119], v11 offset:13312
v_exp_f32 v51, v51
v_add_f32 v34, v34, v50
s_cmp_le_u32 s64, 1
s_addc_u32 s48, 1, 0
v_mfma_f32_32x32x16_bf16 v[208:223], a[120:123], v[92:95], v[208:223]
ds_read_b64_tr_b16 a[120:121], v12 offset:12288
ds_read_b64_tr_b16 a[122:123], v12 offset:13312
v_exp_f32 v52, v52
v_add_f32 v34, v34, v51
v_cvt_pk_bf16_f32 v81, v50, v51
v_mfma_f32_32x32x16_bf16 v[240:255], a[124:127], v[92:95], v[240:255]
ds_read_b64_tr_b16 a[124:125], v13 offset:12288
ds_read_b64_tr_b16 a[126:127], v13 offset:13312
v_exp_f32 v53, v53
v_add_f32 v34, v34, v52
s_lshl_b32 s48, s48, 18
s_waitcnt vmcnt(21)
s_barrier
v_mfma_f32_32x32x16_bf16 v[64:79], a[64:67], a[4:7], v[112:127]
ds_read_b128 a[64:67], v2 offset:16384
v_exp_f32 v54, v54
v_add_f32 v34, v34, v53
v_cvt_pk_bf16_f32 v82, v52, v53
s_add_u32 s48, s48, s95
v_mfma_f32_32x32x16_bf16 v[64:79], a[68:71], a[12:15], v[64:79]
ds_read_b128 a[68:71], v3 offset:16384
v_exp_f32 v55, v55
v_add_f32 v34, v34, v54
s_cmp_le_u32 s64, 2
s_addc_u32 s49, 2, 0
v_mfma_f32_32x32x16_bf16 v[64:79], a[72:75], a[20:23], v[64:79]
ds_read_b128 a[72:75], v4 offset:16384
v_exp_f32 v56, v56
v_add_f32 v34, v34, v55
v_cvt_pk_bf16_f32 v83, v54, v55
s_lshl_b32 s49, s49, 18
v_mfma_f32_32x32x16_bf16 v[64:79], a[76:79], a[28:31], v[64:79]
ds_read_b128 a[76:79], v5 offset:16384
v_exp_f32 v57, v57
v_add_f32 v34, v34, v56
s_add_u32 s49, s49, s95
s_xor_b32 s95, s95, 0x20000
v_mfma_f32_32x32x16_bf16 v[64:79], a[80:83], a[36:39], v[64:79]
ds_read_b128 a[80:83], v6 offset:16384
v_exp_f32 v58, v58
v_add_f32 v34, v34, v57
v_cvt_pk_bf16_f32 v84, v56, v57
s_add_u32 s50, s95, 0
v_mfma_f32_32x32x16_bf16 v[64:79], a[84:87], a[44:47], v[64:79]
ds_read_b128 a[84:87], v7 offset:16384
v_exp_f32 v59, v59
v_add_f32 v34, v34, v58
s_add_u32 s51, s95, 262144
s_add_u32 s52, s95, 524288
v_mfma_f32_32x32x16_bf16 v[64:79], a[88:91], a[52:55], v[64:79]
ds_read_b128 a[88:91], v8 offset:16384
v_exp_f32 v60, v60
v_add_f32 v34, v34, v59
v_cvt_pk_bf16_f32 v85, v58, v59
s_add_u32 s53, s95, 786432
v_mfma_f32_32x32x16_bf16 v[64:79], a[92:95], a[60:63], v[64:79]
ds_read_b128 a[92:95], v9 offset:16384
v_exp_f32 v61, v61
v_add_f32 v34, v34, v60
s_lshl_b32 s94, s64, 8
s_lshl_b32 s95, s65, 7
s_waitcnt lgkmcnt(8)
v_mfma_f32_32x32x16_bf16 v[128:143], a[96:99], v[80:83], v[128:143]
v_exp_f32 v62, v62
v_add_f32 v34, v34, v61
v_cvt_pk_bf16_f32 v86, v60, v61
s_add_u32 s37, s94, s95
s_xor_b32 s36, s37, 128
v_mfma_f32_32x32x16_bf16 v[160:175], a[100:103], v[80:83], v[160:175]
v_exp_f32 v63, v63
v_add_f32 v34, v34, v62
s_add_u32 m0, s27, 8192
s_add_u32 s38, s36, 131072
s_add_u32 s39, s37, 131072
v_mfma_f32_32x32x16_bf16 v[192:207], a[104:107], v[80:83], v[192:207]
v_exp_f32 v64, v64
v_add_f32 v34, v34, v63
v_cvt_pk_bf16_f32 v87, v62, v63
s_lshl_b32 s95, s65, 21
s_lshl_b32 s82, s2, 15
v_mfma_f32_32x32x16_bf16 v[224:239], a[108:111], v[80:83], v[224:239]
buffer_load_dwordx4 v22, s[12:15], s58 offen nt lds
v_exp_f32 v65, v65
v_add_f32 v35, v35, v64
s_lshl_b32 s94, s24, 13
v_mfma_f32_32x32x16_bf16 v[128:143], a[112:115], v[84:87], v[128:143]
v_exp_f32 v66, v66
v_add_f32 v35, v35, v65
v_cvt_pk_bf16_f32 v88, v64, v65
s_add_u32 s82, s82, s94
s_xor_b32 s32, s82, 65536
v_mfma_f32_32x32x16_bf16 v[160:175], a[116:119], v[84:87], v[160:175]
buffer_load_dwordx4 v23, s[12:15], s58 offen offset:1024 nt lds
v_exp_f32 v67, v67
v_add_f32 v35, v35, v66
s_lshl_b32 s94, s3, 2
v_mfma_f32_32x32x16_bf16 v[192:207], a[120:123], v[84:87], v[192:207]
v_exp_f32 v68, v68
v_add_f32 v35, v35, v67
v_cvt_pk_bf16_f32 v89, v66, v67
s_add_u32 s58, s58, 8192
s_add_u32 s94, s94, s24
v_mfma_f32_32x32x16_bf16 v[224:239], a[124:127], v[84:87], v[224:239]
v_exp_f32 v69, v69
v_add_f32 v35, v35, v68
s_add_u32 m0, s30, 0
s_lshl_b32 s94, s94, 14
s_add_u32 s76, s94, s95
s_waitcnt lgkmcnt(0)
v_mfma_f32_32x32x16_bf16 v[48:63], a[64:67], a[0:3], v[96:111]
v_exp_f32 v70, v70
v_add_f32 v35, v35, v69
v_cvt_pk_bf16_f32 v90, v68, v69
v_and_b32 v36, 63, v0
v_lshrrev_b32 v37, 3, v36
v_mfma_f32_32x32x16_bf16 v[48:63], a[68:71], a[8:11], v[48:63]
buffer_load_dwordx4 v24, s[16:19], s59 offen nt lds
v_exp_f32 v71, v71
v_add_f32 v35, v35, v70
v_bfe_u32 v38, v36, 4, 1
v_mfma_f32_32x32x16_bf16 v[48:63], a[72:75], a[16:19], v[48:63]
v_exp_f32 v72, v72
v_add_f32 v35, v35, v71
v_cvt_pk_bf16_f32 v91, v70, v71
v_lshlrev_b32 v38, 2, v38
v_and_b32 v39, 7, v36
v_mfma_f32_32x32x16_bf16 v[48:63], a[76:79], a[24:27], v[48:63]
buffer_load_dwordx4 v24, s[16:19], s59 offen offset:1024 nt lds
v_exp_f32 v73, v73
v_add_f32 v35, v35, v72
v_xor_b32 v38, v38, v39
v_mfma_f32_32x32x16_bf16 v[48:63], a[80:83], a[32:35], v[48:63]
v_exp_f32 v74, v74
v_add_f32 v35, v35, v73
v_cvt_pk_bf16_f32 v92, v72, v73
s_add_u32 s59, s59, 8192
v_lshlrev_b32 v38, 4, v38
v_mfma_f32_32x32x16_bf16 v[48:63], a[84:87], a[40:43], v[48:63]
v_exp_f32 v75, v75
v_add_f32 v35, v35, v74
v_lshl_add_u32 v37, v37, 10, v38
s_lshl_b32 s94, s24, 15
v_add_u32 v25, s94, v37
v_mfma_f32_32x32x16_bf16 v[48:63], a[88:91], a[48:51], v[48:63]
v_exp_f32 v76, v76
v_add_f32 v35, v35, v75
v_cvt_pk_bf16_f32 v93, v74, v75
v_add_u32 v26, 7168, v25
v_add_u32 v27, 14336, v25
v_mfma_f32_32x32x16_bf16 v[48:63], a[92:95], a[56:59], v[48:63]
v_exp_f32 v77, v77
v_add_f32 v35, v35, v76
v_add_u32 v28, 21504, v25
v_lshrrev_b32 v37, 5, v36
v_bfe_u32 v38, v36, 2, 2
v_mfma_f32_32x32x16_bf16 v[144:159], a[96:99], v[88:91], v[144:159]
ds_read_b64_tr_b16 a[96:97], v10 offset:16384
ds_read_b64_tr_b16 a[98:99], v10 offset:17408
v_exp_f32 v78, v78
v_add_f32 v35, v35, v77
v_cvt_pk_bf16_f32 v94, v76, v77
v_mfma_f32_32x32x16_bf16 v[176:191], a[100:103], v[88:91], v[176:191]
ds_read_b64_tr_b16 a[100:101], v11 offset:16384
ds_read_b64_tr_b16 a[102:103], v11 offset:17408
v_exp_f32 v79, v79
v_add_f32 v35, v35, v78
v_lshl_add_u32 v37, v37, 3, v38
v_mfma_f32_32x32x16_bf16 v[208:223], a[104:107], v[88:91], v[208:223]
ds_read_b64_tr_b16 a[104:105], v12 offset:16384
ds_read_b64_tr_b16 a[106:107], v12 offset:17408
v_exp_f32 v48, v48
v_add_f32 v35, v35, v79
v_cvt_pk_bf16_f32 v95, v78, v79
v_mfma_f32_32x32x16_bf16 v[240:255], a[108:111], v[88:91], v[240:255]
ds_read_b64_tr_b16 a[108:109], v13 offset:16384
ds_read_b64_tr_b16 a[110:111], v13 offset:17408
v_exp_f32 v49, v49
v_add_f32 v34, v34, v48
v_lshlrev_b32 v37, 7, v37
v_mfma_f32_32x32x16_bf16 v[144:159], a[112:115], v[92:95], v[144:159]
ds_read_b64_tr_b16 a[112:113], v10 offset:20480
ds_read_b64_tr_b16 a[114:115], v10 offset:21504
v_exp_f32 v50, v50
v_add_f32 v34, v34, v49
v_cvt_pk_bf16_f32 v80, v48, v49
v_mfma_f32_32x32x16_bf16 v[176:191], a[116:119], v[92:95], v[176:191]
ds_read_b64_tr_b16 a[116:117], v11 offset:20480
ds_read_b64_tr_b16 a[118:119], v11 offset:21504
v_exp_f32 v51, v51
v_add_f32 v34, v34, v50
v_and_b32 v38, 2, v38
v_mfma_f32_32x32x16_bf16 v[208:223], a[120:123], v[92:95], v[208:223]
ds_read_b64_tr_b16 a[120:121], v12 offset:20480
ds_read_b64_tr_b16 a[122:123], v12 offset:21504
v_exp_f32 v52, v52
v_add_f32 v34, v34, v51
v_cvt_pk_bf16_f32 v81, v50, v51
v_mfma_f32_32x32x16_bf16 v[240:255], a[124:127], v[92:95], v[240:255]
ds_read_b64_tr_b16 a[124:125], v13 offset:20480
ds_read_b64_tr_b16 a[126:127], v13 offset:21504
v_exp_f32 v53, v53
v_add_f32 v34, v34, v52
v_lshl_or_b32 v37, v38, 5, v37
s_waitcnt vmcnt(25)
s_barrier
v_mfma_f32_32x32x16_bf16 v[64:79], a[64:67], a[4:7], v[112:127]
ds_read_b128 a[64:67], v2 offset:24576
v_exp_f32 v54, v54
v_add_f32 v34, v34, v53
v_cvt_pk_bf16_f32 v82, v52, v53
v_bfe_u32 v38, v36, 4, 1
v_mfma_f32_32x32x16_bf16 v[64:79], a[68:71], a[12:15], v[64:79]
ds_read_b128 a[68:71], v3 offset:24576
v_exp_f32 v55, v55
v_add_f32 v34, v34, v54
v_lshlrev_b32 v38, 5, v38
v_add_u32 v37, v37, v38
v_mfma_f32_32x32x16_bf16 v[64:79], a[72:75], a[20:23], v[64:79]
ds_read_b128 a[72:75], v4 offset:24576
v_exp_f32 v56, v56
v_add_f32 v34, v34, v55
v_cvt_pk_bf16_f32 v83, v54, v55
v_and_b32 v38, 1, v36
v_mfma_f32_32x32x16_bf16 v[64:79], a[76:79], a[28:31], v[64:79]
ds_read_b128 a[76:79], v5 offset:24576
v_exp_f32 v57, v57
v_add_f32 v34, v34, v56
v_lshl_or_b32 v37, v38, 4, v37
v_bfe_u32 v38, v36, 1, 1
v_mfma_f32_32x32x16_bf16 v[64:79], a[80:83], a[36:39], v[64:79]
ds_read_b128 a[80:83], v6 offset:24576
v_exp_f32 v58, v58
v_add_f32 v34, v34, v57
v_cvt_pk_bf16_f32 v84, v56, v57
v_lshl_or_b32 v18, v38, 3, v37
v_mfma_f32_32x32x16_bf16 v[64:79], a[84:87], a[44:47], v[64:79]
ds_read_b128 a[84:87], v7 offset:24576
v_exp_f32 v59, v59
v_add_f32 v34, v34, v58
v_xor_b32 v19, 64, v18
v_add_u32 v20, 0x10000, v18
v_mfma_f32_32x32x16_bf16 v[64:79], a[88:91], a[52:55], v[64:79]
ds_read_b128 a[88:91], v8 offset:24576
v_exp_f32 v60, v60
v_add_f32 v34, v34, v59
v_cvt_pk_bf16_f32 v85, v58, v59
v_add_u32 v29, 0x20000, v18
v_mfma_f32_32x32x16_bf16 v[64:79], a[92:95], a[60:63], v[64:79]
ds_read_b128 a[92:95], v9 offset:24576
v_exp_f32 v61, v61
v_add_f32 v34, v34, v60
v_add_u32 v21, 0x10000, v19
v_add_u32 v30, 0x20000, v19
s_waitcnt lgkmcnt(8)
v_mfma_f32_32x32x16_bf16 v[128:143], a[96:99], v[80:83], v[128:143]
v_exp_f32 v62, v62
v_add_f32 v34, v34, v61
v_cvt_pk_bf16_f32 v86, v60, v61
v_lshlrev_b32 v31, 7, v36
s_cmp_eq_u32 s24, 3
s_cselect_b32 s94, 0x40000000, 0
v_mfma_f32_32x32x16_bf16 v[160:175], a[100:103], v[80:83], v[160:175]
v_exp_f32 v63, v63
v_add_f32 v34, v34, v62
s_add_u32 m0, s27, 16384
s_cmp_lg_u32 s46, 0
s_cselect_b32 s95, s94, 0
s_cselect_b32 s94, 0, s94
v_mfma_f32_32x32x16_bf16 v[192:207], a[104:107], v[80:83], v[192:207]
v_exp_f32 v64, v64
v_add_f32 v34, v34, v63
v_cvt_pk_bf16_f32 v87, v62, v63
v_bfe_u32 v37, v36, 4, 1
v_lshlrev_b32 v37, 30, v37
v_mfma_f32_32x32x16_bf16 v[224:239], a[108:111], v[80:83], v[224:239]
buffer_load_dwordx4 v22, s[12:15], s58 offen nt lds
v_exp_f32 v65, v65
v_add_f32 v35, v35, v64
v_and_b32 v38, s94, v37
v_mfma_f32_32x32x16_bf16 v[128:143], a[112:115], v[84:87], v[128:143]
v_exp_f32 v66, v66
v_add_f32 v35, v35, v65
v_cvt_pk_bf16_f32 v88, v64, v65
v_or_b32 v32, v38, v33
v_and_b32 v38, s95, v37
v_mfma_f32_32x32x16_bf16 v[160:175], a[116:119], v[84:87], v[160:175]
buffer_load_dwordx4 v23, s[12:15], s58 offen offset:1024 nt lds
v_exp_f32 v67, v67
v_add_f32 v35, v35, v66
v_or_b32 v33, v38, v33
v_mfma_f32_32x32x16_bf16 v[192:207], a[120:123], v[84:87], v[192:207]
v_exp_f32 v68, v68
v_add_f32 v35, v35, v67
v_cvt_pk_bf16_f32 v89, v66, v67
s_add_u32 s58, s58, 8192
s_lshl_b32 s66, s24, 14
v_mfma_f32_32x32x16_bf16 v[224:239], a[124:127], v[84:87], v[224:239]
v_exp_f32 v69, v69
v_add_f32 v35, v35, v68
s_add_u32 m0, s30, 8192
s_lshl_b32 s62, s78, 17
s_add_u32 s66, s66, s62
s_waitcnt lgkmcnt(0)
v_mfma_f32_32x32x16_bf16 v[48:63], a[64:67], a[0:3], v[96:111]
v_exp_f32 v70, v70
v_add_f32 v35, v35, v69
v_cvt_pk_bf16_f32 v90, v68, v69
s_lshr_b32 s62, s46, 2
s_add_u32 s66, s66, s62
v_mfma_f32_32x32x16_bf16 v[48:63], a[68:71], a[8:11], v[48:63]
buffer_load_dwordx4 v24, s[16:19], s59 offen nt lds
v_exp_f32 v71, v71
v_add_f32 v35, v35, v70
s_add_u32 s67, s66, 4096
v_mfma_f32_32x32x16_bf16 v[48:63], a[72:75], a[16:19], v[48:63]
v_exp_f32 v72, v72
v_add_f32 v35, v35, v71
v_cvt_pk_bf16_f32 v91, v70, v71
s_xor_b32 s68, s66, 8192
s_add_u32 s69, s68, 4096
v_mfma_f32_32x32x16_bf16 v[48:63], a[76:79], a[24:27], v[48:63]
buffer_load_dwordx4 v24, s[16:19], s59 offen offset:1024 nt lds
v_exp_f32 v73, v73
v_add_f32 v35, v35, v72
v_accvgpr_read_b32 v14, a128
v_mfma_f32_32x32x16_bf16 v[48:63], a[80:83], a[32:35], v[48:63]
v_exp_f32 v74, v74
v_add_f32 v35, v35, v73
v_cvt_pk_bf16_f32 v92, v72, v73
s_add_u32 s59, s59, 8192
v_accvgpr_read_b32 v15, a129
v_mfma_f32_32x32x16_bf16 v[48:63], a[84:87], a[40:43], v[48:63]
v_exp_f32 v75, v75
v_add_f32 v35, v35, v74
v_accvgpr_read_b32 v16, a130
v_accvgpr_read_b32 v17, a131
v_mul_f32 v14, s35, v14
v_mfma_f32_32x32x16_bf16 v[48:63], a[88:91], a[48:51], v[48:63]
v_exp_f32 v76, v76
v_add_f32 v35, v35, v75
v_cvt_pk_bf16_f32 v93, v74, v75
v_mul_f32 v15, s35, v15
v_mul_f32 v16, s35, v16
v_mfma_f32_32x32x16_bf16 v[48:63], a[92:95], a[56:59], v[48:63]
v_exp_f32 v77, v77
v_add_f32 v35, v35, v76
v_mul_f32 v17, s35, v17
v_cvt_pk_bf16_f32 v14, v14, v15
v_cvt_pk_bf16_f32 v16, v16, v17
v_mfma_f32_32x32x16_bf16 v[144:159], a[96:99], v[88:91], v[144:159]
ds_read_b64_tr_b16 a[96:97], v10 offset:24576
ds_read_b64_tr_b16 a[98:99], v10 offset:25600
v_exp_f32 v78, v78
v_add_f32 v35, v35, v77
v_cvt_pk_bf16_f32 v94, v76, v77
v_mfma_f32_32x32x16_bf16 v[176:191], a[100:103], v[88:91], v[176:191]
ds_read_b64_tr_b16 a[100:101], v11 offset:24576
ds_read_b64_tr_b16 a[102:103], v11 offset:25600
v_exp_f32 v79, v79
v_add_f32 v35, v35, v78
v_accvgpr_write_b32 a128, v14
v_mfma_f32_32x32x16_bf16 v[208:223], a[104:107], v[88:91], v[208:223]
ds_read_b64_tr_b16 a[104:105], v12 offset:24576
ds_read_b64_tr_b16 a[106:107], v12 offset:25600
v_exp_f32 v48, v48
v_add_f32 v35, v35, v79
v_cvt_pk_bf16_f32 v95, v78, v79
v_mfma_f32_32x32x16_bf16 v[240:255], a[108:111], v[88:91], v[240:255]
ds_read_b64_tr_b16 a[108:109], v13 offset:24576
ds_read_b64_tr_b16 a[110:111], v13 offset:25600
v_exp_f32 v49, v49
v_add_f32 v34, v34, v48
v_accvgpr_write_b32 a129, v16
v_mfma_f32_32x32x16_bf16 v[144:159], a[112:115], v[92:95], v[144:159]
ds_read_b64_tr_b16 a[112:113], v10 offset:28672
ds_read_b64_tr_b16 a[114:115], v10 offset:29696
v_exp_f32 v50, v50
v_add_f32 v34, v34, v49
v_cvt_pk_bf16_f32 v80, v48, v49
v_mfma_f32_32x32x16_bf16 v[176:191], a[116:119], v[92:95], v[176:191]
ds_read_b64_tr_b16 a[116:117], v11 offset:28672
ds_read_b64_tr_b16 a[118:119], v11 offset:29696
v_exp_f32 v51, v51
v_add_f32 v34, v34, v50
v_accvgpr_read_b32 v14, a132
v_mfma_f32_32x32x16_bf16 v[208:223], a[120:123], v[92:95], v[208:223]
ds_read_b64_tr_b16 a[120:121], v12 offset:28672
ds_read_b64_tr_b16 a[122:123], v12 offset:29696
v_exp_f32 v52, v52
v_add_f32 v34, v34, v51
v_cvt_pk_bf16_f32 v81, v50, v51
v_mfma_f32_32x32x16_bf16 v[240:255], a[124:127], v[92:95], v[240:255]
ds_read_b64_tr_b16 a[124:125], v13 offset:28672
ds_read_b64_tr_b16 a[126:127], v13 offset:29696
v_exp_f32 v53, v53
v_add_f32 v34, v34, v52
v_accvgpr_read_b32 v15, a133
s_waitcnt vmcnt(19)
s_barrier
v_mfma_f32_32x32x16_bf16 v[64:79], a[64:67], a[4:7], v[112:127]
ds_read_b128 a[64:67], v2 offset:49152
v_exp_f32 v54, v54
v_add_f32 v34, v34, v53
v_cvt_pk_bf16_f32 v82, v52, v53
v_accvgpr_read_b32 v16, a134
v_mfma_f32_32x32x16_bf16 v[64:79], a[68:71], a[12:15], v[64:79]
ds_read_b128 a[68:71], v3 offset:49152
v_exp_f32 v55, v55
v_add_f32 v34, v34, v54
v_accvgpr_read_b32 v17, a135
v_mul_f32 v14, s35, v14
v_mfma_f32_32x32x16_bf16 v[64:79], a[72:75], a[20:23], v[64:79]
ds_read_b128 a[72:75], v4 offset:49152
v_exp_f32 v56, v56
v_add_f32 v34, v34, v55
v_cvt_pk_bf16_f32 v83, v54, v55
v_mul_f32 v15, s35, v15
v_mfma_f32_32x32x16_bf16 v[64:79], a[76:79], a[28:31], v[64:79]
ds_read_b128 a[76:79], v5 offset:49152
v_exp_f32 v57, v57
v_add_f32 v34, v34, v56
v_mul_f32 v16, s35, v16
v_mul_f32 v17, s35, v17
v_mfma_f32_32x32x16_bf16 v[64:79], a[80:83], a[36:39], v[64:79]
ds_read_b128 a[80:83], v6 offset:49152
v_exp_f32 v58, v58
v_add_f32 v34, v34, v57
v_cvt_pk_bf16_f32 v84, v56, v57
v_cvt_pk_bf16_f32 v14, v14, v15
v_mfma_f32_32x32x16_bf16 v[64:79], a[84:87], a[44:47], v[64:79]
ds_read_b128 a[84:87], v7 offset:49152
v_exp_f32 v59, v59
v_add_f32 v34, v34, v58
v_cvt_pk_bf16_f32 v16, v16, v17
v_accvgpr_write_b32 a130, v14
v_mfma_f32_32x32x16_bf16 v[64:79], a[88:91], a[52:55], v[64:79]
ds_read_b128 a[88:91], v8 offset:49152
v_exp_f32 v60, v60
v_add_f32 v34, v34, v59
v_cvt_pk_bf16_f32 v85, v58, v59
v_accvgpr_write_b32 a131, v16
v_mfma_f32_32x32x16_bf16 v[64:79], a[92:95], a[60:63], v[64:79]
ds_read_b128 a[92:95], v9 offset:49152
v_exp_f32 v61, v61
v_add_f32 v34, v34, v60
v_accvgpr_read_b32 v14, a136
v_accvgpr_read_b32 v15, a137
s_waitcnt lgkmcnt(8)
v_mfma_f32_32x32x16_bf16 v[128:143], a[96:99], v[80:83], v[128:143]
v_exp_f32 v62, v62
v_add_f32 v34, v34, v61
v_cvt_pk_bf16_f32 v86, v60, v61
v_accvgpr_read_b32 v16, a138
v_accvgpr_read_b32 v17, a139
v_mfma_f32_32x32x16_bf16 v[160:175], a[100:103], v[80:83], v[160:175]
v_exp_f32 v63, v63
v_add_f32 v34, v34, v62
s_add_u32 m0, s27, 24576
v_mul_f32 v14, s35, v14
v_mul_f32 v15, s35, v15
v_mfma_f32_32x32x16_bf16 v[192:207], a[104:107], v[80:83], v[192:207]
v_exp_f32 v64, v64
v_add_f32 v34, v34, v63
v_cvt_pk_bf16_f32 v87, v62, v63
v_mul_f32 v16, s35, v16
v_mul_f32 v17, s35, v17
v_mfma_f32_32x32x16_bf16 v[224:239], a[108:111], v[80:83], v[224:239]
buffer_load_dwordx4 v22, s[12:15], s58 offen nt lds
v_exp_f32 v65, v65
v_add_f32 v35, v35, v64
v_cvt_pk_bf16_f32 v14, v14, v15
v_mfma_f32_32x32x16_bf16 v[128:143], a[112:115], v[84:87], v[128:143]
v_exp_f32 v66, v66
v_add_f32 v35, v35, v65
v_cvt_pk_bf16_f32 v88, v64, v65
v_cvt_pk_bf16_f32 v16, v16, v17
v_accvgpr_write_b32 a132, v14
v_mfma_f32_32x32x16_bf16 v[160:175], a[116:119], v[84:87], v[160:175]
buffer_load_dwordx4 v23, s[12:15], s58 offen offset:1024 nt lds
v_exp_f32 v67, v67
v_add_f32 v35, v35, v66
v_accvgpr_write_b32 a133, v16
v_mfma_f32_32x32x16_bf16 v[192:207], a[120:123], v[84:87], v[192:207]
v_exp_f32 v68, v68
v_add_f32 v35, v35, v67
v_cvt_pk_bf16_f32 v89, v66, v67
s_add_u32 s58, s58, 8192
v_accvgpr_read_b32 v14, a140
v_mfma_f32_32x32x16_bf16 v[224:239], a[124:127], v[84:87], v[224:239]
v_exp_f32 v69, v69
v_add_f32 v35, v35, v68
s_add_u32 m0, s30, 16384
v_accvgpr_read_b32 v15, a141
v_accvgpr_read_b32 v16, a142
s_waitcnt lgkmcnt(0)
v_mfma_f32_32x32x16_bf16 v[48:63], a[64:67], a[0:3], v[96:111]
v_exp_f32 v70, v70
v_add_f32 v35, v35, v69
v_cvt_pk_bf16_f32 v90, v68, v69
v_accvgpr_read_b32 v17, a143
v_mul_f32 v14, s35, v14
v_mfma_f32_32x32x16_bf16 v[48:63], a[68:71], a[8:11], v[48:63]
buffer_load_dwordx4 v24, s[16:19], s59 offen nt lds
v_exp_f32 v71, v71
v_add_f32 v35, v35, v70
v_mul_f32 v15, s35, v15
v_mfma_f32_32x32x16_bf16 v[48:63], a[72:75], a[16:19], v[48:63]
v_exp_f32 v72, v72
v_add_f32 v35, v35, v71
v_cvt_pk_bf16_f32 v91, v70, v71
v_mul_f32 v16, s35, v16
v_mul_f32 v17, s35, v17
v_mfma_f32_32x32x16_bf16 v[48:63], a[76:79], a[24:27], v[48:63]
buffer_load_dwordx4 v24, s[16:19], s59 offen offset:1024 nt lds
v_exp_f32 v73, v73
v_add_f32 v35, v35, v72
v_cvt_pk_bf16_f32 v14, v14, v15
v_mfma_f32_32x32x16_bf16 v[48:63], a[80:83], a[32:35], v[48:63]
v_exp_f32 v74, v74
v_add_f32 v35, v35, v73
v_cvt_pk_bf16_f32 v92, v72, v73
s_add_u32 s59, s59, 8192
v_cvt_pk_bf16_f32 v16, v16, v17
v_mfma_f32_32x32x16_bf16 v[48:63], a[84:87], a[40:43], v[48:63]
v_exp_f32 v75, v75
v_add_f32 v35, v35, v74
v_accvgpr_write_b32 a134, v14
v_accvgpr_write_b32 a135, v16
v_accvgpr_read_b32 v14, a144
v_mfma_f32_32x32x16_bf16 v[48:63], a[88:91], a[48:51], v[48:63]
v_exp_f32 v76, v76
v_add_f32 v35, v35, v75
v_cvt_pk_bf16_f32 v93, v74, v75
v_accvgpr_read_b32 v15, a145
v_accvgpr_read_b32 v16, a146
v_mfma_f32_32x32x16_bf16 v[48:63], a[92:95], a[56:59], v[48:63]
v_exp_f32 v77, v77
v_add_f32 v35, v35, v76
v_accvgpr_read_b32 v17, a147
v_mul_f32 v14, s35, v14
v_mul_f32 v15, s35, v15
v_mfma_f32_32x32x16_bf16 v[144:159], a[96:99], v[88:91], v[144:159]
ds_read_b64_tr_b16 a[96:97], v10 offset:49152
ds_read_b64_tr_b16 a[98:99], v10 offset:50176
v_exp_f32 v78, v78
v_add_f32 v35, v35, v77
v_cvt_pk_bf16_f32 v94, v76, v77
v_mfma_f32_32x32x16_bf16 v[176:191], a[100:103], v[88:91], v[176:191]
ds_read_b64_tr_b16 a[100:101], v11 offset:49152
ds_read_b64_tr_b16 a[102:103], v11 offset:50176
v_exp_f32 v79, v79
v_add_f32 v35, v35, v78
v_mul_f32 v16, s35, v16
v_mfma_f32_32x32x16_bf16 v[208:223], a[104:107], v[88:91], v[208:223]
ds_read_b64_tr_b16 a[104:105], v12 offset:49152
ds_read_b64_tr_b16 a[106:107], v12 offset:50176
v_exp_f32 v48, v48
v_add_f32 v35, v35, v79
v_cvt_pk_bf16_f32 v95, v78, v79
v_mfma_f32_32x32x16_bf16 v[240:255], a[108:111], v[88:91], v[240:255]
ds_read_b64_tr_b16 a[108:109], v13 offset:49152
ds_read_b64_tr_b16 a[110:111], v13 offset:50176
v_exp_f32 v49, v49
v_add_f32 v34, v34, v48
v_mul_f32 v17, s35, v17
v_mfma_f32_32x32x16_bf16 v[144:159], a[112:115], v[92:95], v[144:159]
ds_read_b64_tr_b16 a[112:113], v10 offset:53248
ds_read_b64_tr_b16 a[114:115], v10 offset:54272
v_exp_f32 v50, v50
v_add_f32 v34, v34, v49
v_cvt_pk_bf16_f32 v80, v48, v49
v_mfma_f32_32x32x16_bf16 v[176:191], a[116:119], v[92:95], v[176:191]
ds_read_b64_tr_b16 a[116:117], v11 offset:53248
ds_read_b64_tr_b16 a[118:119], v11 offset:54272
v_exp_f32 v51, v51
v_add_f32 v34, v34, v50
v_cvt_pk_bf16_f32 v14, v14, v15
v_mfma_f32_32x32x16_bf16 v[208:223], a[120:123], v[92:95], v[208:223]
ds_read_b64_tr_b16 a[120:121], v12 offset:53248
ds_read_b64_tr_b16 a[122:123], v12 offset:54272
v_exp_f32 v52, v52
v_add_f32 v34, v34, v51
v_cvt_pk_bf16_f32 v81, v50, v51
v_mfma_f32_32x32x16_bf16 v[240:255], a[124:127], v[92:95], v[240:255]
ds_read_b64_tr_b16 a[124:125], v13 offset:53248
ds_read_b64_tr_b16 a[126:127], v13 offset:54272
v_exp_f32 v53, v53
v_add_f32 v34, v34, v52
v_cvt_pk_bf16_f32 v16, v16, v17
s_waitcnt vmcnt(21)
s_barrier
v_mfma_f32_32x32x16_bf16 v[64:79], a[64:67], a[4:7], v[112:127]
ds_read_b128 a[64:67], v2 offset:57344
v_exp_f32 v54, v54
v_add_f32 v34, v34, v53
v_cvt_pk_bf16_f32 v82, v52, v53
v_accvgpr_write_b32 a136, v14
v_mfma_f32_32x32x16_bf16 v[64:79], a[68:71], a[12:15], v[64:79]
ds_read_b128 a[68:71], v3 offset:57344
v_exp_f32 v55, v55
v_add_f32 v34, v34, v54
v_accvgpr_write_b32 a137, v16
v_accvgpr_read_b32 v14, a148
v_mfma_f32_32x32x16_bf16 v[64:79], a[72:75], a[20:23], v[64:79]
ds_read_b128 a[72:75], v4 offset:57344
v_exp_f32 v56, v56
v_add_f32 v34, v34, v55
v_cvt_pk_bf16_f32 v83, v54, v55
v_accvgpr_read_b32 v15, a149
v_mfma_f32_32x32x16_bf16 v[64:79], a[76:79], a[28:31], v[64:79]
ds_read_b128 a[76:79], v5 offset:57344
v_exp_f32 v57, v57
v_add_f32 v34, v34, v56
v_accvgpr_read_b32 v16, a150
v_accvgpr_read_b32 v17, a151
v_mfma_f32_32x32x16_bf16 v[64:79], a[80:83], a[36:39], v[64:79]
ds_read_b128 a[80:83], v6 offset:57344
v_exp_f32 v58, v58
v_add_f32 v34, v34, v57
v_cvt_pk_bf16_f32 v84, v56, v57
v_mul_f32 v14, s35, v14
v_mfma_f32_32x32x16_bf16 v[64:79], a[84:87], a[44:47], v[64:79]
ds_read_b128 a[84:87], v7 offset:57344
v_exp_f32 v59, v59
v_add_f32 v34, v34, v58
v_mul_f32 v15, s35, v15
v_mul_f32 v16, s35, v16
v_mfma_f32_32x32x16_bf16 v[64:79], a[88:91], a[52:55], v[64:79]
ds_read_b128 a[88:91], v8 offset:57344
v_exp_f32 v60, v60
v_add_f32 v34, v34, v59
v_cvt_pk_bf16_f32 v85, v58, v59
v_mul_f32 v17, s35, v17
v_mfma_f32_32x32x16_bf16 v[64:79], a[92:95], a[60:63], v[64:79]
ds_read_b128 a[92:95], v9 offset:57344
v_exp_f32 v61, v61
v_add_f32 v34, v34, v60
v_cvt_pk_bf16_f32 v14, v14, v15
v_cvt_pk_bf16_f32 v16, v16, v17
s_waitcnt lgkmcnt(8)
v_mfma_f32_32x32x16_bf16 v[128:143], a[96:99], v[80:83], v[128:143]
v_exp_f32 v62, v62
v_add_f32 v34, v34, v61
v_cvt_pk_bf16_f32 v86, v60, v61
v_accvgpr_write_b32 a138, v14
v_accvgpr_write_b32 a139, v16
v_mfma_f32_32x32x16_bf16 v[160:175], a[100:103], v[80:83], v[160:175]
v_exp_f32 v63, v63
v_add_f32 v34, v34, v62
s_add_u32 m0, s27, 49152
v_accvgpr_read_b32 v14, a152
v_accvgpr_read_b32 v15, a153
v_mfma_f32_32x32x16_bf16 v[192:207], a[104:107], v[80:83], v[192:207]
v_exp_f32 v64, v64
v_add_f32 v34, v34, v63
v_cvt_pk_bf16_f32 v87, v62, v63
v_accvgpr_read_b32 v16, a154
v_accvgpr_read_b32 v17, a155
v_mfma_f32_32x32x16_bf16 v[224:239], a[108:111], v[80:83], v[224:239]
buffer_load_dwordx4 v22, s[12:15], s58 offen nt lds
v_exp_f32 v65, v65
v_add_f32 v35, v35, v64
v_mul_f32 v14, s35, v14
v_mfma_f32_32x32x16_bf16 v[128:143], a[112:115], v[84:87], v[128:143]
v_exp_f32 v66, v66
v_add_f32 v35, v35, v65
v_cvt_pk_bf16_f32 v88, v64, v65
v_mul_f32 v15, s35, v15
v_mul_f32 v16, s35, v16
v_mfma_f32_32x32x16_bf16 v[160:175], a[116:119], v[84:87], v[160:175]
buffer_load_dwordx4 v23, s[12:15], s58 offen offset:1024 nt lds
v_exp_f32 v67, v67
v_add_f32 v35, v35, v66
v_mul_f32 v17, s35, v17
v_mfma_f32_32x32x16_bf16 v[192:207], a[120:123], v[84:87], v[192:207]
v_exp_f32 v68, v68
v_add_f32 v35, v35, v67
v_cvt_pk_bf16_f32 v89, v66, v67
s_add_u32 s58, s58, 8192
v_cvt_pk_bf16_f32 v14, v14, v15
v_mfma_f32_32x32x16_bf16 v[224:239], a[124:127], v[84:87], v[224:239]
v_exp_f32 v69, v69
v_add_f32 v35, v35, v68
s_add_u32 m0, s30, 24576
v_cvt_pk_bf16_f32 v16, v16, v17
v_accvgpr_write_b32 a140, v14
s_waitcnt lgkmcnt(0)
v_mfma_f32_32x32x16_bf16 v[48:63], a[64:67], a[0:3], v[96:111]
v_exp_f32 v70, v70
v_add_f32 v35, v35, v69
v_cvt_pk_bf16_f32 v90, v68, v69
v_accvgpr_write_b32 a141, v16
v_accvgpr_read_b32 v14, a156
v_mfma_f32_32x32x16_bf16 v[48:63], a[68:71], a[8:11], v[48:63]
buffer_load_dwordx4 v24, s[16:19], s59 offen nt lds
v_exp_f32 v71, v71
v_add_f32 v35, v35, v70
v_accvgpr_read_b32 v15, a157
v_mfma_f32_32x32x16_bf16 v[48:63], a[72:75], a[16:19], v[48:63]
v_exp_f32 v72, v72
v_add_f32 v35, v35, v71
v_cvt_pk_bf16_f32 v91, v70, v71
v_accvgpr_read_b32 v16, a158
v_accvgpr_read_b32 v17, a159
v_mfma_f32_32x32x16_bf16 v[48:63], a[76:79], a[24:27], v[48:63]
buffer_load_dwordx4 v24, s[16:19], s59 offen offset:1024 nt lds
v_exp_f32 v73, v73
v_add_f32 v35, v35, v72
v_mul_f32 v14, s35, v14
v_mfma_f32_32x32x16_bf16 v[48:63], a[80:83], a[32:35], v[48:63]
v_exp_f32 v74, v74
v_add_f32 v35, v35, v73
v_cvt_pk_bf16_f32 v92, v72, v73
s_add_u32 s59, s59, 8192
v_mul_f32 v15, s35, v15
v_mfma_f32_32x32x16_bf16 v[48:63], a[84:87], a[40:43], v[48:63]
v_exp_f32 v75, v75
v_add_f32 v35, v35, v74
v_mul_f32 v16, s35, v16
v_mul_f32 v17, s35, v17
v_cvt_pk_bf16_f32 v14, v14, v15
v_mfma_f32_32x32x16_bf16 v[48:63], a[88:91], a[48:51], v[48:63]
v_exp_f32 v76, v76
v_add_f32 v35, v35, v75
v_cvt_pk_bf16_f32 v93, v74, v75
v_cvt_pk_bf16_f32 v16, v16, v17
v_accvgpr_write_b32 a142, v14
v_mfma_f32_32x32x16_bf16 v[48:63], a[92:95], a[56:59], v[48:63]
v_exp_f32 v77, v77
v_add_f32 v35, v35, v76
v_accvgpr_write_b32 a143, v16
v_accvgpr_read_b32 v14, a160
v_accvgpr_read_b32 v15, a161
v_mfma_f32_32x32x16_bf16 v[144:159], a[96:99], v[88:91], v[144:159]
ds_read_b64_tr_b16 a[96:97], v10 offset:57344
ds_read_b64_tr_b16 a[98:99], v10 offset:58368
v_exp_f32 v78, v78
v_add_f32 v35, v35, v77
v_cvt_pk_bf16_f32 v94, v76, v77
v_mfma_f32_32x32x16_bf16 v[176:191], a[100:103], v[88:91], v[176:191]
ds_read_b64_tr_b16 a[100:101], v11 offset:57344
ds_read_b64_tr_b16 a[102:103], v11 offset:58368
v_exp_f32 v79, v79
v_add_f32 v35, v35, v78
v_accvgpr_read_b32 v16, a162
v_mfma_f32_32x32x16_bf16 v[208:223], a[104:107], v[88:91], v[208:223]
ds_read_b64_tr_b16 a[104:105], v12 offset:57344
ds_read_b64_tr_b16 a[106:107], v12 offset:58368
v_exp_f32 v48, v48
v_add_f32 v35, v35, v79
v_cvt_pk_bf16_f32 v95, v78, v79
v_mfma_f32_32x32x16_bf16 v[240:255], a[108:111], v[88:91], v[240:255]
ds_read_b64_tr_b16 a[108:109], v13 offset:57344
ds_read_b64_tr_b16 a[110:111], v13 offset:58368
v_exp_f32 v49, v49
v_add_f32 v34, v34, v48
v_accvgpr_read_b32 v17, a163
v_mfma_f32_32x32x16_bf16 v[144:159], a[112:115], v[92:95], v[144:159]
ds_read_b64_tr_b16 a[112:113], v10 offset:61440
ds_read_b64_tr_b16 a[114:115], v10 offset:62464
v_exp_f32 v50, v50
v_add_f32 v34, v34, v49
v_cvt_pk_bf16_f32 v80, v48, v49
v_mfma_f32_32x32x16_bf16 v[176:191], a[116:119], v[92:95], v[176:191]
ds_read_b64_tr_b16 a[116:117], v11 offset:61440
ds_read_b64_tr_b16 a[118:119], v11 offset:62464
v_exp_f32 v51, v51
v_add_f32 v34, v34, v50
v_mul_f32 v14, s35, v14
v_mfma_f32_32x32x16_bf16 v[208:223], a[120:123], v[92:95], v[208:223]
ds_read_b64_tr_b16 a[120:121], v12 offset:61440
ds_read_b64_tr_b16 a[122:123], v12 offset:62464
v_exp_f32 v52, v52
v_add_f32 v34, v34, v51
v_cvt_pk_bf16_f32 v81, v50, v51
v_mfma_f32_32x32x16_bf16 v[240:255], a[124:127], v[92:95], v[240:255]
ds_read_b64_tr_b16 a[124:125], v13 offset:61440
ds_read_b64_tr_b16 a[126:127], v13 offset:62464
v_exp_f32 v53, v53
v_add_f32 v34, v34, v52
v_mul_f32 v15, s35, v15
s_waitcnt vmcnt(23)
s_barrier
v_mfma_f32_32x32x16_bf16 v[64:79], a[64:67], a[4:7], v[112:127]
ds_read_b128 a[64:67], v2 offset:32768
v_exp_f32 v54, v54
v_add_f32 v34, v34, v53
v_cvt_pk_bf16_f32 v82, v52, v53
v_mul_f32 v16, s35, v16
v_mfma_f32_32x32x16_bf16 v[64:79], a[68:71], a[12:15], v[64:79]
ds_read_b128 a[68:71], v3 offset:32768
v_exp_f32 v55, v55
v_add_f32 v34, v34, v54
v_mul_f32 v17, s35, v17
v_cvt_pk_bf16_f32 v14, v14, v15
v_mfma_f32_32x32x16_bf16 v[64:79], a[72:75], a[20:23], v[64:79]
ds_read_b128 a[72:75], v4 offset:32768
v_exp_f32 v56, v56
v_add_f32 v34, v34, v55
v_cvt_pk_bf16_f32 v83, v54, v55
v_cvt_pk_bf16_f32 v16, v16, v17
v_mfma_f32_32x32x16_bf16 v[64:79], a[76:79], a[28:31], v[64:79]
ds_read_b128 a[76:79], v5 offset:32768
v_exp_f32 v57, v57
v_add_f32 v34, v34, v56
v_accvgpr_write_b32 a144, v14
v_accvgpr_write_b32 a145, v16
v_mfma_f32_32x32x16_bf16 v[64:79], a[80:83], a[36:39], v[64:79]
ds_read_b128 a[80:83], v6 offset:32768
v_exp_f32 v58, v58
v_add_f32 v34, v34, v57
v_cvt_pk_bf16_f32 v84, v56, v57
v_accvgpr_read_b32 v14, a164
v_mfma_f32_32x32x16_bf16 v[64:79], a[84:87], a[44:47], v[64:79]
ds_read_b128 a[84:87], v7 offset:32768
v_exp_f32 v59, v59
v_add_f32 v34, v34, v58
v_accvgpr_read_b32 v15, a165
v_accvgpr_read_b32 v16, a166
v_mfma_f32_32x32x16_bf16 v[64:79], a[88:91], a[52:55], v[64:79]
ds_read_b128 a[88:91], v8 offset:32768
v_exp_f32 v60, v60
v_add_f32 v34, v34, v59
v_cvt_pk_bf16_f32 v85, v58, v59
v_accvgpr_read_b32 v17, a167
v_mfma_f32_32x32x16_bf16 v[64:79], a[92:95], a[60:63], v[64:79]
ds_read_b128 a[92:95], v9 offset:32768
v_exp_f32 v61, v61
v_add_f32 v34, v34, v60
v_mul_f32 v14, s35, v14
v_mul_f32 v15, s35, v15
s_waitcnt lgkmcnt(8)
v_mfma_f32_32x32x16_bf16 v[128:143], a[96:99], v[80:83], v[128:143]
v_exp_f32 v62, v62
v_add_f32 v34, v34, v61
v_cvt_pk_bf16_f32 v86, v60, v61
v_mul_f32 v16, s35, v16
v_mul_f32 v17, s35, v17
v_mfma_f32_32x32x16_bf16 v[160:175], a[100:103], v[80:83], v[160:175]
v_exp_f32 v63, v63
v_add_f32 v34, v34, v62
s_add_u32 m0, s27, 57344
v_cvt_pk_bf16_f32 v14, v14, v15
v_cvt_pk_bf16_f32 v16, v16, v17
v_mfma_f32_32x32x16_bf16 v[192:207], a[104:107], v[80:83], v[192:207]
v_exp_f32 v64, v64
v_add_f32 v34, v34, v63
v_cvt_pk_bf16_f32 v87, v62, v63
v_accvgpr_write_b32 a146, v14
v_accvgpr_write_b32 a147, v16
v_mfma_f32_32x32x16_bf16 v[224:239], a[108:111], v[80:83], v[224:239]
buffer_load_dwordx4 v22, s[12:15], s58 offen nt lds
v_exp_f32 v65, v65
v_add_f32 v35, v35, v64
v_accvgpr_read_b32 v14, a168
v_mfma_f32_32x32x16_bf16 v[128:143], a[112:115], v[84:87], v[128:143]
v_exp_f32 v66, v66
v_add_f32 v35, v35, v65
v_cvt_pk_bf16_f32 v88, v64, v65
v_accvgpr_read_b32 v15, a169
v_accvgpr_read_b32 v16, a170
v_mfma_f32_32x32x16_bf16 v[160:175], a[116:119], v[84:87], v[160:175]
buffer_load_dwordx4 v23, s[12:15], s58 offen offset:1024 nt lds
v_exp_f32 v67, v67
v_add_f32 v35, v35, v66
v_accvgpr_read_b32 v17, a171
v_mfma_f32_32x32x16_bf16 v[192:207], a[120:123], v[84:87], v[192:207]
v_exp_f32 v68, v68
v_add_f32 v35, v35, v67
v_cvt_pk_bf16_f32 v89, v66, v67
s_add_u32 s58, s58, 8192
v_mul_f32 v14, s35, v14
v_mfma_f32_32x32x16_bf16 v[224:239], a[124:127], v[84:87], v[224:239]
v_exp_f32 v69, v69
v_add_f32 v35, v35, v68
s_add_u32 m0, s30, 49152
v_mul_f32 v15, s35, v15
v_mul_f32 v16, s35, v16
s_waitcnt lgkmcnt(0)
v_mfma_f32_32x32x16_bf16 v[48:63], a[64:67], a[0:3], v[96:111]
v_exp_f32 v70, v70
v_add_f32 v35, v35, v69
v_cvt_pk_bf16_f32 v90, v68, v69
v_mul_f32 v17, s35, v17
v_cvt_pk_bf16_f32 v14, v14, v15
v_mfma_f32_32x32x16_bf16 v[48:63], a[68:71], a[8:11], v[48:63]
buffer_load_dwordx4 v24, s[16:19], s59 offen nt lds
v_exp_f32 v71, v71
v_add_f32 v35, v35, v70
v_cvt_pk_bf16_f32 v16, v16, v17
v_mfma_f32_32x32x16_bf16 v[48:63], a[72:75], a[16:19], v[48:63]
v_exp_f32 v72, v72
v_add_f32 v35, v35, v71
v_cvt_pk_bf16_f32 v91, v70, v71
v_accvgpr_write_b32 a148, v14
v_accvgpr_write_b32 a149, v16
v_mfma_f32_32x32x16_bf16 v[48:63], a[76:79], a[24:27], v[48:63]
buffer_load_dwordx4 v24, s[16:19], s59 offen offset:1024 nt lds
v_exp_f32 v73, v73
v_add_f32 v35, v35, v72
v_accvgpr_read_b32 v14, a172
v_mfma_f32_32x32x16_bf16 v[48:63], a[80:83], a[32:35], v[48:63]
v_exp_f32 v74, v74
v_add_f32 v35, v35, v73
v_cvt_pk_bf16_f32 v92, v72, v73
s_add_u32 s59, s59, 8192
v_accvgpr_read_b32 v15, a173
v_mfma_f32_32x32x16_bf16 v[48:63], a[84:87], a[40:43], v[48:63]
v_exp_f32 v75, v75
v_add_f32 v35, v35, v74
v_accvgpr_read_b32 v16, a174
v_accvgpr_read_b32 v17, a175
v_mul_f32 v14, s35, v14
v_mfma_f32_32x32x16_bf16 v[48:63], a[88:91], a[48:51], v[48:63]
v_exp_f32 v76, v76
v_add_f32 v35, v35, v75
v_cvt_pk_bf16_f32 v93, v74, v75
v_mul_f32 v15, s35, v15
v_mul_f32 v16, s35, v16
v_mfma_f32_32x32x16_bf16 v[48:63], a[92:95], a[56:59], v[48:63]
v_exp_f32 v77, v77
v_add_f32 v35, v35, v76
v_mul_f32 v17, s35, v17
v_cvt_pk_bf16_f32 v14, v14, v15
v_cvt_pk_bf16_f32 v16, v16, v17
v_mfma_f32_32x32x16_bf16 v[144:159], a[96:99], v[88:91], v[144:159]
ds_read_b64_tr_b16 a[96:97], v10 offset:32768
ds_read_b64_tr_b16 a[98:99], v10 offset:33792
v_exp_f32 v78, v78
v_add_f32 v35, v35, v77
v_cvt_pk_bf16_f32 v94, v76, v77
v_mfma_f32_32x32x16_bf16 v[176:191], a[100:103], v[88:91], v[176:191]
ds_read_b64_tr_b16 a[100:101], v11 offset:32768
ds_read_b64_tr_b16 a[102:103], v11 offset:33792
v_exp_f32 v79, v79
v_add_f32 v35, v35, v78
v_accvgpr_write_b32 a150, v14
v_mfma_f32_32x32x16_bf16 v[208:223], a[104:107], v[88:91], v[208:223]
ds_read_b64_tr_b16 a[104:105], v12 offset:32768
ds_read_b64_tr_b16 a[106:107], v12 offset:33792
v_exp_f32 v48, v48
v_add_f32 v35, v35, v79
v_cvt_pk_bf16_f32 v95, v78, v79
v_mfma_f32_32x32x16_bf16 v[240:255], a[108:111], v[88:91], v[240:255]
ds_read_b64_tr_b16 a[108:109], v13 offset:32768
ds_read_b64_tr_b16 a[110:111], v13 offset:33792
v_exp_f32 v49, v49
v_add_f32 v34, v34, v48
v_accvgpr_write_b32 a151, v16
v_mfma_f32_32x32x16_bf16 v[144:159], a[112:115], v[92:95], v[144:159]
ds_read_b64_tr_b16 a[112:113], v10 offset:36864
ds_read_b64_tr_b16 a[114:115], v10 offset:37888
v_exp_f32 v50, v50
v_add_f32 v34, v34, v49
v_cvt_pk_bf16_f32 v80, v48, v49
v_mfma_f32_32x32x16_bf16 v[176:191], a[116:119], v[92:95], v[176:191]
ds_read_b64_tr_b16 a[116:117], v11 offset:36864
ds_read_b64_tr_b16 a[118:119], v11 offset:37888
v_exp_f32 v51, v51
v_add_f32 v34, v34, v50
v_accvgpr_read_b32 v14, a176
v_mfma_f32_32x32x16_bf16 v[208:223], a[120:123], v[92:95], v[208:223]
ds_read_b64_tr_b16 a[120:121], v12 offset:36864
ds_read_b64_tr_b16 a[122:123], v12 offset:37888
v_exp_f32 v52, v52
v_add_f32 v34, v34, v51
v_cvt_pk_bf16_f32 v81, v50, v51
v_mfma_f32_32x32x16_bf16 v[240:255], a[124:127], v[92:95], v[240:255]
ds_read_b64_tr_b16 a[124:125], v13 offset:36864
ds_read_b64_tr_b16 a[126:127], v13 offset:37888
v_exp_f32 v53, v53
v_add_f32 v34, v34, v52
v_accvgpr_read_b32 v15, a177
s_waitcnt vmcnt(20)
s_barrier
v_mfma_f32_32x32x16_bf16 v[64:79], a[64:67], a[4:7], v[112:127]
ds_read_b128 a[64:67], v2 offset:40960
v_exp_f32 v54, v54
v_add_f32 v34, v34, v53
v_cvt_pk_bf16_f32 v82, v52, v53
v_accvgpr_read_b32 v16, a178
v_mfma_f32_32x32x16_bf16 v[64:79], a[68:71], a[12:15], v[64:79]
ds_read_b128 a[68:71], v3 offset:40960
v_exp_f32 v55, v55
v_add_f32 v34, v34, v54
v_mov_b32 v36, -1
v_accvgpr_read_b32 v17, a179
v_mfma_f32_32x32x16_bf16 v[64:79], a[72:75], a[20:23], v[64:79]
ds_read_b128 a[72:75], v4 offset:40960
v_exp_f32 v56, v56
v_add_f32 v34, v34, v55
v_cvt_pk_bf16_f32 v83, v54, v55
v_mul_f32 v14, s35, v14
v_mfma_f32_32x32x16_bf16 v[64:79], a[76:79], a[28:31], v[64:79]
ds_read_b128 a[76:79], v5 offset:40960
v_exp_f32 v57, v57
v_add_f32 v34, v34, v56
v_mov_b32 v37, -1
v_mul_f32 v15, s35, v15
v_mfma_f32_32x32x16_bf16 v[64:79], a[80:83], a[36:39], v[64:79]
ds_read_b128 a[80:83], v6 offset:40960
v_exp_f32 v58, v58
v_add_f32 v34, v34, v57
v_cvt_pk_bf16_f32 v84, v56, v57
v_mul_f32 v16, s35, v16
v_mfma_f32_32x32x16_bf16 v[64:79], a[84:87], a[44:47], v[64:79]
ds_read_b128 a[84:87], v7 offset:40960
v_exp_f32 v59, v59
v_add_f32 v34, v34, v58
v_mov_b32 v38, -1
v_mul_f32 v17, s35, v17
v_mfma_f32_32x32x16_bf16 v[64:79], a[88:91], a[52:55], v[64:79]
ds_read_b128 a[88:91], v8 offset:40960
v_exp_f32 v60, v60
v_add_f32 v34, v34, v59
v_cvt_pk_bf16_f32 v85, v58, v59
v_cvt_pk_bf16_f32 v14, v14, v15
v_mfma_f32_32x32x16_bf16 v[64:79], a[92:95], a[60:63], v[64:79]
ds_read_b128 a[92:95], v9 offset:40960
v_exp_f32 v61, v61
v_add_f32 v34, v34, v60
v_mov_b32 v39, -1
v_cvt_pk_bf16_f32 v16, v16, v17
s_waitcnt lgkmcnt(8)
v_mfma_f32_32x32x16_bf16 v[128:143], a[96:99], v[80:83], v[128:143]
v_exp_f32 v62, v62
v_add_f32 v34, v34, v61
v_cvt_pk_bf16_f32 v86, v60, v61
v_accvgpr_write_b32 a152, v14
v_accvgpr_write_b32 a153, v16
v_mfma_f32_32x32x16_bf16 v[160:175], a[100:103], v[80:83], v[160:175]
v_exp_f32 v63, v63
v_add_f32 v34, v34, v62
s_add_u32 m0, s27, 32768
v_accvgpr_read_b32 v14, a180
v_accvgpr_read_b32 v15, a181
v_mfma_f32_32x32x16_bf16 v[192:207], a[104:107], v[80:83], v[192:207]
v_exp_f32 v64, v64
v_add_f32 v34, v34, v63
v_cvt_pk_bf16_f32 v87, v62, v63
v_accvgpr_read_b32 v16, a182
v_accvgpr_read_b32 v17, a183
v_mfma_f32_32x32x16_bf16 v[224:239], a[108:111], v[80:83], v[224:239]
buffer_load_dwordx4 v22, s[12:15], s58 offen nt lds
v_exp_f32 v65, v65
v_add_f32 v35, v35, v64
v_mul_f32 v14, s35, v14
v_mfma_f32_32x32x16_bf16 v[128:143], a[112:115], v[84:87], v[128:143]
v_exp_f32 v66, v66
v_add_f32 v35, v35, v65
v_cvt_pk_bf16_f32 v88, v64, v65
v_mul_f32 v15, s35, v15
v_mul_f32 v16, s35, v16
v_mfma_f32_32x32x16_bf16 v[160:175], a[116:119], v[84:87], v[160:175]
buffer_load_dwordx4 v23, s[12:15], s58 offen offset:1024 nt lds
v_exp_f32 v67, v67
v_add_f32 v35, v35, v66
v_mul_f32 v17, s35, v17
v_mfma_f32_32x32x16_bf16 v[192:207], a[120:123], v[84:87], v[192:207]
v_exp_f32 v68, v68
v_add_f32 v35, v35, v67
v_cvt_pk_bf16_f32 v89, v66, v67
s_add_u32 s58, s58, 8192
v_cvt_pk_bf16_f32 v14, v14, v15
v_mfma_f32_32x32x16_bf16 v[224:239], a[124:127], v[84:87], v[224:239]
v_exp_f32 v69, v69
v_add_f32 v35, v35, v68
s_add_u32 m0, s30, 57344
v_cvt_pk_bf16_f32 v16, v16, v17
v_accvgpr_write_b32 a154, v14
s_waitcnt lgkmcnt(0)
v_mfma_f32_32x32x16_bf16 v[48:63], a[64:67], a[0:3], v[96:111]
v_exp_f32 v70, v70
v_add_f32 v35, v35, v69
v_cvt_pk_bf16_f32 v90, v68, v69
v_accvgpr_write_b32 a155, v16
v_accvgpr_read_b32 v14, a184
v_mfma_f32_32x32x16_bf16 v[48:63], a[68:71], a[8:11], v[48:63]
buffer_load_dwordx4 v24, s[16:19], s59 offen nt lds
v_exp_f32 v71, v71
v_add_f32 v35, v35, v70
v_accvgpr_read_b32 v15, a185
v_mfma_f32_32x32x16_bf16 v[48:63], a[72:75], a[16:19], v[48:63]
v_exp_f32 v72, v72
v_add_f32 v35, v35, v71
v_cvt_pk_bf16_f32 v91, v70, v71
v_accvgpr_read_b32 v16, a186
v_accvgpr_read_b32 v17, a187
v_mfma_f32_32x32x16_bf16 v[48:63], a[76:79], a[24:27], v[48:63]
buffer_load_dwordx4 v24, s[16:19], s59 offen offset:1024 nt lds
v_exp_f32 v73, v73
v_add_f32 v35, v35, v72
v_mul_f32 v14, s35, v14
v_mfma_f32_32x32x16_bf16 v[48:63], a[80:83], a[32:35], v[48:63]
v_exp_f32 v74, v74
v_add_f32 v35, v35, v73
v_cvt_pk_bf16_f32 v92, v72, v73
s_add_u32 s59, s59, 8192
v_mul_f32 v15, s35, v15
v_mfma_f32_32x32x16_bf16 v[48:63], a[84:87], a[40:43], v[48:63]
v_exp_f32 v75, v75
v_add_f32 v35, v35, v74
v_mul_f32 v16, s35, v16
v_mul_f32 v17, s35, v17
v_cvt_pk_bf16_f32 v14, v14, v15
v_mfma_f32_32x32x16_bf16 v[48:63], a[88:91], a[48:51], v[48:63]
v_exp_f32 v76, v76
v_add_f32 v35, v35, v75
v_cvt_pk_bf16_f32 v93, v74, v75
v_cvt_pk_bf16_f32 v16, v16, v17
v_accvgpr_write_b32 a156, v14
v_mfma_f32_32x32x16_bf16 v[48:63], a[92:95], a[56:59], v[48:63]
v_exp_f32 v77, v77
v_add_f32 v35, v35, v76
v_accvgpr_write_b32 a157, v16
v_accvgpr_read_b32 v14, a188
v_accvgpr_read_b32 v15, a189
v_mfma_f32_32x32x16_bf16 v[144:159], a[96:99], v[88:91], v[144:159]
ds_read_b64_tr_b16 a[96:97], v10 offset:40960
ds_read_b64_tr_b16 a[98:99], v10 offset:41984
v_exp_f32 v78, v78
v_add_f32 v35, v35, v77
v_cvt_pk_bf16_f32 v94, v76, v77
v_mfma_f32_32x32x16_bf16 v[176:191], a[100:103], v[88:91], v[176:191]
ds_read_b64_tr_b16 a[100:101], v11 offset:40960
ds_read_b64_tr_b16 a[102:103], v11 offset:41984
v_exp_f32 v79, v79
v_add_f32 v35, v35, v78
v_accvgpr_read_b32 v16, a190
v_mfma_f32_32x32x16_bf16 v[208:223], a[104:107], v[88:91], v[208:223]
ds_read_b64_tr_b16 a[104:105], v12 offset:40960
ds_read_b64_tr_b16 a[106:107], v12 offset:41984
v_exp_f32 v48, v48
v_add_f32 v35, v35, v79
v_cvt_pk_bf16_f32 v95, v78, v79
v_mfma_f32_32x32x16_bf16 v[240:255], a[108:111], v[88:91], v[240:255]
ds_read_b64_tr_b16 a[108:109], v13 offset:40960
ds_read_b64_tr_b16 a[110:111], v13 offset:41984
v_exp_f32 v49, v49
v_add_f32 v34, v34, v48
v_accvgpr_read_b32 v17, a191
v_mfma_f32_32x32x16_bf16 v[144:159], a[112:115], v[92:95], v[144:159]
ds_read_b64_tr_b16 a[112:113], v10 offset:45056
ds_read_b64_tr_b16 a[114:115], v10 offset:46080
v_exp_f32 v50, v50
v_add_f32 v34, v34, v49
v_cvt_pk_bf16_f32 v80, v48, v49
v_mfma_f32_32x32x16_bf16 v[176:191], a[116:119], v[92:95], v[176:191]
ds_read_b64_tr_b16 a[116:117], v11 offset:45056
ds_read_b64_tr_b16 a[118:119], v11 offset:46080
v_exp_f32 v51, v51
v_add_f32 v34, v34, v50
v_mul_f32 v14, s35, v14
v_mfma_f32_32x32x16_bf16 v[208:223], a[120:123], v[92:95], v[208:223]
ds_read_b64_tr_b16 a[120:121], v12 offset:45056
ds_read_b64_tr_b16 a[122:123], v12 offset:46080
v_exp_f32 v52, v52
v_add_f32 v34, v34, v51
v_cvt_pk_bf16_f32 v81, v50, v51
v_mfma_f32_32x32x16_bf16 v[240:255], a[124:127], v[92:95], v[240:255]
ds_read_b64_tr_b16 a[124:125], v13 offset:45056
ds_read_b64_tr_b16 a[126:127], v13 offset:46080
v_exp_f32 v53, v53
v_add_f32 v34, v34, v52
v_mul_f32 v15, s35, v15
s_waitcnt vmcnt(20)
s_barrier
v_mfma_f32_32x32x16_bf16 v[64:79], a[64:67], a[4:7], v[112:127]
ds_read_b128 a[64:67], v2 offset:0
v_exp_f32 v54, v54
v_add_f32 v34, v34, v53
v_cvt_pk_bf16_f32 v82, v52, v53
v_mul_f32 v16, s35, v16
v_mfma_f32_32x32x16_bf16 v[64:79], a[68:71], a[12:15], v[64:79]
ds_read_b128 a[68:71], v3 offset:0
buffer_store_dwordx4 v[36:39], v33, s[40:43], s82 offen offset:0 sc1
v_exp_f32 v55, v55
v_add_f32 v34, v34, v54
v_mfma_f32_32x32x16_bf16 v[64:79], a[72:75], a[20:23], v[64:79]
ds_read_b128 a[72:75], v4 offset:0
v_exp_f32 v56, v56
v_add_f32 v34, v34, v55
v_cvt_pk_bf16_f32 v83, v54, v55
v_mul_f32 v17, s35, v17
v_mfma_f32_32x32x16_bf16 v[64:79], a[76:79], a[28:31], v[64:79]
ds_read_b128 a[76:79], v5 offset:0
buffer_store_dwordx4 v[36:39], v33, s[40:43], s82 offen offset:1024 sc1
v_exp_f32 v57, v57
v_add_f32 v34, v34, v56
v_mfma_f32_32x32x16_bf16 v[64:79], a[80:83], a[36:39], v[64:79]
ds_read_b128 a[80:83], v6 offset:0
v_exp_f32 v58, v58
v_add_f32 v34, v34, v57
v_cvt_pk_bf16_f32 v84, v56, v57
v_cvt_pk_bf16_f32 v14, v14, v15
v_mfma_f32_32x32x16_bf16 v[64:79], a[84:87], a[44:47], v[64:79]
ds_read_b128 a[84:87], v7 offset:0
buffer_store_dwordx4 v[36:39], v33, s[40:43], s82 offen offset:2048 sc1
v_exp_f32 v59, v59
v_add_f32 v34, v34, v58
v_mfma_f32_32x32x16_bf16 v[64:79], a[88:91], a[52:55], v[64:79]
ds_read_b128 a[88:91], v8 offset:0
v_exp_f32 v60, v60
v_add_f32 v34, v34, v59
v_cvt_pk_bf16_f32 v85, v58, v59
v_cvt_pk_bf16_f32 v16, v16, v17
v_mfma_f32_32x32x16_bf16 v[64:79], a[92:95], a[60:63], v[64:79]
ds_read_b128 a[92:95], v9 offset:0
buffer_store_dwordx4 v[36:39], v33, s[40:43], s82 offen offset:3072 sc1
v_exp_f32 v61, v61
v_add_f32 v34, v34, v60
s_waitcnt lgkmcnt(8)
v_mfma_f32_32x32x16_bf16 v[128:143], a[96:99], v[80:83], v[128:143]
v_exp_f32 v62, v62
v_add_f32 v34, v34, v61
v_cvt_pk_bf16_f32 v86, v60, v61
v_accvgpr_write_b32 a158, v14
v_accvgpr_write_b32 a159, v16
v_mfma_f32_32x32x16_bf16 v[160:175], a[100:103], v[80:83], v[160:175]
v_exp_f32 v63, v63
v_add_f32 v34, v34, v62
s_add_u32 m0, s27, 40960
v_accvgpr_read_b32 v14, a192
v_accvgpr_read_b32 v15, a193
v_mfma_f32_32x32x16_bf16 v[192:207], a[104:107], v[80:83], v[192:207]
v_exp_f32 v64, v64
v_add_f32 v34, v34, v63
v_cvt_pk_bf16_f32 v87, v62, v63
v_accvgpr_read_b32 v16, a194
v_accvgpr_read_b32 v17, a195
v_mfma_f32_32x32x16_bf16 v[224:239], a[108:111], v[80:83], v[224:239]
buffer_load_dwordx4 v22, s[12:15], s58 offen nt lds
v_exp_f32 v65, v65
v_add_f32 v35, v35, v64
v_mul_f32 v14, s35, v14
v_mfma_f32_32x32x16_bf16 v[128:143], a[112:115], v[84:87], v[128:143]
v_exp_f32 v66, v66
v_add_f32 v35, v35, v65
v_cvt_pk_bf16_f32 v88, v64, v65
v_mul_f32 v15, s35, v15
v_mul_f32 v16, s35, v16
v_mfma_f32_32x32x16_bf16 v[160:175], a[116:119], v[84:87], v[160:175]
buffer_load_dwordx4 v23, s[12:15], s58 offen offset:1024 nt lds
v_exp_f32 v67, v67
v_add_f32 v35, v35, v66
v_mul_f32 v17, s35, v17
v_mfma_f32_32x32x16_bf16 v[192:207], a[120:123], v[84:87], v[192:207]
v_exp_f32 v68, v68
v_add_f32 v35, v35, v67
v_cvt_pk_bf16_f32 v89, v66, v67
s_add_u32 s58, s58, 8192
v_cvt_pk_bf16_f32 v14, v14, v15
v_mfma_f32_32x32x16_bf16 v[224:239], a[124:127], v[84:87], v[224:239]
v_exp_f32 v69, v69
v_add_f32 v35, v35, v68
s_add_u32 m0, s30, 32768
v_cvt_pk_bf16_f32 v16, v16, v17
v_accvgpr_write_b32 a160, v14
s_waitcnt lgkmcnt(0)
v_mfma_f32_32x32x16_bf16 v[48:63], a[64:67], a[0:3], v[96:111]
v_exp_f32 v70, v70
v_add_f32 v35, v35, v69
v_cvt_pk_bf16_f32 v90, v68, v69
v_accvgpr_write_b32 a161, v16
v_accvgpr_read_b32 v14, a196
v_mfma_f32_32x32x16_bf16 v[48:63], a[68:71], a[8:11], v[48:63]
buffer_load_dwordx4 v24, s[16:19], s59 offen nt lds
v_exp_f32 v71, v71
v_add_f32 v35, v35, v70
v_accvgpr_read_b32 v15, a197
v_mfma_f32_32x32x16_bf16 v[48:63], a[72:75], a[16:19], v[48:63]
v_exp_f32 v72, v72
v_add_f32 v35, v35, v71
v_cvt_pk_bf16_f32 v91, v70, v71
v_accvgpr_read_b32 v16, a198
v_accvgpr_read_b32 v17, a199
v_mfma_f32_32x32x16_bf16 v[48:63], a[76:79], a[24:27], v[48:63]
buffer_load_dwordx4 v24, s[16:19], s59 offen offset:1024 nt lds
v_exp_f32 v73, v73
v_add_f32 v35, v35, v72
v_mul_f32 v14, s35, v14
v_mfma_f32_32x32x16_bf16 v[48:63], a[80:83], a[32:35], v[48:63]
v_exp_f32 v74, v74
v_add_f32 v35, v35, v73
v_cvt_pk_bf16_f32 v92, v72, v73
s_add_u32 s59, s59, 8192
v_mul_f32 v15, s35, v15
v_mfma_f32_32x32x16_bf16 v[48:63], a[84:87], a[40:43], v[48:63]
v_exp_f32 v75, v75
v_add_f32 v35, v35, v74
v_mul_f32 v16, s35, v16
v_mul_f32 v17, s35, v17
v_cvt_pk_bf16_f32 v14, v14, v15
v_mfma_f32_32x32x16_bf16 v[48:63], a[88:91], a[48:51], v[48:63]
v_exp_f32 v76, v76
v_add_f32 v35, v35, v75
v_cvt_pk_bf16_f32 v93, v74, v75
v_cvt_pk_bf16_f32 v16, v16, v17
v_accvgpr_write_b32 a162, v14
v_mfma_f32_32x32x16_bf16 v[48:63], a[92:95], a[56:59], v[48:63]
v_exp_f32 v77, v77
v_add_f32 v35, v35, v76
v_accvgpr_write_b32 a163, v16
v_accvgpr_read_b32 v14, a200
v_accvgpr_read_b32 v15, a201
L1_oepi0:
v_mfma_f32_32x32x16_bf16 v[144:159], a[96:99], v[88:91], v[144:159]
ds_read_b64_tr_b16 a[96:97], v10 offset:0
ds_read_b64_tr_b16 a[98:99], v10 offset:1024
v_exp_f32 v78, v78
v_add_f32 v35, v35, v77
v_cvt_pk_bf16_f32 v94, v76, v77
v_mfma_f32_32x32x16_bf16 v[176:191], a[100:103], v[88:91], v[176:191]
ds_read_b64_tr_b16 a[100:101], v11 offset:0
ds_read_b64_tr_b16 a[102:103], v11 offset:1024
v_exp_f32 v79, v79
v_add_f32 v35, v35, v78
v_accvgpr_read_b32 v16, a202
v_mfma_f32_32x32x16_bf16 v[208:223], a[104:107], v[88:91], v[208:223]
ds_read_b64_tr_b16 a[104:105], v12 offset:0
ds_read_b64_tr_b16 a[106:107], v12 offset:1024
v_exp_f32 v48, v48
v_add_f32 v35, v35, v79
v_cvt_pk_bf16_f32 v95, v78, v79
v_mfma_f32_32x32x16_bf16 v[240:255], a[108:111], v[88:91], v[240:255]
ds_read_b64_tr_b16 a[108:109], v13 offset:0
ds_read_b64_tr_b16 a[110:111], v13 offset:1024
v_exp_f32 v49, v49
v_add_f32 v34, v34, v48
v_accvgpr_read_b32 v17, a203
v_mfma_f32_32x32x16_bf16 v[144:159], a[112:115], v[92:95], v[144:159]
ds_read_b64_tr_b16 a[112:113], v10 offset:4096
ds_read_b64_tr_b16 a[114:115], v10 offset:5120
v_exp_f32 v50, v50
v_add_f32 v34, v34, v49
v_cvt_pk_bf16_f32 v80, v48, v49
v_mfma_f32_32x32x16_bf16 v[176:191], a[116:119], v[92:95], v[176:191]
ds_read_b64_tr_b16 a[116:117], v11 offset:4096
ds_read_b64_tr_b16 a[118:119], v11 offset:5120
v_exp_f32 v51, v51
v_add_f32 v34, v34, v50
v_mul_f32 v14, s35, v14
v_mfma_f32_32x32x16_bf16 v[208:223], a[120:123], v[92:95], v[208:223]
ds_read_b64_tr_b16 a[120:121], v12 offset:4096
ds_read_b64_tr_b16 a[122:123], v12 offset:5120
v_exp_f32 v52, v52
v_add_f32 v34, v34, v51
v_cvt_pk_bf16_f32 v81, v50, v51
v_mfma_f32_32x32x16_bf16 v[240:255], a[124:127], v[92:95], v[240:255]
ds_read_b64_tr_b16 a[124:125], v13 offset:4096
ds_read_b64_tr_b16 a[126:127], v13 offset:5120
v_exp_f32 v53, v53
v_add_f32 v34, v34, v52
v_mul_f32 v15, s35, v15
s_waitcnt vmcnt(24)
s_barrier
v_mfma_f32_32x32x16_bf16 v[64:79], a[64:67], a[4:7], v[112:127]
ds_read_b128 a[64:67], v2 offset:8192
v_exp_f32 v54, v54
v_add_f32 v34, v34, v53
v_cvt_pk_bf16_f32 v82, v52, v53
v_mul_f32 v16, s35, v16
v_mfma_f32_32x32x16_bf16 v[64:79], a[68:71], a[12:15], v[64:79]
ds_read_b128 a[68:71], v3 offset:8192
v_exp_f32 v55, v55
v_add_f32 v34, v34, v54
v_mul_f32 v17, s35, v17
v_cvt_pk_bf16_f32 v14, v14, v15
v_mfma_f32_32x32x16_bf16 v[64:79], a[72:75], a[20:23], v[64:79]
ds_read_b128 a[72:75], v4 offset:8192
v_exp_f32 v56, v56
v_add_f32 v34, v34, v55
v_cvt_pk_bf16_f32 v83, v54, v55
v_cvt_pk_bf16_f32 v16, v16, v17
v_mfma_f32_32x32x16_bf16 v[64:79], a[76:79], a[28:31], v[64:79]
ds_read_b128 a[76:79], v5 offset:8192
v_exp_f32 v57, v57
v_add_f32 v34, v34, v56
v_accvgpr_write_b32 a164, v14
v_accvgpr_write_b32 a165, v16
v_mfma_f32_32x32x16_bf16 v[64:79], a[80:83], a[36:39], v[64:79]
ds_read_b128 a[80:83], v6 offset:8192
v_exp_f32 v58, v58
v_add_f32 v34, v34, v57
v_cvt_pk_bf16_f32 v84, v56, v57
v_accvgpr_read_b32 v14, a204
v_mfma_f32_32x32x16_bf16 v[64:79], a[84:87], a[44:47], v[64:79]
ds_read_b128 a[84:87], v7 offset:8192
v_exp_f32 v59, v59
v_add_f32 v34, v34, v58
v_accvgpr_read_b32 v15, a205
v_accvgpr_read_b32 v16, a206
v_mfma_f32_32x32x16_bf16 v[64:79], a[88:91], a[52:55], v[64:79]
ds_read_b128 a[88:91], v8 offset:8192
v_exp_f32 v60, v60
v_add_f32 v34, v34, v59
v_cvt_pk_bf16_f32 v85, v58, v59
v_accvgpr_read_b32 v17, a207
v_mfma_f32_32x32x16_bf16 v[64:79], a[92:95], a[60:63], v[64:79]
ds_read_b128 a[92:95], v9 offset:8192
v_exp_f32 v61, v61
v_add_f32 v34, v34, v60
v_mul_f32 v14, s35, v14
v_mul_f32 v15, s35, v15
s_waitcnt lgkmcnt(8)
v_mfma_f32_32x32x16_bf16 v[128:143], a[96:99], v[80:83], v[128:143]
v_exp_f32 v62, v62
v_add_f32 v34, v34, v61
v_cvt_pk_bf16_f32 v86, v60, v61
v_mul_f32 v16, s35, v16
v_mul_f32 v17, s35, v17
v_mfma_f32_32x32x16_bf16 v[160:175], a[100:103], v[80:83], v[160:175]
v_exp_f32 v63, v63
v_add_f32 v34, v34, v62
s_add_u32 m0, s27, 0
v_cvt_pk_bf16_f32 v14, v14, v15
v_cvt_pk_bf16_f32 v16, v16, v17
v_mfma_f32_32x32x16_bf16 v[192:207], a[104:107], v[80:83], v[192:207]
v_exp_f32 v64, v64
v_add_f32 v34, v34, v63
v_cvt_pk_bf16_f32 v87, v62, v63
v_accvgpr_write_b32 a166, v14
v_accvgpr_write_b32 a167, v16
v_mfma_f32_32x32x16_bf16 v[224:239], a[108:111], v[80:83], v[224:239]
buffer_load_dwordx4 v22, s[12:15], s58 offen nt lds
v_exp_f32 v65, v65
v_add_f32 v35, v35, v64
v_accvgpr_read_b32 v14, a208
v_mfma_f32_32x32x16_bf16 v[128:143], a[112:115], v[84:87], v[128:143]
v_exp_f32 v66, v66
v_add_f32 v35, v35, v65
v_cvt_pk_bf16_f32 v88, v64, v65
v_accvgpr_read_b32 v15, a209
v_accvgpr_read_b32 v16, a210
v_mfma_f32_32x32x16_bf16 v[160:175], a[116:119], v[84:87], v[160:175]
buffer_load_dwordx4 v23, s[12:15], s58 offen offset:1024 nt lds
v_exp_f32 v67, v67
v_add_f32 v35, v35, v66
v_accvgpr_read_b32 v17, a211
v_mfma_f32_32x32x16_bf16 v[192:207], a[120:123], v[84:87], v[192:207]
v_exp_f32 v68, v68
v_add_f32 v35, v35, v67
v_cvt_pk_bf16_f32 v89, v66, v67
s_add_u32 s58, s58, 8192
v_mul_f32 v14, s35, v14
v_mfma_f32_32x32x16_bf16 v[224:239], a[124:127], v[84:87], v[224:239]
v_exp_f32 v69, v69
v_add_f32 v35, v35, v68
s_add_u32 m0, s30, 40960
v_mul_f32 v15, s35, v15
v_mul_f32 v16, s35, v16
s_waitcnt lgkmcnt(0)
v_mfma_f32_32x32x16_bf16 v[48:63], a[64:67], a[0:3], v[96:111]
v_exp_f32 v70, v70
v_add_f32 v35, v35, v69
v_cvt_pk_bf16_f32 v90, v68, v69
v_mul_f32 v17, s35, v17
v_cvt_pk_bf16_f32 v14, v14, v15
v_mfma_f32_32x32x16_bf16 v[48:63], a[68:71], a[8:11], v[48:63]
buffer_load_dwordx4 v24, s[16:19], s59 offen nt lds
v_exp_f32 v71, v71
v_add_f32 v35, v35, v70
v_cvt_pk_bf16_f32 v16, v16, v17
v_mfma_f32_32x32x16_bf16 v[48:63], a[72:75], a[16:19], v[48:63]
v_exp_f32 v72, v72
v_add_f32 v35, v35, v71
v_cvt_pk_bf16_f32 v91, v70, v71
v_accvgpr_write_b32 a168, v14
v_accvgpr_write_b32 a169, v16
v_mfma_f32_32x32x16_bf16 v[48:63], a[76:79], a[24:27], v[48:63]
buffer_load_dwordx4 v24, s[16:19], s59 offen offset:1024 nt lds
v_exp_f32 v73, v73
v_add_f32 v35, v35, v72
v_accvgpr_read_b32 v14, a212
v_mfma_f32_32x32x16_bf16 v[48:63], a[80:83], a[32:35], v[48:63]
v_exp_f32 v74, v74
v_add_f32 v35, v35, v73
v_cvt_pk_bf16_f32 v92, v72, v73
s_add_u32 s59, s59, 8192
v_accvgpr_read_b32 v15, a213
v_mfma_f32_32x32x16_bf16 v[48:63], a[84:87], a[40:43], v[48:63]
v_exp_f32 v75, v75
v_add_f32 v35, v35, v74
v_accvgpr_read_b32 v16, a214
v_accvgpr_read_b32 v17, a215
v_mul_f32 v14, s35, v14
v_mfma_f32_32x32x16_bf16 v[48:63], a[88:91], a[48:51], v[48:63]
v_exp_f32 v76, v76
v_add_f32 v35, v35, v75
v_cvt_pk_bf16_f32 v93, v74, v75
v_mul_f32 v15, s35, v15
v_mul_f32 v16, s35, v16
v_mfma_f32_32x32x16_bf16 v[48:63], a[92:95], a[56:59], v[48:63]
v_exp_f32 v77, v77
v_add_f32 v35, v35, v76
v_mul_f32 v17, s35, v17
v_cvt_pk_bf16_f32 v14, v14, v15
v_cvt_pk_bf16_f32 v16, v16, v17
v_mfma_f32_32x32x16_bf16 v[144:159], a[96:99], v[88:91], v[144:159]
ds_read_b64_tr_b16 a[96:97], v10 offset:8192
ds_read_b64_tr_b16 a[98:99], v10 offset:9216
v_exp_f32 v78, v78
v_add_f32 v35, v35, v77
v_cvt_pk_bf16_f32 v94, v76, v77
v_mfma_f32_32x32x16_bf16 v[176:191], a[100:103], v[88:91], v[176:191]
ds_read_b64_tr_b16 a[100:101], v11 offset:8192
ds_read_b64_tr_b16 a[102:103], v11 offset:9216
v_exp_f32 v79, v79
v_add_f32 v35, v35, v78
v_accvgpr_write_b32 a170, v14
v_mfma_f32_32x32x16_bf16 v[208:223], a[104:107], v[88:91], v[208:223]
ds_read_b64_tr_b16 a[104:105], v12 offset:8192
ds_read_b64_tr_b16 a[106:107], v12 offset:9216
v_exp_f32 v48, v48
v_add_f32 v35, v35, v79
v_cvt_pk_bf16_f32 v95, v78, v79
v_mfma_f32_32x32x16_bf16 v[240:255], a[108:111], v[88:91], v[240:255]
ds_read_b64_tr_b16 a[108:109], v13 offset:8192
ds_read_b64_tr_b16 a[110:111], v13 offset:9216
v_exp_f32 v49, v49
v_add_f32 v34, v34, v48
v_accvgpr_write_b32 a171, v16
v_mfma_f32_32x32x16_bf16 v[144:159], a[112:115], v[92:95], v[144:159]
ds_read_b64_tr_b16 a[112:113], v10 offset:12288
ds_read_b64_tr_b16 a[114:115], v10 offset:13312
v_exp_f32 v50, v50
v_add_f32 v34, v34, v49
v_cvt_pk_bf16_f32 v80, v48, v49
v_mfma_f32_32x32x16_bf16 v[176:191], a[116:119], v[92:95], v[176:191]
ds_read_b64_tr_b16 a[116:117], v11 offset:12288
ds_read_b64_tr_b16 a[118:119], v11 offset:13312
v_exp_f32 v51, v51
v_add_f32 v34, v34, v50
v_accvgpr_read_b32 v14, a216
v_mfma_f32_32x32x16_bf16 v[208:223], a[120:123], v[92:95], v[208:223]
ds_read_b64_tr_b16 a[120:121], v12 offset:12288
ds_read_b64_tr_b16 a[122:123], v12 offset:13312
v_exp_f32 v52, v52
v_add_f32 v34, v34, v51
v_cvt_pk_bf16_f32 v81, v50, v51
v_mfma_f32_32x32x16_bf16 v[240:255], a[124:127], v[92:95], v[240:255]
ds_read_b64_tr_b16 a[124:125], v13 offset:12288
ds_read_b64_tr_b16 a[126:127], v13 offset:13312
v_exp_f32 v53, v53
v_add_f32 v34, v34, v52
v_accvgpr_read_b32 v15, a217
s_waitcnt vmcnt(24)
s_barrier
v_mfma_f32_32x32x16_bf16 v[64:79], a[64:67], a[4:7], v[112:127]
ds_read_b128 a[64:67], v2 offset:16384
v_exp_f32 v54, v54
v_add_f32 v34, v34, v53
v_cvt_pk_bf16_f32 v82, v52, v53
v_accvgpr_read_b32 v16, a218
v_mfma_f32_32x32x16_bf16 v[64:79], a[68:71], a[12:15], v[64:79]
ds_read_b128 a[68:71], v3 offset:16384
v_exp_f32 v55, v55
v_add_f32 v34, v34, v54
v_accvgpr_read_b32 v17, a219
v_mul_f32 v14, s35, v14
v_mfma_f32_32x32x16_bf16 v[64:79], a[72:75], a[20:23], v[64:79]
ds_read_b128 a[72:75], v4 offset:16384
v_exp_f32 v56, v56
v_add_f32 v34, v34, v55
v_cvt_pk_bf16_f32 v83, v54, v55
v_mul_f32 v15, s35, v15
v_mfma_f32_32x32x16_bf16 v[64:79], a[76:79], a[28:31], v[64:79]
ds_read_b128 a[76:79], v5 offset:16384
v_exp_f32 v57, v57
v_add_f32 v34, v34, v56
v_mul_f32 v16, s35, v16
v_mul_f32 v17, s35, v17
v_mfma_f32_32x32x16_bf16 v[64:79], a[80:83], a[36:39], v[64:79]
ds_read_b128 a[80:83], v6 offset:16384
v_exp_f32 v58, v58
v_add_f32 v34, v34, v57
v_cvt_pk_bf16_f32 v84, v56, v57
v_cvt_pk_bf16_f32 v14, v14, v15
v_mfma_f32_32x32x16_bf16 v[64:79], a[84:87], a[44:47], v[64:79]
ds_read_b128 a[84:87], v7 offset:16384
v_exp_f32 v59, v59
v_add_f32 v34, v34, v58
v_cvt_pk_bf16_f32 v16, v16, v17
v_accvgpr_write_b32 a172, v14
v_mfma_f32_32x32x16_bf16 v[64:79], a[88:91], a[52:55], v[64:79]
ds_read_b128 a[88:91], v8 offset:16384
v_exp_f32 v60, v60
v_add_f32 v34, v34, v59
v_cvt_pk_bf16_f32 v85, v58, v59
v_accvgpr_write_b32 a173, v16
v_mfma_f32_32x32x16_bf16 v[64:79], a[92:95], a[60:63], v[64:79]
ds_read_b128 a[92:95], v9 offset:16384
v_exp_f32 v61, v61
v_add_f32 v34, v34, v60
v_accvgpr_read_b32 v14, a220
v_accvgpr_read_b32 v15, a221
s_waitcnt lgkmcnt(8)
v_mfma_f32_32x32x16_bf16 v[128:143], a[96:99], v[80:83], v[128:143]
v_exp_f32 v62, v62
v_add_f32 v34, v34, v61
v_cvt_pk_bf16_f32 v86, v60, v61
v_accvgpr_read_b32 v16, a222
v_accvgpr_read_b32 v17, a223
v_mfma_f32_32x32x16_bf16 v[160:175], a[100:103], v[80:83], v[160:175]
v_exp_f32 v63, v63
v_add_f32 v34, v34, v62
s_add_u32 m0, s27, 8192
v_mul_f32 v14, s35, v14
v_mul_f32 v15, s35, v15
v_mfma_f32_32x32x16_bf16 v[192:207], a[104:107], v[80:83], v[192:207]
v_exp_f32 v64, v64
v_add_f32 v34, v34, v63
v_cvt_pk_bf16_f32 v87, v62, v63
v_mul_f32 v16, s35, v16
v_mul_f32 v17, s35, v17
v_mfma_f32_32x32x16_bf16 v[224:239], a[108:111], v[80:83], v[224:239]
buffer_load_dwordx4 v22, s[12:15], s58 offen nt lds
v_exp_f32 v65, v65
v_add_f32 v35, v35, v64
v_cvt_pk_bf16_f32 v14, v14, v15
v_mfma_f32_32x32x16_bf16 v[128:143], a[112:115], v[84:87], v[128:143]
v_exp_f32 v66, v66
v_add_f32 v35, v35, v65
v_cvt_pk_bf16_f32 v88, v64, v65
v_cvt_pk_bf16_f32 v16, v16, v17
v_accvgpr_write_b32 a174, v14
v_mfma_f32_32x32x16_bf16 v[160:175], a[116:119], v[84:87], v[160:175]
buffer_load_dwordx4 v23, s[12:15], s58 offen offset:1024 nt lds
v_exp_f32 v67, v67
v_add_f32 v35, v35, v66
v_accvgpr_write_b32 a175, v16
v_mfma_f32_32x32x16_bf16 v[192:207], a[120:123], v[84:87], v[192:207]
v_exp_f32 v68, v68
v_add_f32 v35, v35, v67
v_cvt_pk_bf16_f32 v89, v66, v67
s_add_u32 s58, s58, 8192
v_accvgpr_read_b32 v14, a224
v_mfma_f32_32x32x16_bf16 v[224:239], a[124:127], v[84:87], v[224:239]
v_exp_f32 v69, v69
v_add_f32 v35, v35, v68
s_add_u32 m0, s30, 0
v_accvgpr_read_b32 v15, a225
v_accvgpr_read_b32 v16, a226
s_waitcnt lgkmcnt(0)
v_mfma_f32_32x32x16_bf16 v[48:63], a[64:67], a[0:3], v[96:111]
v_exp_f32 v70, v70
v_add_f32 v35, v35, v69
v_cvt_pk_bf16_f32 v90, v68, v69
v_accvgpr_read_b32 v17, a227
v_mul_f32 v14, s35, v14
v_mfma_f32_32x32x16_bf16 v[48:63], a[68:71], a[8:11], v[48:63]
buffer_load_dwordx4 v24, s[16:19], s59 offen nt lds
v_exp_f32 v71, v71
v_add_f32 v35, v35, v70
v_mul_f32 v15, s35, v15
v_mfma_f32_32x32x16_bf16 v[48:63], a[72:75], a[16:19], v[48:63]
v_exp_f32 v72, v72
v_add_f32 v35, v35, v71
v_cvt_pk_bf16_f32 v91, v70, v71
v_mul_f32 v16, s35, v16
v_mul_f32 v17, s35, v17
v_mfma_f32_32x32x16_bf16 v[48:63], a[76:79], a[24:27], v[48:63]
buffer_load_dwordx4 v24, s[16:19], s59 offen offset:1024 nt lds
v_exp_f32 v73, v73
v_add_f32 v35, v35, v72
v_cvt_pk_bf16_f32 v14, v14, v15
v_mfma_f32_32x32x16_bf16 v[48:63], a[80:83], a[32:35], v[48:63]
v_exp_f32 v74, v74
v_add_f32 v35, v35, v73
v_cvt_pk_bf16_f32 v92, v72, v73
s_add_u32 s59, s59, 8192
v_cvt_pk_bf16_f32 v16, v16, v17
v_mfma_f32_32x32x16_bf16 v[48:63], a[84:87], a[40:43], v[48:63]
v_exp_f32 v75, v75
v_add_f32 v35, v35, v74
v_accvgpr_write_b32 a176, v14
v_accvgpr_write_b32 a177, v16
v_accvgpr_read_b32 v14, a228
v_mfma_f32_32x32x16_bf16 v[48:63], a[88:91], a[48:51], v[48:63]
v_exp_f32 v76, v76
v_add_f32 v35, v35, v75
v_cvt_pk_bf16_f32 v93, v74, v75
v_accvgpr_read_b32 v15, a229
v_accvgpr_read_b32 v16, a230
v_mfma_f32_32x32x16_bf16 v[48:63], a[92:95], a[56:59], v[48:63]
v_exp_f32 v77, v77
v_add_f32 v35, v35, v76
v_accvgpr_read_b32 v17, a231
v_mul_f32 v14, s35, v14
v_mul_f32 v15, s35, v15
s_lshr_b32 s94, s2, 5
s_xor_b32 s94, s94, s2
s_and_b32 s94, s94, 1
s_mul_i32 s94, s94, 33
s_xor_b32 s63, s2, s94
s_getpc_b64 s[94:95]
Lpc_p1:
s_add_u32 s94, s94, L1_pf1-Lpc_p1
s_addc_u32 s95, s95, 0
s_bfe_u32 s63, s63, 0x40003
s_lshl_b32 s63, s63, 2
s_add_u32 s63, s63, s24
s_mul_i32 s63, s63, 4
v_and_b32 v47, 63, v0
v_add_u32 v47, s63, v47
v_lshlrev_b32 v47, 7, v47
s_mov_b32 s63, L1_pf2-L1_pf1-4
v_min_u32 v47, s63, v47
s_mov_b64 exec, 15
global_load_dword v47, v47, s[94:95]
s_mov_b64 exec, -1
v_mfma_f32_32x32x16_bf16 v[144:159], a[96:99], v[88:91], v[144:159]
ds_read_b64_tr_b16 a[96:97], v10 offset:16384
ds_read_b64_tr_b16 a[98:99], v10 offset:17408
v_exp_f32 v78, v78
v_add_f32 v35, v35, v77
v_cvt_pk_bf16_f32 v94, v76, v77
v_mfma_f32_32x32x16_bf16 v[176:191], a[100:103], v[88:91], v[176:191]
ds_read_b64_tr_b16 a[100:101], v11 offset:16384
ds_read_b64_tr_b16 a[102:103], v11 offset:17408
v_exp_f32 v79, v79
v_add_f32 v35, v35, v78
v_mul_f32 v16, s35, v16
v_mfma_f32_32x32x16_bf16 v[208:223], a[104:107], v[88:91], v[208:223]
ds_read_b64_tr_b16 a[104:105], v12 offset:16384
ds_read_b64_tr_b16 a[106:107], v12 offset:17408
v_exp_f32 v48, v48
v_add_f32 v35, v35, v79
v_cvt_pk_bf16_f32 v95, v78, v79
v_mfma_f32_32x32x16_bf16 v[240:255], a[108:111], v[88:91], v[240:255]
ds_read_b64_tr_b16 a[108:109], v13 offset:16384
ds_read_b64_tr_b16 a[110:111], v13 offset:17408
v_exp_f32 v49, v49
v_add_f32 v34, v34, v48
v_mul_f32 v17, s35, v17
v_mfma_f32_32x32x16_bf16 v[144:159], a[112:115], v[92:95], v[144:159]
ds_read_b64_tr_b16 a[112:113], v10 offset:20480
ds_read_b64_tr_b16 a[114:115], v10 offset:21504
v_exp_f32 v50, v50
v_add_f32 v34, v34, v49
v_cvt_pk_bf16_f32 v80, v48, v49
v_mfma_f32_32x32x16_bf16 v[176:191], a[116:119], v[92:95], v[176:191]
ds_read_b64_tr_b16 a[116:117], v11 offset:20480
ds_read_b64_tr_b16 a[118:119], v11 offset:21504
v_exp_f32 v51, v51
v_add_f32 v34, v34, v50
v_cvt_pk_bf16_f32 v14, v14, v15
v_mfma_f32_32x32x16_bf16 v[208:223], a[120:123], v[92:95], v[208:223]
ds_read_b64_tr_b16 a[120:121], v12 offset:20480
ds_read_b64_tr_b16 a[122:123], v12 offset:21504
v_exp_f32 v52, v52
v_add_f32 v34, v34, v51
v_cvt_pk_bf16_f32 v81, v50, v51
v_mfma_f32_32x32x16_bf16 v[240:255], a[124:127], v[92:95], v[240:255]
ds_read_b64_tr_b16 a[124:125], v13 offset:20480
ds_read_b64_tr_b16 a[126:127], v13 offset:21504
v_exp_f32 v53, v53
v_add_f32 v34, v34, v52
v_cvt_pk_bf16_f32 v16, v16, v17
s_waitcnt vmcnt(25)
s_barrier
v_mfma_f32_32x32x16_bf16 v[64:79], a[64:67], a[4:7], v[112:127]
ds_read_b128 a[64:67], v2 offset:24576
v_exp_f32 v54, v54
v_add_f32 v34, v34, v53
v_cvt_pk_bf16_f32 v82, v52, v53
v_accvgpr_write_b32 a178, v14
v_mfma_f32_32x32x16_bf16 v[64:79], a[68:71], a[12:15], v[64:79]
ds_read_b128 a[68:71], v3 offset:24576
v_exp_f32 v55, v55
v_add_f32 v34, v34, v54
v_accvgpr_write_b32 a179, v16
v_accvgpr_read_b32 v14, a232
v_mfma_f32_32x32x16_bf16 v[64:79], a[72:75], a[20:23], v[64:79]
ds_read_b128 a[72:75], v4 offset:24576
v_exp_f32 v56, v56
v_add_f32 v34, v34, v55
v_cvt_pk_bf16_f32 v83, v54, v55
v_accvgpr_read_b32 v15, a233
v_mfma_f32_32x32x16_bf16 v[64:79], a[76:79], a[28:31], v[64:79]
ds_read_b128 a[76:79], v5 offset:24576
v_exp_f32 v57, v57
v_add_f32 v34, v34, v56
v_accvgpr_read_b32 v16, a234
v_accvgpr_read_b32 v17, a235
v_mfma_f32_32x32x16_bf16 v[64:79], a[80:83], a[36:39], v[64:79]
ds_read_b128 a[80:83], v6 offset:24576
v_exp_f32 v58, v58
v_add_f32 v34, v34, v57
v_cvt_pk_bf16_f32 v84, v56, v57
v_mul_f32 v14, s35, v14
v_mfma_f32_32x32x16_bf16 v[64:79], a[84:87], a[44:47], v[64:79]
ds_read_b128 a[84:87], v7 offset:24576
v_exp_f32 v59, v59
v_add_f32 v34, v34, v58
v_mul_f32 v15, s35, v15
v_mul_f32 v16, s35, v16
v_mfma_f32_32x32x16_bf16 v[64:79], a[88:91], a[52:55], v[64:79]
ds_read_b128 a[88:91], v8 offset:24576
v_exp_f32 v60, v60
v_add_f32 v34, v34, v59
v_cvt_pk_bf16_f32 v85, v58, v59
v_mul_f32 v17, s35, v17
v_mfma_f32_32x32x16_bf16 v[64:79], a[92:95], a[60:63], v[64:79]
ds_read_b128 a[92:95], v9 offset:24576
v_exp_f32 v61, v61
v_add_f32 v34, v34, v60
v_cvt_pk_bf16_f32 v14, v14, v15
v_cvt_pk_bf16_f32 v16, v16, v17
s_waitcnt lgkmcnt(8)
v_mfma_f32_32x32x16_bf16 v[128:143], a[96:99], v[80:83], v[128:143]
v_exp_f32 v62, v62
v_add_f32 v34, v34, v61
v_cvt_pk_bf16_f32 v86, v60, v61
v_accvgpr_write_b32 a180, v14
v_accvgpr_write_b32 a181, v16
v_mfma_f32_32x32x16_bf16 v[160:175], a[100:103], v[80:83], v[160:175]
v_exp_f32 v63, v63
v_add_f32 v34, v34, v62
s_add_u32 m0, s27, 16384
v_accvgpr_read_b32 v14, a236
v_accvgpr_read_b32 v15, a237
v_mfma_f32_32x32x16_bf16 v[192:207], a[104:107], v[80:83], v[192:207]
v_exp_f32 v64, v64
v_add_f32 v34, v34, v63
v_cvt_pk_bf16_f32 v87, v62, v63
v_accvgpr_read_b32 v16, a238
v_accvgpr_read_b32 v17, a239
v_mfma_f32_32x32x16_bf16 v[224:239], a[108:111], v[80:83], v[224:239]
buffer_load_dwordx4 v22, s[12:15], s58 offen nt lds
v_exp_f32 v65, v65
v_add_f32 v35, v35, v64
v_mul_f32 v14, s35, v14
v_mfma_f32_32x32x16_bf16 v[128:143], a[112:115], v[84:87], v[128:143]
v_exp_f32 v66, v66
v_add_f32 v35, v35, v65
v_cvt_pk_bf16_f32 v88, v64, v65
v_mul_f32 v15, s35, v15
v_mul_f32 v16, s35, v16
v_mfma_f32_32x32x16_bf16 v[160:175], a[116:119], v[84:87], v[160:175]
buffer_load_dwordx4 v23, s[12:15], s58 offen offset:1024 nt lds
v_exp_f32 v67, v67
v_add_f32 v35, v35, v66
v_mul_f32 v17, s35, v17
v_mfma_f32_32x32x16_bf16 v[192:207], a[120:123], v[84:87], v[192:207]
v_exp_f32 v68, v68
v_add_f32 v35, v35, v67
v_cvt_pk_bf16_f32 v89, v66, v67
s_add_u32 s58, s58, 8192
v_cvt_pk_bf16_f32 v14, v14, v15
v_mfma_f32_32x32x16_bf16 v[224:239], a[124:127], v[84:87], v[224:239]
v_exp_f32 v69, v69
v_add_f32 v35, v35, v68
s_add_u32 m0, s30, 8192
v_cvt_pk_bf16_f32 v16, v16, v17
v_accvgpr_write_b32 a182, v14
s_waitcnt lgkmcnt(0)
v_mfma_f32_32x32x16_bf16 v[48:63], a[64:67], a[0:3], v[96:111]
v_exp_f32 v70, v70
v_add_f32 v35, v35, v69
v_cvt_pk_bf16_f32 v90, v68, v69
v_accvgpr_write_b32 a183, v16
v_accvgpr_read_b32 v14, a240
v_mfma_f32_32x32x16_bf16 v[48:63], a[68:71], a[8:11], v[48:63]
buffer_load_dwordx4 v24, s[16:19], s59 offen nt lds
v_exp_f32 v71, v71
v_add_f32 v35, v35, v70
v_accvgpr_read_b32 v15, a241
v_mfma_f32_32x32x16_bf16 v[48:63], a[72:75], a[16:19], v[48:63]
v_exp_f32 v72, v72
v_add_f32 v35, v35, v71
v_cvt_pk_bf16_f32 v91, v70, v71
v_accvgpr_read_b32 v16, a242
v_accvgpr_read_b32 v17, a243
v_mfma_f32_32x32x16_bf16 v[48:63], a[76:79], a[24:27], v[48:63]
buffer_load_dwordx4 v24, s[16:19], s59 offen offset:1024 nt lds
v_exp_f32 v73, v73
v_add_f32 v35, v35, v72
v_mul_f32 v14, s35, v14
v_mfma_f32_32x32x16_bf16 v[48:63], a[80:83], a[32:35], v[48:63]
v_exp_f32 v74, v74
v_add_f32 v35, v35, v73
v_cvt_pk_bf16_f32 v92, v72, v73
s_add_u32 s59, s59, 8192
v_mul_f32 v15, s35, v15
v_mfma_f32_32x32x16_bf16 v[48:63], a[84:87], a[40:43], v[48:63]
v_exp_f32 v75, v75
v_add_f32 v35, v35, v74
v_mul_f32 v16, s35, v16
v_mul_f32 v17, s35, v17
v_cvt_pk_bf16_f32 v14, v14, v15
v_mfma_f32_32x32x16_bf16 v[48:63], a[88:91], a[48:51], v[48:63]
v_exp_f32 v76, v76
v_add_f32 v35, v35, v75
v_cvt_pk_bf16_f32 v93, v74, v75
v_cvt_pk_bf16_f32 v16, v16, v17
v_accvgpr_write_b32 a184, v14
v_mfma_f32_32x32x16_bf16 v[48:63], a[92:95], a[56:59], v[48:63]
v_exp_f32 v77, v77
v_add_f32 v35, v35, v76
v_accvgpr_write_b32 a185, v16
v_accvgpr_read_b32 v14, a244
v_accvgpr_read_b32 v15, a245
v_mfma_f32_32x32x16_bf16 v[144:159], a[96:99], v[88:91], v[144:159]
ds_read_b64_tr_b16 a[96:97], v10 offset:24576
ds_read_b64_tr_b16 a[98:99], v10 offset:25600
v_exp_f32 v78, v78
v_add_f32 v35, v35, v77
v_cvt_pk_bf16_f32 v94, v76, v77
v_mfma_f32_32x32x16_bf16 v[176:191], a[100:103], v[88:91], v[176:191]
ds_read_b64_tr_b16 a[100:101], v11 offset:24576
ds_read_b64_tr_b16 a[102:103], v11 offset:25600
v_exp_f32 v79, v79
v_add_f32 v35, v35, v78
v_accvgpr_read_b32 v16, a246
v_mfma_f32_32x32x16_bf16 v[208:223], a[104:107], v[88:91], v[208:223]
ds_read_b64_tr_b16 a[104:105], v12 offset:24576
ds_read_b64_tr_b16 a[106:107], v12 offset:25600
v_exp_f32 v48, v48
v_add_f32 v35, v35, v79
v_cvt_pk_bf16_f32 v95, v78, v79
v_mfma_f32_32x32x16_bf16 v[240:255], a[108:111], v[88:91], v[240:255]
ds_read_b64_tr_b16 a[108:109], v13 offset:24576
ds_read_b64_tr_b16 a[110:111], v13 offset:25600
v_exp_f32 v49, v49
v_add_f32 v34, v34, v48
v_accvgpr_read_b32 v17, a247
v_mfma_f32_32x32x16_bf16 v[144:159], a[112:115], v[92:95], v[144:159]
ds_read_b64_tr_b16 a[112:113], v10 offset:28672
ds_read_b64_tr_b16 a[114:115], v10 offset:29696
v_exp_f32 v50, v50
v_add_f32 v34, v34, v49
v_cvt_pk_bf16_f32 v80, v48, v49
v_mfma_f32_32x32x16_bf16 v[176:191], a[116:119], v[92:95], v[176:191]
ds_read_b64_tr_b16 a[116:117], v11 offset:28672
ds_read_b64_tr_b16 a[118:119], v11 offset:29696
v_exp_f32 v51, v51
v_add_f32 v34, v34, v50
v_mul_f32 v14, s35, v14
v_mfma_f32_32x32x16_bf16 v[208:223], a[120:123], v[92:95], v[208:223]
ds_read_b64_tr_b16 a[120:121], v12 offset:28672
ds_read_b64_tr_b16 a[122:123], v12 offset:29696
v_exp_f32 v52, v52
v_add_f32 v34, v34, v51
v_cvt_pk_bf16_f32 v81, v50, v51
v_mfma_f32_32x32x16_bf16 v[240:255], a[124:127], v[92:95], v[240:255]
ds_read_b64_tr_b16 a[124:125], v13 offset:28672
ds_read_b64_tr_b16 a[126:127], v13 offset:29696
v_exp_f32 v53, v53
v_add_f32 v34, v34, v52
v_mul_f32 v15, s35, v15
s_waitcnt vmcnt(17)
s_barrier
s_cmp_lg_u32 s24, 0
s_cbranch_scc1 L_rdy
v_mov_b32 v44, s92
v_mov_b32 v45, 1
s_mov_b64 exec, 1
global_store_byte v44, v45, s[90:91] sc1
s_mov_b64 exec, -1
L_rdy:
v_mfma_f32_32x32x16_bf16 v[64:79], a[64:67], a[4:7], v[112:127]
ds_read_b128 a[64:67], v2 offset:49152
v_exp_f32 v54, v54
v_add_f32 v34, v34, v53
v_cvt_pk_bf16_f32 v82, v52, v53
v_mul_f32 v16, s35, v16
v_mfma_f32_32x32x16_bf16 v[64:79], a[68:71], a[12:15], v[64:79]
ds_read_b128 a[68:71], v3 offset:49152
v_exp_f32 v55, v55
v_add_f32 v34, v34, v54
v_mul_f32 v17, s35, v17
v_cvt_pk_bf16_f32 v14, v14, v15
v_mfma_f32_32x32x16_bf16 v[64:79], a[72:75], a[20:23], v[64:79]
ds_read_b128 a[72:75], v4 offset:49152
v_exp_f32 v56, v56
v_add_f32 v34, v34, v55
v_cvt_pk_bf16_f32 v83, v54, v55
v_cvt_pk_bf16_f32 v16, v16, v17
v_mfma_f32_32x32x16_bf16 v[64:79], a[76:79], a[28:31], v[64:79]
ds_read_b128 a[76:79], v5 offset:49152
v_exp_f32 v57, v57
v_add_f32 v34, v34, v56
v_accvgpr_write_b32 a186, v14
v_accvgpr_write_b32 a187, v16
v_mfma_f32_32x32x16_bf16 v[64:79], a[80:83], a[36:39], v[64:79]
ds_read_b128 a[80:83], v6 offset:49152
v_exp_f32 v58, v58
v_add_f32 v34, v34, v57
v_cvt_pk_bf16_f32 v84, v56, v57
v_accvgpr_read_b32 v14, a248
v_mfma_f32_32x32x16_bf16 v[64:79], a[84:87], a[44:47], v[64:79]
ds_read_b128 a[84:87], v7 offset:49152
v_exp_f32 v59, v59
v_add_f32 v34, v34, v58
v_accvgpr_read_b32 v15, a249
v_accvgpr_read_b32 v16, a250
v_mfma_f32_32x32x16_bf16 v[64:79], a[88:91], a[52:55], v[64:79]
ds_read_b128 a[88:91], v8 offset:49152
v_exp_f32 v60, v60
v_add_f32 v34, v34, v59
v_cvt_pk_bf16_f32 v85, v58, v59
v_accvgpr_read_b32 v17, a251
v_mfma_f32_32x32x16_bf16 v[64:79], a[92:95], a[60:63], v[64:79]
ds_read_b128 a[92:95], v9 offset:49152
v_exp_f32 v61, v61
v_add_f32 v34, v34, v60
v_mul_f32 v14, s35, v14
v_mul_f32 v15, s35, v15
s_waitcnt lgkmcnt(8)
v_mfma_f32_32x32x16_bf16 v[128:143], a[96:99], v[80:83], v[128:143]
v_exp_f32 v62, v62
v_add_f32 v34, v34, v61
v_cvt_pk_bf16_f32 v86, v60, v61
v_mul_f32 v16, s35, v16
v_mul_f32 v17, s35, v17
v_mfma_f32_32x32x16_bf16 v[160:175], a[100:103], v[80:83], v[160:175]
v_exp_f32 v63, v63
v_add_f32 v34, v34, v62
s_add_u32 m0, s27, 24576
v_cvt_pk_bf16_f32 v14, v14, v15
v_cvt_pk_bf16_f32 v16, v16, v17
v_mfma_f32_32x32x16_bf16 v[192:207], a[104:107], v[80:83], v[192:207]
v_exp_f32 v64, v64
v_add_f32 v34, v34, v63
v_cvt_pk_bf16_f32 v87, v62, v63
v_accvgpr_write_b32 a188, v14
v_accvgpr_write_b32 a189, v16
v_mfma_f32_32x32x16_bf16 v[224:239], a[108:111], v[80:83], v[224:239]
buffer_load_dwordx4 v22, s[12:15], s58 offen nt lds
v_exp_f32 v65, v65
v_add_f32 v35, v35, v64
v_accvgpr_read_b32 v14, a252
v_mfma_f32_32x32x16_bf16 v[128:143], a[112:115], v[84:87], v[128:143]
v_exp_f32 v66, v66
v_add_f32 v35, v35, v65
v_cvt_pk_bf16_f32 v88, v64, v65
v_accvgpr_read_b32 v15, a253
v_accvgpr_read_b32 v16, a254
v_mfma_f32_32x32x16_bf16 v[160:175], a[116:119], v[84:87], v[160:175]
buffer_load_dwordx4 v23, s[12:15], s58 offen offset:1024 nt lds
v_exp_f32 v67, v67
v_add_f32 v35, v35, v66
v_accvgpr_read_b32 v17, a255
v_mfma_f32_32x32x16_bf16 v[192:207], a[120:123], v[84:87], v[192:207]
v_exp_f32 v68, v68
v_add_f32 v35, v35, v67
v_cvt_pk_bf16_f32 v89, v66, v67
s_add_u32 s58, s58, 8192
v_mul_f32 v14, s35, v14
v_mfma_f32_32x32x16_bf16 v[224:239], a[124:127], v[84:87], v[224:239]
v_exp_f32 v69, v69
v_add_f32 v35, v35, v68
s_add_u32 m0, s30, 16384
v_mul_f32 v15, s35, v15
v_mul_f32 v16, s35, v16
s_waitcnt lgkmcnt(0)
v_mfma_f32_32x32x16_bf16 v[48:63], a[64:67], a[0:3], v[96:111]
v_exp_f32 v70, v70
v_add_f32 v35, v35, v69
v_cvt_pk_bf16_f32 v90, v68, v69
v_mul_f32 v17, s35, v17
v_cvt_pk_bf16_f32 v14, v14, v15
v_mfma_f32_32x32x16_bf16 v[48:63], a[68:71], a[8:11], v[48:63]
buffer_load_dwordx4 v24, s[16:19], s59 offen nt lds
v_exp_f32 v71, v71
v_add_f32 v35, v35, v70
v_cvt_pk_bf16_f32 v16, v16, v17
v_mfma_f32_32x32x16_bf16 v[48:63], a[72:75], a[16:19], v[48:63]
v_exp_f32 v72, v72
v_add_f32 v35, v35, v71
v_cvt_pk_bf16_f32 v91, v70, v71
v_accvgpr_write_b32 a190, v14
v_accvgpr_write_b32 a191, v16
v_mfma_f32_32x32x16_bf16 v[48:63], a[76:79], a[24:27], v[48:63]
buffer_load_dwordx4 v24, s[16:19], s59 offen offset:1024 nt lds
v_exp_f32 v73, v73
v_add_f32 v35, v35, v72
v_mfma_f32_32x32x16_bf16 v[48:63], a[80:83], a[32:35], v[48:63]
v_exp_f32 v74, v74
v_add_f32 v35, v35, v73
v_cvt_pk_bf16_f32 v92, v72, v73
s_add_u32 s59, s59, 8192
v_mfma_f32_32x32x16_bf16 v[48:63], a[84:87], a[40:43], v[48:63]
v_exp_f32 v75, v75
v_add_f32 v35, v35, v74
v_mfma_f32_32x32x16_bf16 v[48:63], a[88:91], a[48:51], v[48:63]
v_exp_f32 v76, v76
v_add_f32 v35, v35, v75
v_cvt_pk_bf16_f32 v93, v74, v75
v_mfma_f32_32x32x16_bf16 v[48:63], a[92:95], a[56:59], v[48:63]
v_exp_f32 v77, v77
v_add_f32 v35, v35, v76
v_mfma_f32_32x32x16_bf16 v[144:159], a[96:99], v[88:91], v[144:159]
ds_read_b64_tr_b16 a[96:97], v10 offset:49152
ds_read_b64_tr_b16 a[98:99], v10 offset:50176
v_exp_f32 v78, v78
v_add_f32 v35, v35, v77
v_cvt_pk_bf16_f32 v94, v76, v77
v_mfma_f32_32x32x16_bf16 v[176:191], a[100:103], v[88:91], v[176:191]
ds_read_b64_tr_b16 a[100:101], v11 offset:49152
ds_read_b64_tr_b16 a[102:103], v11 offset:50176
v_exp_f32 v79, v79
v_add_f32 v35, v35, v78
v_mfma_f32_32x32x16_bf16 v[208:223], a[104:107], v[88:91], v[208:223]
ds_read_b64_tr_b16 a[104:105], v12 offset:49152
ds_read_b64_tr_b16 a[106:107], v12 offset:50176
v_exp_f32 v48, v48
v_add_f32 v35, v35, v79
v_cvt_pk_bf16_f32 v95, v78, v79
v_mfma_f32_32x32x16_bf16 v[240:255], a[108:111], v[88:91], v[240:255]
ds_read_b64_tr_b16 a[108:109], v13 offset:49152
ds_read_b64_tr_b16 a[110:111], v13 offset:50176
v_exp_f32 v49, v49
v_add_f32 v34, v34, v48
v_mfma_f32_32x32x16_bf16 v[144:159], a[112:115], v[92:95], v[144:159]
ds_read_b64_tr_b16 a[112:113], v10 offset:53248
ds_read_b64_tr_b16 a[114:115], v10 offset:54272
v_exp_f32 v50, v50
v_add_f32 v34, v34, v49
v_cvt_pk_bf16_f32 v80, v48, v49
v_mfma_f32_32x32x16_bf16 v[176:191], a[116:119], v[92:95], v[176:191]
ds_read_b64_tr_b16 a[116:117], v11 offset:53248
ds_read_b64_tr_b16 a[118:119], v11 offset:54272
v_exp_f32 v51, v51
v_add_f32 v34, v34, v50
v_mfma_f32_32x32x16_bf16 v[208:223], a[120:123], v[92:95], v[208:223]
ds_read_b64_tr_b16 a[120:121], v12 offset:53248
ds_read_b64_tr_b16 a[122:123], v12 offset:54272
v_exp_f32 v52, v52
v_add_f32 v34, v34, v51
v_cvt_pk_bf16_f32 v81, v50, v51
v_mfma_f32_32x32x16_bf16 v[240:255], a[124:127], v[92:95], v[240:255]
ds_read_b64_tr_b16 a[124:125], v13 offset:53248
ds_read_b64_tr_b16 a[126:127], v13 offset:54272
v_exp_f32 v53, v53
v_add_f32 v34, v34, v52
s_waitcnt vmcnt(63)
s_barrier
v_mfma_f32_32x32x16_bf16 v[64:79], a[64:67], a[4:7], v[112:127]
ds_read_b128 a[64:67], v2 offset:57344
v_exp_f32 v54, v54
v_add_f32 v34, v34, v53
v_cvt_pk_bf16_f32 v82, v52, v53
v_mfma_f32_32x32x16_bf16 v[64:79], a[68:71], a[12:15], v[64:79]
ds_read_b128 a[68:71], v3 offset:57344
v_exp_f32 v55, v55
v_add_f32 v34, v34, v54
v_mfma_f32_32x32x16_bf16 v[64:79], a[72:75], a[20:23], v[64:79]
ds_read_b128 a[72:75], v4 offset:57344
v_exp_f32 v56, v56
v_add_f32 v34, v34, v55
v_cvt_pk_bf16_f32 v83, v54, v55
v_mfma_f32_32x32x16_bf16 v[64:79], a[76:79], a[28:31], v[64:79]
ds_read_b128 a[76:79], v5 offset:57344
v_exp_f32 v57, v57
v_add_f32 v34, v34, v56
v_mfma_f32_32x32x16_bf16 v[64:79], a[80:83], a[36:39], v[64:79]
ds_read_b128 a[80:83], v6 offset:57344
v_exp_f32 v58, v58
v_add_f32 v34, v34, v57
v_cvt_pk_bf16_f32 v84, v56, v57
v_mfma_f32_32x32x16_bf16 v[64:79], a[84:87], a[44:47], v[64:79]
ds_read_b128 a[84:87], v7 offset:57344
v_exp_f32 v59, v59
v_add_f32 v34, v34, v58
v_mfma_f32_32x32x16_bf16 v[64:79], a[88:91], a[52:55], v[64:79]
ds_read_b128 a[88:91], v8 offset:57344
v_exp_f32 v60, v60
v_add_f32 v34, v34, v59
v_cvt_pk_bf16_f32 v85, v58, v59
v_mfma_f32_32x32x16_bf16 v[64:79], a[92:95], a[60:63], v[64:79]
ds_read_b128 a[92:95], v9 offset:57344
v_exp_f32 v61, v61
v_add_f32 v34, v34, v60
s_waitcnt lgkmcnt(8)
v_mfma_f32_32x32x16_bf16 v[128:143], a[96:99], v[80:83], v[128:143]
v_exp_f32 v62, v62
v_add_f32 v34, v34, v61
v_cvt_pk_bf16_f32 v86, v60, v61
v_mfma_f32_32x32x16_bf16 v[160:175], a[100:103], v[80:83], v[160:175]
v_exp_f32 v63, v63
v_add_f32 v34, v34, v62
s_add_u32 m0, s27, 49152
v_mfma_f32_32x32x16_bf16 v[192:207], a[104:107], v[80:83], v[192:207]
v_exp_f32 v64, v64
v_add_f32 v34, v34, v63
v_cvt_pk_bf16_f32 v87, v62, v63
v_mfma_f32_32x32x16_bf16 v[224:239], a[108:111], v[80:83], v[224:239]
buffer_load_dwordx4 v22, s[12:15], s58 offen nt lds
v_exp_f32 v65, v65
v_add_f32 v35, v35, v64
v_mfma_f32_32x32x16_bf16 v[128:143], a[112:115], v[84:87], v[128:143]
v_exp_f32 v66, v66
v_add_f32 v35, v35, v65
v_cvt_pk_bf16_f32 v88, v64, v65
v_mfma_f32_32x32x16_bf16 v[160:175], a[116:119], v[84:87], v[160:175]
buffer_load_dwordx4 v23, s[12:15], s58 offen offset:1024 nt lds
v_exp_f32 v67, v67
v_add_f32 v35, v35, v66
v_mfma_f32_32x32x16_bf16 v[192:207], a[120:123], v[84:87], v[192:207]
v_exp_f32 v68, v68
v_add_f32 v35, v35, v67
v_cvt_pk_bf16_f32 v89, v66, v67
s_add_u32 s58, s58, 8192
v_mfma_f32_32x32x16_bf16 v[224:239], a[124:127], v[84:87], v[224:239]
v_exp_f32 v69, v69
v_add_f32 v35, v35, v68
s_add_u32 m0, s30, 24576
s_waitcnt lgkmcnt(0)
v_mfma_f32_32x32x16_bf16 v[48:63], a[64:67], a[0:3], v[96:111]
v_exp_f32 v70, v70
v_add_f32 v35, v35, v69
v_cvt_pk_bf16_f32 v90, v68, v69
v_mfma_f32_32x32x16_bf16 v[48:63], a[68:71], a[8:11], v[48:63]
buffer_load_dwordx4 v24, s[16:19], s59 offen nt lds
v_exp_f32 v71, v71
v_add_f32 v35, v35, v70
v_mfma_f32_32x32x16_bf16 v[48:63], a[72:75], a[16:19], v[48:63]
v_exp_f32 v72, v72
v_add_f32 v35, v35, v71
v_cvt_pk_bf16_f32 v91, v70, v71
v_mfma_f32_32x32x16_bf16 v[48:63], a[76:79], a[24:27], v[48:63]
buffer_load_dwordx4 v24, s[16:19], s59 offen offset:1024 nt lds
v_exp_f32 v73, v73
v_add_f32 v35, v35, v72
v_mfma_f32_32x32x16_bf16 v[48:63], a[80:83], a[32:35], v[48:63]
v_exp_f32 v74, v74
v_add_f32 v35, v35, v73
v_cvt_pk_bf16_f32 v92, v72, v73
s_add_u32 s59, s59, 8192
v_mfma_f32_32x32x16_bf16 v[48:63], a[84:87], a[40:43], v[48:63]
v_exp_f32 v75, v75
v_add_f32 v35, v35, v74
v_mfma_f32_32x32x16_bf16 v[48:63], a[88:91], a[48:51], v[48:63]
v_exp_f32 v76, v76
v_add_f32 v35, v35, v75
v_cvt_pk_bf16_f32 v93, v74, v75
v_mfma_f32_32x32x16_bf16 v[48:63], a[92:95], a[56:59], v[48:63]
v_exp_f32 v77, v77
v_add_f32 v35, v35, v76
v_mfma_f32_32x32x16_bf16 v[144:159], a[96:99], v[88:91], v[144:159]
ds_read_b64_tr_b16 a[96:97], v10 offset:57344
ds_read_b64_tr_b16 a[98:99], v10 offset:58368
v_exp_f32 v78, v78
v_add_f32 v35, v35, v77
v_cvt_pk_bf16_f32 v94, v76, v77
v_mfma_f32_32x32x16_bf16 v[176:191], a[100:103], v[88:91], v[176:191]
ds_read_b64_tr_b16 a[100:101], v11 offset:57344
ds_read_b64_tr_b16 a[102:103], v11 offset:58368
v_exp_f32 v79, v79
v_add_f32 v35, v35, v78
v_mfma_f32_32x32x16_bf16 v[208:223], a[104:107], v[88:91], v[208:223]
ds_read_b64_tr_b16 a[104:105], v12 offset:57344
ds_read_b64_tr_b16 a[106:107], v12 offset:58368
v_exp_f32 v48, v48
v_add_f32 v35, v35, v79
v_cvt_pk_bf16_f32 v95, v78, v79
v_mfma_f32_32x32x16_bf16 v[240:255], a[108:111], v[88:91], v[240:255]
ds_read_b64_tr_b16 a[108:109], v13 offset:57344
ds_read_b64_tr_b16 a[110:111], v13 offset:58368
v_exp_f32 v49, v49
v_add_f32 v34, v34, v48
v_mfma_f32_32x32x16_bf16 v[144:159], a[112:115], v[92:95], v[144:159]
ds_read_b64_tr_b16 a[112:113], v10 offset:61440
ds_read_b64_tr_b16 a[114:115], v10 offset:62464
v_exp_f32 v50, v50
v_add_f32 v34, v34, v49
v_cvt_pk_bf16_f32 v80, v48, v49
v_mfma_f32_32x32x16_bf16 v[176:191], a[116:119], v[92:95], v[176:191]
ds_read_b64_tr_b16 a[116:117], v11 offset:61440
ds_read_b64_tr_b16 a[118:119], v11 offset:62464
v_exp_f32 v51, v51
v_add_f32 v34, v34, v50
v_mfma_f32_32x32x16_bf16 v[208:223], a[120:123], v[92:95], v[208:223]
ds_read_b64_tr_b16 a[120:121], v12 offset:61440
ds_read_b64_tr_b16 a[122:123], v12 offset:62464
v_exp_f32 v52, v52
v_add_f32 v34, v34, v51
v_cvt_pk_bf16_f32 v81, v50, v51
v_mfma_f32_32x32x16_bf16 v[240:255], a[124:127], v[92:95], v[240:255]
ds_read_b64_tr_b16 a[124:125], v13 offset:61440
ds_read_b64_tr_b16 a[126:127], v13 offset:62464
v_exp_f32 v53, v53
v_add_f32 v34, v34, v52
s_waitcnt vmcnt(21)
s_barrier
v_mfma_f32_32x32x16_bf16 v[64:79], a[64:67], a[4:7], v[112:127]
ds_read_b128 a[64:67], v2 offset:32768
v_exp_f32 v54, v54
v_add_f32 v34, v34, v53
v_cvt_pk_bf16_f32 v82, v52, v53
v_mfma_f32_32x32x16_bf16 v[64:79], a[68:71], a[12:15], v[64:79]
ds_read_b128 a[68:71], v3 offset:32768
v_exp_f32 v55, v55
v_add_f32 v34, v34, v54
v_mfma_f32_32x32x16_bf16 v[64:79], a[72:75], a[20:23], v[64:79]
ds_read_b128 a[72:75], v4 offset:32768
v_exp_f32 v56, v56
v_add_f32 v34, v34, v55
v_cvt_pk_bf16_f32 v83, v54, v55
v_mfma_f32_32x32x16_bf16 v[64:79], a[76:79], a[28:31], v[64:79]
ds_read_b128 a[76:79], v5 offset:32768
v_exp_f32 v57, v57
v_add_f32 v34, v34, v56
v_mfma_f32_32x32x16_bf16 v[64:79], a[80:83], a[36:39], v[64:79]
ds_read_b128 a[80:83], v6 offset:32768
v_exp_f32 v58, v58
v_add_f32 v34, v34, v57
v_cvt_pk_bf16_f32 v84, v56, v57
v_mfma_f32_32x32x16_bf16 v[64:79], a[84:87], a[44:47], v[64:79]
ds_read_b128 a[84:87], v7 offset:32768
v_exp_f32 v59, v59
v_add_f32 v34, v34, v58
v_mfma_f32_32x32x16_bf16 v[64:79], a[88:91], a[52:55], v[64:79]
ds_read_b128 a[88:91], v8 offset:32768
v_exp_f32 v60, v60
v_add_f32 v34, v34, v59
v_cvt_pk_bf16_f32 v85, v58, v59
v_mfma_f32_32x32x16_bf16 v[64:79], a[92:95], a[60:63], v[64:79]
ds_read_b128 a[92:95], v9 offset:32768
v_exp_f32 v61, v61
v_add_f32 v34, v34, v60
s_waitcnt lgkmcnt(8)
v_mfma_f32_32x32x16_bf16 v[128:143], a[96:99], v[80:83], v[128:143]
v_exp_f32 v62, v62
v_add_f32 v34, v34, v61
v_cvt_pk_bf16_f32 v86, v60, v61
v_mfma_f32_32x32x16_bf16 v[160:175], a[100:103], v[80:83], v[160:175]
v_exp_f32 v63, v63
v_add_f32 v34, v34, v62
s_add_u32 m0, s27, 57344
v_mfma_f32_32x32x16_bf16 v[192:207], a[104:107], v[80:83], v[192:207]
v_exp_f32 v64, v64
v_add_f32 v34, v34, v63
v_cvt_pk_bf16_f32 v87, v62, v63
v_mfma_f32_32x32x16_bf16 v[224:239], a[108:111], v[80:83], v[224:239]
buffer_load_dwordx4 v22, s[12:15], s58 offen nt lds
v_exp_f32 v65, v65
v_add_f32 v35, v35, v64
v_mfma_f32_32x32x16_bf16 v[128:143], a[112:115], v[84:87], v[128:143]
v_exp_f32 v66, v66
v_add_f32 v35, v35, v65
v_cvt_pk_bf16_f32 v88, v64, v65
v_mfma_f32_32x32x16_bf16 v[160:175], a[116:119], v[84:87], v[160:175]
buffer_load_dwordx4 v23, s[12:15], s58 offen offset:1024 nt lds
v_exp_f32 v67, v67
v_add_f32 v35, v35, v66
v_mfma_f32_32x32x16_bf16 v[192:207], a[120:123], v[84:87], v[192:207]
v_exp_f32 v68, v68
v_add_f32 v35, v35, v67
v_cvt_pk_bf16_f32 v89, v66, v67
s_add_u32 s58, s58, 8192
v_mfma_f32_32x32x16_bf16 v[224:239], a[124:127], v[84:87], v[224:239]
v_exp_f32 v69, v69
v_add_f32 v35, v35, v68
s_add_u32 m0, s30, 49152
s_waitcnt lgkmcnt(0)
v_mfma_f32_32x32x16_bf16 v[48:63], a[64:67], a[0:3], v[96:111]
v_exp_f32 v70, v70
v_add_f32 v35, v35, v69
v_cvt_pk_bf16_f32 v90, v68, v69
v_mfma_f32_32x32x16_bf16 v[48:63], a[68:71], a[8:11], v[48:63]
buffer_load_dwordx4 v24, s[16:19], s59 offen nt lds
v_exp_f32 v71, v71
v_add_f32 v35, v35, v70
v_mfma_f32_32x32x16_bf16 v[48:63], a[72:75], a[16:19], v[48:63]
v_exp_f32 v72, v72
v_add_f32 v35, v35, v71
v_cvt_pk_bf16_f32 v91, v70, v71
v_mfma_f32_32x32x16_bf16 v[48:63], a[76:79], a[24:27], v[48:63]
buffer_load_dwordx4 v24, s[16:19], s59 offen offset:1024 nt lds
v_exp_f32 v73, v73
v_add_f32 v35, v35, v72
v_mfma_f32_32x32x16_bf16 v[48:63], a[80:83], a[32:35], v[48:63]
v_exp_f32 v74, v74
v_add_f32 v35, v35, v73
v_cvt_pk_bf16_f32 v92, v72, v73
s_add_u32 s59, s59, 8192
v_mfma_f32_32x32x16_bf16 v[48:63], a[84:87], a[40:43], v[48:63]
v_exp_f32 v75, v75
v_add_f32 v35, v35, v74
v_mfma_f32_32x32x16_bf16 v[48:63], a[88:91], a[48:51], v[48:63]
v_exp_f32 v76, v76
v_add_f32 v35, v35, v75
v_cvt_pk_bf16_f32 v93, v74, v75
v_mfma_f32_32x32x16_bf16 v[48:63], a[92:95], a[56:59], v[48:63]
v_exp_f32 v77, v77
v_add_f32 v35, v35, v76
v_mfma_f32_32x32x16_bf16 v[144:159], a[96:99], v[88:91], v[144:159]
ds_read_b64_tr_b16 a[96:97], v10 offset:32768
ds_read_b64_tr_b16 a[98:99], v10 offset:33792
v_exp_f32 v78, v78
v_add_f32 v35, v35, v77
v_cvt_pk_bf16_f32 v94, v76, v77
v_mfma_f32_32x32x16_bf16 v[176:191], a[100:103], v[88:91], v[176:191]
ds_read_b64_tr_b16 a[100:101], v11 offset:32768
ds_read_b64_tr_b16 a[102:103], v11 offset:33792
v_exp_f32 v79, v79
v_add_f32 v35, v35, v78
v_mfma_f32_32x32x16_bf16 v[208:223], a[104:107], v[88:91], v[208:223]
ds_read_b64_tr_b16 a[104:105], v12 offset:32768
ds_read_b64_tr_b16 a[106:107], v12 offset:33792
v_exp_f32 v48, v48
v_add_f32 v35, v35, v79
v_cvt_pk_bf16_f32 v95, v78, v79
v_mfma_f32_32x32x16_bf16 v[240:255], a[108:111], v[88:91], v[240:255]
ds_read_b64_tr_b16 a[108:109], v13 offset:32768
ds_read_b64_tr_b16 a[110:111], v13 offset:33792
v_exp_f32 v49, v49
v_add_f32 v34, v34, v48
v_mfma_f32_32x32x16_bf16 v[144:159], a[112:115], v[92:95], v[144:159]
ds_read_b64_tr_b16 a[112:113], v10 offset:36864
ds_read_b64_tr_b16 a[114:115], v10 offset:37888
v_exp_f32 v50, v50
v_add_f32 v34, v34, v49
v_cvt_pk_bf16_f32 v80, v48, v49
v_mfma_f32_32x32x16_bf16 v[176:191], a[116:119], v[92:95], v[176:191]
ds_read_b64_tr_b16 a[116:117], v11 offset:36864
ds_read_b64_tr_b16 a[118:119], v11 offset:37888
v_exp_f32 v51, v51
v_add_f32 v34, v34, v50
v_mfma_f32_32x32x16_bf16 v[208:223], a[120:123], v[92:95], v[208:223]
ds_read_b64_tr_b16 a[120:121], v12 offset:36864
ds_read_b64_tr_b16 a[122:123], v12 offset:37888
v_exp_f32 v52, v52
v_add_f32 v34, v34, v51
v_cvt_pk_bf16_f32 v81, v50, v51
v_mfma_f32_32x32x16_bf16 v[240:255], a[124:127], v[92:95], v[240:255]
ds_read_b64_tr_b16 a[124:125], v13 offset:36864
ds_read_b64_tr_b16 a[126:127], v13 offset:37888
v_exp_f32 v53, v53
v_add_f32 v34, v34, v52
s_waitcnt vmcnt(21)
s_barrier
v_mfma_f32_32x32x16_bf16 v[64:79], a[64:67], a[4:7], v[112:127]
ds_read_b128 a[64:67], v2 offset:40960
v_exp_f32 v54, v54
v_add_f32 v34, v34, v53
v_cvt_pk_bf16_f32 v82, v52, v53
v_mfma_f32_32x32x16_bf16 v[64:79], a[68:71], a[12:15], v[64:79]
ds_read_b128 a[68:71], v3 offset:40960
v_exp_f32 v55, v55
v_add_f32 v34, v34, v54
v_mfma_f32_32x32x16_bf16 v[64:79], a[72:75], a[20:23], v[64:79]
ds_read_b128 a[72:75], v4 offset:40960
v_exp_f32 v56, v56
v_add_f32 v34, v34, v55
v_cvt_pk_bf16_f32 v83, v54, v55
v_mfma_f32_32x32x16_bf16 v[64:79], a[76:79], a[28:31], v[64:79]
ds_read_b128 a[76:79], v5 offset:40960
v_exp_f32 v57, v57
v_add_f32 v34, v34, v56
v_mfma_f32_32x32x16_bf16 v[64:79], a[80:83], a[36:39], v[64:79]
ds_read_b128 a[80:83], v6 offset:40960
v_exp_f32 v58, v58
v_add_f32 v34, v34, v57
v_cvt_pk_bf16_f32 v84, v56, v57
v_mfma_f32_32x32x16_bf16 v[64:79], a[84:87], a[44:47], v[64:79]
ds_read_b128 a[84:87], v7 offset:40960
v_exp_f32 v59, v59
v_add_f32 v34, v34, v58
v_mfma_f32_32x32x16_bf16 v[64:79], a[88:91], a[52:55], v[64:79]
ds_read_b128 a[88:91], v8 offset:40960
v_exp_f32 v60, v60
v_add_f32 v34, v34, v59
v_cvt_pk_bf16_f32 v85, v58, v59
v_mfma_f32_32x32x16_bf16 v[64:79], a[92:95], a[60:63], v[64:79]
ds_read_b128 a[92:95], v9 offset:40960
v_exp_f32 v61, v61
v_add_f32 v34, v34, v60
s_waitcnt lgkmcnt(8)
v_mfma_f32_32x32x16_bf16 v[128:143], a[96:99], v[80:83], v[128:143]
v_exp_f32 v62, v62
v_add_f32 v34, v34, v61
v_cvt_pk_bf16_f32 v86, v60, v61
v_mfma_f32_32x32x16_bf16 v[160:175], a[100:103], v[80:83], v[160:175]
v_exp_f32 v63, v63
v_add_f32 v34, v34, v62
s_add_u32 m0, s27, 32768
v_mfma_f32_32x32x16_bf16 v[192:207], a[104:107], v[80:83], v[192:207]
v_exp_f32 v64, v64
v_add_f32 v34, v34, v63
v_cvt_pk_bf16_f32 v87, v62, v63
v_mfma_f32_32x32x16_bf16 v[224:239], a[108:111], v[80:83], v[224:239]
buffer_load_dwordx4 v22, s[12:15], s58 offen nt lds
v_exp_f32 v65, v65
v_add_f32 v35, v35, v64
v_mfma_f32_32x32x16_bf16 v[128:143], a[112:115], v[84:87], v[128:143]
v_exp_f32 v66, v66
v_add_f32 v35, v35, v65
v_cvt_pk_bf16_f32 v88, v64, v65
v_mfma_f32_32x32x16_bf16 v[160:175], a[116:119], v[84:87], v[160:175]
buffer_load_dwordx4 v23, s[12:15], s58 offen offset:1024 nt lds
v_exp_f32 v67, v67
v_add_f32 v35, v35, v66
v_mfma_f32_32x32x16_bf16 v[192:207], a[120:123], v[84:87], v[192:207]
v_exp_f32 v68, v68
v_add_f32 v35, v35, v67
v_cvt_pk_bf16_f32 v89, v66, v67
s_add_u32 s58, s58, 8192
v_mfma_f32_32x32x16_bf16 v[224:239], a[124:127], v[84:87], v[224:239]
v_exp_f32 v69, v69
v_add_f32 v35, v35, v68
s_add_u32 m0, s30, 57344
s_waitcnt lgkmcnt(0)
v_mfma_f32_32x32x16_bf16 v[48:63], a[64:67], a[0:3], v[96:111]
v_exp_f32 v70, v70
v_add_f32 v35, v35, v69
v_cvt_pk_bf16_f32 v90, v68, v69
v_mfma_f32_32x32x16_bf16 v[48:63], a[68:71], a[8:11], v[48:63]
buffer_load_dwordx4 v24, s[16:19], s59 offen nt lds
v_exp_f32 v71, v71
v_add_f32 v35, v35, v70
v_mfma_f32_32x32x16_bf16 v[48:63], a[72:75], a[16:19], v[48:63]
v_exp_f32 v72, v72
v_add_f32 v35, v35, v71
v_cvt_pk_bf16_f32 v91, v70, v71
v_mfma_f32_32x32x16_bf16 v[48:63], a[76:79], a[24:27], v[48:63]
buffer_load_dwordx4 v24, s[16:19], s59 offen offset:1024 nt lds
v_exp_f32 v73, v73
v_add_f32 v35, v35, v72
v_mfma_f32_32x32x16_bf16 v[48:63], a[80:83], a[32:35], v[48:63]
v_exp_f32 v74, v74
v_add_f32 v35, v35, v73
v_cvt_pk_bf16_f32 v92, v72, v73
s_add_u32 s59, s59, 8192
v_mfma_f32_32x32x16_bf16 v[48:63], a[84:87], a[40:43], v[48:63]
v_exp_f32 v75, v75
v_add_f32 v35, v35, v74
v_mfma_f32_32x32x16_bf16 v[48:63], a[88:91], a[48:51], v[48:63]
v_exp_f32 v76, v76
v_add_f32 v35, v35, v75
v_cvt_pk_bf16_f32 v93, v74, v75
v_mfma_f32_32x32x16_bf16 v[48:63], a[92:95], a[56:59], v[48:63]
v_exp_f32 v77, v77
v_add_f32 v35, v35, v76
v_mfma_f32_32x32x16_bf16 v[144:159], a[96:99], v[88:91], v[144:159]
ds_read_b64_tr_b16 a[96:97], v10 offset:40960
ds_read_b64_tr_b16 a[98:99], v10 offset:41984
v_exp_f32 v78, v78
v_add_f32 v35, v35, v77
v_cvt_pk_bf16_f32 v94, v76, v77
v_mfma_f32_32x32x16_bf16 v[176:191], a[100:103], v[88:91], v[176:191]
ds_read_b64_tr_b16 a[100:101], v11 offset:40960
ds_read_b64_tr_b16 a[102:103], v11 offset:41984
v_exp_f32 v79, v79
v_add_f32 v35, v35, v78
v_mfma_f32_32x32x16_bf16 v[208:223], a[104:107], v[88:91], v[208:223]
ds_read_b64_tr_b16 a[104:105], v12 offset:40960
ds_read_b64_tr_b16 a[106:107], v12 offset:41984
v_exp_f32 v48, v48
v_add_f32 v35, v35, v79
v_cvt_pk_bf16_f32 v95, v78, v79
v_mfma_f32_32x32x16_bf16 v[240:255], a[108:111], v[88:91], v[240:255]
ds_read_b64_tr_b16 a[108:109], v13 offset:40960
ds_read_b64_tr_b16 a[110:111], v13 offset:41984
v_exp_f32 v49, v49
v_add_f32 v34, v34, v48
v_mfma_f32_32x32x16_bf16 v[144:159], a[112:115], v[92:95], v[144:159]
ds_read_b64_tr_b16 a[112:113], v10 offset:45056
ds_read_b64_tr_b16 a[114:115], v10 offset:46080
v_exp_f32 v50, v50
v_add_f32 v34, v34, v49
v_cvt_pk_bf16_f32 v80, v48, v49
v_mfma_f32_32x32x16_bf16 v[176:191], a[116:119], v[92:95], v[176:191]
ds_read_b64_tr_b16 a[116:117], v11 offset:45056
ds_read_b64_tr_b16 a[118:119], v11 offset:46080
v_exp_f32 v51, v51
v_add_f32 v34, v34, v50
v_mfma_f32_32x32x16_bf16 v[208:223], a[120:123], v[92:95], v[208:223]
ds_read_b64_tr_b16 a[120:121], v12 offset:45056
ds_read_b64_tr_b16 a[122:123], v12 offset:46080
v_exp_f32 v52, v52
v_add_f32 v34, v34, v51
v_cvt_pk_bf16_f32 v81, v50, v51
v_mfma_f32_32x32x16_bf16 v[240:255], a[124:127], v[92:95], v[240:255]
ds_read_b64_tr_b16 a[124:125], v13 offset:45056
ds_read_b64_tr_b16 a[126:127], v13 offset:46080
v_exp_f32 v53, v53
v_add_f32 v34, v34, v52
s_waitcnt vmcnt(21)
s_barrier
v_mfma_f32_32x32x16_bf16 v[64:79], a[64:67], a[4:7], v[112:127]
ds_read_b128 a[64:67], v2 offset:0
v_exp_f32 v54, v54
v_add_f32 v34, v34, v53
v_cvt_pk_bf16_f32 v82, v52, v53
v_mfma_f32_32x32x16_bf16 v[64:79], a[68:71], a[12:15], v[64:79]
ds_read_b128 a[68:71], v3 offset:0
v_exp_f32 v55, v55
v_add_f32 v34, v34, v54
v_mfma_f32_32x32x16_bf16 v[64:79], a[72:75], a[20:23], v[64:79]
ds_read_b128 a[72:75], v4 offset:0
v_exp_f32 v56, v56
v_add_f32 v34, v34, v55
v_cvt_pk_bf16_f32 v83, v54, v55
v_mfma_f32_32x32x16_bf16 v[64:79], a[76:79], a[28:31], v[64:79]
ds_read_b128 a[76:79], v5 offset:0
v_exp_f32 v57, v57
v_add_f32 v34, v34, v56
v_mfma_f32_32x32x16_bf16 v[64:79], a[80:83], a[36:39], v[64:79]
ds_read_b128 a[80:83], v6 offset:0
v_exp_f32 v58, v58
v_add_f32 v34, v34, v57
v_cvt_pk_bf16_f32 v84, v56, v57
v_mfma_f32_32x32x16_bf16 v[64:79], a[84:87], a[44:47], v[64:79]
ds_read_b128 a[84:87], v7 offset:0
v_exp_f32 v59, v59
v_add_f32 v34, v34, v58
v_mfma_f32_32x32x16_bf16 v[64:79], a[88:91], a[52:55], v[64:79]
ds_read_b128 a[88:91], v8 offset:0
v_exp_f32 v60, v60
v_add_f32 v34, v34, v59
v_cvt_pk_bf16_f32 v85, v58, v59
v_mfma_f32_32x32x16_bf16 v[64:79], a[92:95], a[60:63], v[64:79]
ds_read_b128 a[92:95], v9 offset:0
v_exp_f32 v61, v61
v_add_f32 v34, v34, v60
s_cmp_eq_u32 s25, 0
s_cbranch_scc1 L1_cs0
v_mov_b32 v96, v46
v_mov_b32 v97, v46
v_mov_b32 v98, v46
v_mov_b32 v99, v46
v_mov_b32 v100, v46
v_mov_b32 v101, v46
v_mov_b32 v102, v46
v_mov_b32 v103, v46
v_mov_b32 v104, v46
v_mov_b32 v105, v46
v_mov_b32 v106, v46
v_mov_b32 v107, v46
v_mov_b32 v108, v46
v_mov_b32 v109, v46
v_mov_b32 v110, v46
v_mov_b32 v111, v46
s_nop 0
L1_cs0:
s_waitcnt lgkmcnt(8)
v_mfma_f32_32x32x16_bf16 v[128:143], a[96:99], v[80:83], v[128:143]
v_exp_f32 v62, v62
v_add_f32 v34, v34, v61
v_cvt_pk_bf16_f32 v86, v60, v61
v_mfma_f32_32x32x16_bf16 v[160:175], a[100:103], v[80:83], v[160:175]
v_exp_f32 v63, v63
v_add_f32 v34, v34, v62
s_add_u32 m0, s27, 40960
v_mfma_f32_32x32x16_bf16 v[192:207], a[104:107], v[80:83], v[192:207]
v_exp_f32 v64, v64
v_add_f32 v34, v34, v63
v_cvt_pk_bf16_f32 v87, v62, v63
v_mfma_f32_32x32x16_bf16 v[224:239], a[108:111], v[80:83], v[224:239]
buffer_load_dwordx4 v22, s[12:15], s58 offen nt lds
v_exp_f32 v65, v65
v_add_f32 v35, v35, v64
v_mov_b32 v16, v34
v_mfma_f32_32x32x16_bf16 v[128:143], a[112:115], v[84:87], v[128:143]
v_exp_f32 v66, v66
v_add_f32 v35, v35, v65
v_cvt_pk_bf16_f32 v88, v64, v65
v_permlane32_swap_b32 v16, v34
v_mfma_f32_32x32x16_bf16 v[160:175], a[116:119], v[84:87], v[160:175]
buffer_load_dwordx4 v23, s[12:15], s58 offen offset:1024 nt lds
v_exp_f32 v67, v67
v_add_f32 v35, v35, v66
v_add_f32 v17, v34, v16
v_cmp_nle_f32_e64 s[70:71], s33, v17
v_rcp_f32 v14, v17
v_mfma_f32_32x32x16_bf16 v[192:207], a[120:123], v[84:87], v[192:207]
v_exp_f32 v68, v68
v_add_f32 v35, v35, v67
v_cvt_pk_bf16_f32 v89, v66, v67
s_add_u32 s58, s58, 8192
v_cmp_nge_f32_e64 s[72:73], s34, v17
v_mfma_f32_32x32x16_bf16 v[224:239], a[124:127], v[84:87], v[224:239]
v_exp_f32 v69, v69
v_add_f32 v35, v35, v68
s_add_u32 m0, s30, 32768
s_nop 0
s_or_b64 s[74:75], s[74:75], s[70:71]
s_or_b64 s[74:75], s[74:75], s[72:73]
s_waitcnt lgkmcnt(0)
v_mfma_f32_32x32x16_bf16 v[48:63], a[64:67], a[128:131], v[96:111]
buffer_load_dword v31, v31, s[84:87], s83 offen
v_exp_f32 v70, v70
v_add_f32 v35, v35, v69
v_cvt_pk_bf16_f32 v90, v68, v69
v_mfma_f32_32x32x16_bf16 v[48:63], a[68:71], a[132:135], v[48:63]
buffer_load_dwordx4 v24, s[16:19], s59 offen nt lds
v_exp_f32 v71, v71
v_add_f32 v35, v35, v70
v_mfma_f32_32x32x16_bf16 v[48:63], a[72:75], a[144:147], v[48:63]
v_exp_f32 v72, v72
v_add_f32 v35, v35, v71
v_cvt_pk_bf16_f32 v91, v70, v71
v_mfma_f32_32x32x16_bf16 v[48:63], a[76:79], a[148:151], v[48:63]
buffer_load_dwordx4 v24, s[16:19], s59 offen offset:1024 nt lds
v_exp_f32 v73, v73
v_add_f32 v35, v35, v72
v_mul_f32 v128, v14, v128
v_mfma_f32_32x32x16_bf16 v[48:63], a[80:83], a[160:163], v[48:63]
v_exp_f32 v74, v74
v_add_f32 v35, v35, v73
v_cvt_pk_bf16_f32 v92, v72, v73
s_add_u32 s59, s59, 8192
v_mul_f32 v129, v14, v129
v_mfma_f32_32x32x16_bf16 v[48:63], a[84:87], a[164:167], v[48:63]
v_exp_f32 v75, v75
v_add_f32 v35, v35, v74
v_cvt_pk_bf16_f32 v128, v128, v129
v_mul_f32 v130, v14, v130
v_mul_f32 v131, v14, v131
v_mfma_f32_32x32x16_bf16 v[48:63], a[88:91], a[176:179], v[48:63]
v_exp_f32 v76, v76
v_add_f32 v35, v35, v75
v_cvt_pk_bf16_f32 v93, v74, v75
v_cvt_pk_bf16_f32 v129, v130, v131
v_mul_f32 v132, v14, v132
v_mfma_f32_32x32x16_bf16 v[48:63], a[92:95], a[180:183], v[48:63]
v_exp_f32 v77, v77
v_add_f32 v35, v35, v76
v_mul_f32 v133, v14, v133
v_cvt_pk_bf16_f32 v130, v132, v133
v_mul_f32 v134, v14, v134
v_mfma_f32_32x32x16_bf16 v[144:159], a[96:99], v[88:91], v[144:159]
ds_read_b64_tr_b16 a[96:97], v10 offset:0
ds_read_b64_tr_b16 a[98:99], v10 offset:1024
v_exp_f32 v78, v78
v_add_f32 v35, v35, v77
v_cvt_pk_bf16_f32 v94, v76, v77
v_mfma_f32_32x32x16_bf16 v[176:191], a[100:103], v[88:91], v[176:191]
ds_read_b64_tr_b16 a[100:101], v11 offset:0
ds_read_b64_tr_b16 a[102:103], v11 offset:1024
v_exp_f32 v79, v79
v_add_f32 v35, v35, v78
v_mul_f32 v135, v14, v135
v_mfma_f32_32x32x16_bf16 v[208:223], a[104:107], v[88:91], v[208:223]
ds_read_b64_tr_b16 a[104:105], v12 offset:0
ds_read_b64_tr_b16 a[106:107], v12 offset:1024
v_exp_f32 v48, v48
v_add_f32 v35, v35, v79
v_cvt_pk_bf16_f32 v95, v78, v79
v_mfma_f32_32x32x16_bf16 v[240:255], a[108:111], v[88:91], v[240:255]
ds_read_b64_tr_b16 a[108:109], v13 offset:0
ds_read_b64_tr_b16 a[110:111], v13 offset:1024
v_exp_f32 v49, v49
v_mov_b32 v34, v48
v_mov_b32 v16, v35
v_mfma_f32_32x32x16_bf16 v[144:159], a[112:115], v[92:95], v[144:159]
ds_read_b64_tr_b16 a[112:113], v10 offset:4096
ds_read_b64_tr_b16 a[114:115], v10 offset:5120
v_exp_f32 v50, v50
v_add_f32 v34, v34, v49
v_cvt_pk_bf16_f32 v80, v48, v49
v_permlane32_swap_b32 v16, v35
v_mfma_f32_32x32x16_bf16 v[176:191], a[116:119], v[92:95], v[176:191]
ds_read_b64_tr_b16 a[116:117], v11 offset:4096
ds_read_b64_tr_b16 a[118:119], v11 offset:5120
v_exp_f32 v51, v51
v_add_f32 v34, v34, v50
v_add_f32 v17, v35, v16
v_cmp_nle_f32_e64 s[70:71], s33, v17
v_rcp_f32 v15, v17
v_mfma_f32_32x32x16_bf16 v[208:223], a[120:123], v[92:95], v[208:223]
ds_read_b64_tr_b16 a[120:121], v12 offset:4096
ds_read_b64_tr_b16 a[122:123], v12 offset:5120
v_exp_f32 v52, v52
v_add_f32 v34, v34, v51
v_cvt_pk_bf16_f32 v81, v50, v51
v_cmp_nge_f32_e64 s[72:73], s34, v17
v_mfma_f32_32x32x16_bf16 v[240:255], a[124:127], v[92:95], v[240:255]
ds_read_b64_tr_b16 a[124:125], v13 offset:4096
ds_read_b64_tr_b16 a[126:127], v13 offset:5120
v_exp_f32 v53, v53
v_add_f32 v34, v34, v52
s_nop 0
s_or_b64 s[74:75], s[74:75], s[70:71]
s_or_b64 s[74:75], s[74:75], s[72:73]
s_cmp_eq_u32 s25, 0
s_cbranch_scc1 L1_cs1
v_mov_b32 v112, v43
v_mov_b32 v113, v43
v_mov_b32 v114, v43
v_mov_b32 v115, v43
v_mov_b32 v116, v43
v_mov_b32 v117, v43
v_mov_b32 v118, v43
v_mov_b32 v119, v43
v_mov_b32 v120, v43
v_mov_b32 v121, v43
v_mov_b32 v122, v43
v_mov_b32 v123, v43
v_mov_b32 v124, v43
v_mov_b32 v125, v43
v_mov_b32 v126, v43
v_mov_b32 v127, v43
s_nop 0
L1_cs1:
s_waitcnt vmcnt(21)
s_barrier
v_mfma_f32_32x32x16_bf16 v[64:79], a[64:67], a[136:139], v[112:127]
ds_read_b128 a[64:67], v2 offset:8192
v_exp_f32 v54, v54
v_add_f32 v34, v34, v53
v_cvt_pk_bf16_f32 v82, v52, v53
v_cvt_pk_bf16_f32 v131, v134, v135
v_mfma_f32_32x32x16_bf16 v[64:79], a[68:71], a[140:143], v[64:79]
ds_read_b128 a[68:71], v3 offset:8192
v_exp_f32 v55, v55
v_add_f32 v34, v34, v54
v_mul_f32 v136, v14, v136
v_mul_f32 v137, v14, v137
v_mfma_f32_32x32x16_bf16 v[64:79], a[72:75], a[152:155], v[64:79]
ds_read_b128 a[72:75], v4 offset:8192
v_exp_f32 v56, v56
v_add_f32 v34, v34, v55
v_cvt_pk_bf16_f32 v83, v54, v55
v_cvt_pk_bf16_f32 v132, v136, v137
v_mfma_f32_32x32x16_bf16 v[64:79], a[76:79], a[156:159], v[64:79]
ds_read_b128 a[76:79], v5 offset:8192
v_exp_f32 v57, v57
v_add_f32 v34, v34, v56
v_mul_f32 v138, v14, v138
v_mul_f32 v139, v14, v139
v_mfma_f32_32x32x16_bf16 v[64:79], a[80:83], a[168:171], v[64:79]
ds_read_b128 a[80:83], v6 offset:8192
v_exp_f32 v58, v58
v_add_f32 v34, v34, v57
v_cvt_pk_bf16_f32 v84, v56, v57
v_cvt_pk_bf16_f32 v133, v138, v139
v_mfma_f32_32x32x16_bf16 v[64:79], a[84:87], a[172:175], v[64:79]
ds_read_b128 a[84:87], v7 offset:8192
v_exp_f32 v59, v59
v_add_f32 v34, v34, v58
v_mul_f32 v140, v14, v140
v_mul_f32 v141, v14, v141
v_mfma_f32_32x32x16_bf16 v[64:79], a[88:91], a[184:187], v[64:79]
ds_read_b128 a[88:91], v8 offset:8192
v_exp_f32 v60, v60
v_add_f32 v34, v34, v59
v_cvt_pk_bf16_f32 v85, v58, v59
v_cvt_pk_bf16_f32 v134, v140, v141
v_mfma_f32_32x32x16_bf16 v[64:79], a[92:95], a[188:191], v[64:79]
ds_read_b128 a[92:95], v9 offset:8192
v_exp_f32 v61, v61
v_add_f32 v34, v34, v60
v_mul_f32 v142, v14, v142
v_mul_f32 v143, v14, v143
s_waitcnt lgkmcnt(8)
v_mfma_f32_32x32x16_bf16 a[0:15], a[96:99], v[80:83], 0
v_exp_f32 v62, v62
v_add_f32 v34, v34, v61
v_cvt_pk_bf16_f32 v86, v60, v61
v_cvt_pk_bf16_f32 v135, v142, v143
v_mfma_f32_32x32x16_bf16 a[16:31], a[100:103], v[80:83], 0
v_exp_f32 v63, v63
v_add_f32 v34, v34, v62
v_mfma_f32_16x16x32_bf16 v[40:43], v[128:131], v[132:135], 0
v_mfma_f32_32x32x16_bf16 a[32:47], a[104:107], v[80:83], 0
v_exp_f32 v64, v64
v_add_f32 v34, v34, v63
v_cvt_pk_bf16_f32 v87, v62, v63
v_mul_f32 v160, v14, v160
v_mul_f32 v161, v14, v161
v_mfma_f32_32x32x16_bf16 a[48:63], a[108:111], v[80:83], 0
v_exp_f32 v65, v65
v_mov_b32 v35, v64
v_cvt_pk_bf16_f32 v160, v160, v161
v_mul_f32 v162, v14, v162
v_mul_f32 v163, v14, v163
v_mfma_f32_32x32x16_bf16 a[0:15], a[112:115], v[84:87], a[0:15]
v_exp_f32 v66, v66
v_add_f32 v35, v35, v65
v_cvt_pk_bf16_f32 v88, v64, v65
v_cvt_pk_bf16_f32 v161, v162, v163
v_mul_f32 v164, v14, v164
v_mfma_f32_32x32x16_bf16 a[16:31], a[116:119], v[84:87], a[16:31]
v_exp_f32 v67, v67
v_add_f32 v35, v35, v66
v_mul_f32 v165, v14, v165
v_cvt_pk_bf16_f32 v162, v164, v165
v_mul_f32 v166, v14, v166
v_mfma_f32_32x32x16_bf16 a[32:47], a[120:123], v[84:87], a[32:47]
v_exp_f32 v68, v68
v_add_f32 v35, v35, v67
v_cvt_pk_bf16_f32 v89, v66, v67
v_mul_f32 v167, v14, v167
v_cvt_pk_bf16_f32 v163, v166, v167
v_mfma_f32_32x32x16_bf16 a[48:63], a[124:127], v[84:87], a[48:63]
v_exp_f32 v69, v69
v_add_f32 v35, v35, v68
s_add_u32 m0, s30, 40960
v_mul_f32 v168, v14, v168
v_mul_f32 v169, v14, v169
s_waitcnt lgkmcnt(0)
v_mfma_f32_32x32x16_bf16 v[48:63], a[64:67], a[128:131], v[96:111]
v_exp_f32 v70, v70
v_add_f32 v35, v35, v69
v_cvt_pk_bf16_f32 v90, v68, v69
v_cvt_pk_bf16_f32 v164, v168, v169
v_mul_f32 v170, v14, v170
v_mfma_f32_32x32x16_bf16 v[48:63], a[68:71], a[132:135], v[48:63]
buffer_load_dwordx4 v24, s[16:19], s59 offen nt lds
v_exp_f32 v71, v71
v_add_f32 v35, v35, v70
v_mul_f32 v171, v14, v171
v_mfma_f32_32x32x16_bf16 v[48:63], a[72:75], a[144:147], v[48:63]
v_exp_f32 v72, v72
v_add_f32 v35, v35, v71
v_cvt_pk_bf16_f32 v91, v70, v71
v_cvt_pk_bf16_f32 v165, v170, v171
v_mul_f32 v172, v14, v172
v_mfma_f32_32x32x16_bf16 v[48:63], a[76:79], a[148:151], v[48:63]
buffer_load_dwordx4 v24, s[16:19], s59 offen offset:1024 nt lds
v_exp_f32 v73, v73
v_add_f32 v35, v35, v72
v_mul_f32 v173, v14, v173
v_mfma_f32_32x32x16_bf16 v[48:63], a[80:83], a[160:163], v[48:63]
v_exp_f32 v74, v74
v_add_f32 v35, v35, v73
v_cvt_pk_bf16_f32 v92, v72, v73
s_add_u32 s59, s59, 8192
v_cvt_pk_bf16_f32 v166, v172, v173
v_mfma_f32_32x32x16_bf16 v[48:63], a[84:87], a[164:167], v[48:63]
v_exp_f32 v75, v75
v_add_f32 v35, v35, v74
v_mul_f32 v174, v14, v174
v_mul_f32 v175, v14, v175
v_cvt_pk_bf16_f32 v167, v174, v175
v_mfma_f32_32x32x16_bf16 v[48:63], a[88:91], a[176:179], v[48:63]
v_exp_f32 v76, v76
v_add_f32 v35, v35, v75
v_cvt_pk_bf16_f32 v93, v74, v75
v_mfma_f32_16x16x32_bf16 v[40:43], v[160:163], v[164:167], v[40:43]
v_mfma_f32_32x32x16_bf16 v[48:63], a[92:95], a[180:183], v[48:63]
v_exp_f32 v77, v77
v_add_f32 v35, v35, v76
v_mul_f32 v192, v14, v192
v_mul_f32 v193, v14, v193
v_cvt_pk_bf16_f32 v192, v192, v193
v_mfma_f32_32x32x16_bf16 a[192:207], a[96:99], v[88:91], 0
ds_read_b64_tr_b16 a[96:97], v10 offset:8192
ds_read_b64_tr_b16 a[98:99], v10 offset:9216
v_exp_f32 v78, v78
v_add_f32 v35, v35, v77
v_cvt_pk_bf16_f32 v94, v76, v77
v_mfma_f32_32x32x16_bf16 a[208:223], a[100:103], v[88:91], 0
ds_read_b64_tr_b16 a[100:101], v11 offset:8192
ds_read_b64_tr_b16 a[102:103], v11 offset:9216
v_exp_f32 v79, v79
v_add_f32 v35, v35, v78
v_mul_f32 v194, v14, v194
v_mfma_f32_32x32x16_bf16 a[224:239], a[104:107], v[88:91], 0
ds_read_b64_tr_b16 a[104:105], v12 offset:8192
ds_read_b64_tr_b16 a[106:107], v12 offset:9216
v_exp_f32 v48, v48
v_add_f32 v35, v35, v79
v_cvt_pk_bf16_f32 v95, v78, v79
v_mfma_f32_32x32x16_bf16 a[240:255], a[108:111], v[88:91], 0
ds_read_b64_tr_b16 a[108:109], v13 offset:8192
ds_read_b64_tr_b16 a[110:111], v13 offset:9216
v_exp_f32 v49, v49
v_add_f32 v34, v34, v48
v_mul_f32 v195, v14, v195
v_mfma_f32_32x32x16_bf16 a[192:207], a[112:115], v[92:95], a[192:207]
ds_read_b64_tr_b16 a[112:113], v10 offset:12288
ds_read_b64_tr_b16 a[114:115], v10 offset:13312
v_exp_f32 v50, v50
v_add_f32 v34, v34, v49
v_cvt_pk_bf16_f32 v80, v48, v49
v_mfma_f32_32x32x16_bf16 a[208:223], a[116:119], v[92:95], a[208:223]
ds_read_b64_tr_b16 a[116:117], v11 offset:12288
ds_read_b64_tr_b16 a[118:119], v11 offset:13312
v_exp_f32 v51, v51
v_add_f32 v34, v34, v50
v_cvt_pk_bf16_f32 v193, v194, v195
v_mfma_f32_32x32x16_bf16 a[224:239], a[120:123], v[92:95], a[224:239]
ds_read_b64_tr_b16 a[120:121], v12 offset:12288
ds_read_b64_tr_b16 a[122:123], v12 offset:13312
v_exp_f32 v52, v52
v_add_f32 v34, v34, v51
v_cvt_pk_bf16_f32 v81, v50, v51
v_mfma_f32_32x32x16_bf16 a[240:255], a[124:127], v[92:95], a[240:255]
ds_read_b64_tr_b16 a[124:125], v13 offset:12288
ds_read_b64_tr_b16 a[126:127], v13 offset:13312
v_exp_f32 v53, v53
v_add_f32 v34, v34, v52
v_mul_f32 v196, v14, v196
s_waitcnt vmcnt(19)
s_barrier
v_mfma_f32_32x32x16_bf16 v[64:79], a[64:67], a[136:139], v[112:127]
ds_read_b128 a[64:67], v2 offset:16384
v_exp_f32 v54, v54
v_add_f32 v34, v34, v53
v_cvt_pk_bf16_f32 v82, v52, v53
v_mul_f32 v197, v14, v197
v_mfma_f32_32x32x16_bf16 v[64:79], a[68:71], a[140:143], v[64:79]
ds_read_b128 a[68:71], v3 offset:16384
v_exp_f32 v55, v55
v_add_f32 v34, v34, v54
v_cvt_pk_bf16_f32 v194, v196, v197
v_mul_f32 v198, v14, v198
v_mfma_f32_32x32x16_bf16 v[64:79], a[72:75], a[152:155], v[64:79]
ds_read_b128 a[72:75], v4 offset:16384
v_exp_f32 v56, v56
v_add_f32 v34, v34, v55
v_cvt_pk_bf16_f32 v83, v54, v55
v_mul_f32 v199, v14, v199
v_mfma_f32_32x32x16_bf16 v[64:79], a[76:79], a[156:159], v[64:79]
ds_read_b128 a[76:79], v5 offset:16384
v_exp_f32 v57, v57
v_add_f32 v34, v34, v56
v_cvt_pk_bf16_f32 v195, v198, v199
v_mul_f32 v200, v14, v200
v_mfma_f32_32x32x16_bf16 v[64:79], a[80:83], a[168:171], v[64:79]
ds_read_b128 a[80:83], v6 offset:16384
v_exp_f32 v58, v58
v_add_f32 v34, v34, v57
v_cvt_pk_bf16_f32 v84, v56, v57
v_mul_f32 v201, v14, v201
v_mfma_f32_32x32x16_bf16 v[64:79], a[84:87], a[172:175], v[64:79]
ds_read_b128 a[84:87], v7 offset:16384
v_exp_f32 v59, v59
v_add_f32 v34, v34, v58
v_cvt_pk_bf16_f32 v196, v200, v201
v_mul_f32 v202, v14, v202
v_mfma_f32_32x32x16_bf16 v[64:79], a[88:91], a[184:187], v[64:79]
ds_read_b128 a[88:91], v8 offset:16384
v_exp_f32 v60, v60
v_add_f32 v34, v34, v59
v_cvt_pk_bf16_f32 v85, v58, v59
v_mul_f32 v203, v14, v203
v_mfma_f32_32x32x16_bf16 v[64:79], a[92:95], a[188:191], v[64:79]
ds_read_b128 a[92:95], v9 offset:16384
v_exp_f32 v61, v61
v_add_f32 v34, v34, v60
v_cvt_pk_bf16_f32 v197, v202, v203
v_mul_f32 v204, v14, v204
s_waitcnt lgkmcnt(8)
v_mfma_f32_32x32x16_bf16 a[0:15], a[96:99], v[80:83], a[0:15]
v_exp_f32 v62, v62
v_add_f32 v34, v34, v61
v_cvt_pk_bf16_f32 v86, v60, v61
s_add_u32 m0, s31, 147456
s_lshl1_add_u32 s79, s54, s37
v_mfma_f32_32x32x16_bf16 a[16:31], a[100:103], v[80:83], a[16:31]
buffer_load_dwordx4 v25, s[84:87], s79 offen offset:0 lds
v_exp_f32 v63, v63
v_add_f32 v34, v34, v62
v_mul_f32 v205, v14, v205
v_mfma_f32_32x32x16_bf16 a[32:47], a[104:107], v[80:83], a[32:47]
v_exp_f32 v64, v64
v_add_f32 v34, v34, v63
v_cvt_pk_bf16_f32 v87, v62, v63
v_cvt_pk_bf16_f32 v198, v204, v205
v_mul_f32 v206, v14, v206
v_mfma_f32_32x32x16_bf16 a[48:63], a[108:111], v[80:83], a[48:63]
buffer_load_dwordx4 v26, s[84:87], s79 offen offset:1024 lds
v_exp_f32 v65, v65
v_add_f32 v35, v35, v64
v_mul_f32 v207, v14, v207
v_mfma_f32_32x32x16_bf16 a[0:15], a[112:115], v[84:87], a[0:15]
v_exp_f32 v66, v66
v_add_f32 v35, v35, v65
v_cvt_pk_bf16_f32 v88, v64, v65
v_cvt_pk_bf16_f32 v199, v206, v207
v_mfma_f32_32x32x16_bf16 a[16:31], a[116:119], v[84:87], a[16:31]
buffer_load_dwordx4 v27, s[84:87], s79 offen offset:2048 lds
v_exp_f32 v67, v67
v_add_f32 v35, v35, v66
v_mfma_f32_16x16x32_bf16 v[40:43], v[192:195], v[196:199], v[40:43]
v_mfma_f32_32x32x16_bf16 a[32:47], a[120:123], v[84:87], a[32:47]
buffer_load_dwordx4 v28, s[84:87], s79 offen offset:3072 lds
v_exp_f32 v68, v68
v_add_f32 v35, v35, v67
v_cvt_pk_bf16_f32 v89, v66, v67
v_mfma_f32_32x32x16_bf16 a[48:63], a[124:127], v[84:87], a[48:63]
v_exp_f32 v69, v69
v_add_f32 v35, v35, v68
v_mul_f32 v224, v14, v224
v_mul_f32 v225, v14, v225
v_cvt_pk_bf16_f32 v224, v224, v225
s_waitcnt lgkmcnt(0)
v_mfma_f32_32x32x16_bf16 v[48:63], a[64:67], a[128:131], v[96:111]
v_exp_f32 v70, v70
v_add_f32 v35, v35, v69
v_cvt_pk_bf16_f32 v90, v68, v69
v_mul_f32 v226, v14, v226
v_mul_f32 v227, v14, v227
v_mfma_f32_32x32x16_bf16 v[48:63], a[68:71], a[132:135], v[48:63]
v_exp_f32 v71, v71
v_add_f32 v35, v35, v70
v_cvt_pk_bf16_f32 v225, v226, v227
v_mul_f32 v228, v14, v228
v_mul_f32 v229, v14, v229
v_mfma_f32_32x32x16_bf16 v[48:63], a[72:75], a[144:147], v[48:63]
v_exp_f32 v72, v72
v_add_f32 v35, v35, v71
v_cvt_pk_bf16_f32 v91, v70, v71
v_cvt_pk_bf16_f32 v226, v228, v229
v_mul_f32 v230, v14, v230
v_mfma_f32_32x32x16_bf16 v[48:63], a[76:79], a[148:151], v[48:63]
v_exp_f32 v73, v73
v_add_f32 v35, v35, v72
v_mul_f32 v231, v14, v231
v_cvt_pk_bf16_f32 v227, v230, v231
v_mul_f32 v232, v14, v232
v_mfma_f32_32x32x16_bf16 v[48:63], a[80:83], a[160:163], v[48:63]
v_exp_f32 v74, v74
v_add_f32 v35, v35, v73
v_cvt_pk_bf16_f32 v92, v72, v73
v_mul_f32 v233, v14, v233
v_cvt_pk_bf16_f32 v228, v232, v233
v_mfma_f32_32x32x16_bf16 v[48:63], a[84:87], a[164:167], v[48:63]
v_exp_f32 v75, v75
v_add_f32 v35, v35, v74
v_mul_f32 v234, v14, v234
v_mul_f32 v235, v14, v235
v_cvt_pk_bf16_f32 v229, v234, v235
v_mfma_f32_32x32x16_bf16 v[48:63], a[88:91], a[176:179], v[48:63]
v_exp_f32 v76, v76
v_add_f32 v35, v35, v75
v_cvt_pk_bf16_f32 v93, v74, v75
v_mul_f32 v236, v14, v236
v_mul_f32 v237, v14, v237
v_mfma_f32_32x32x16_bf16 v[48:63], a[92:95], a[180:183], v[48:63]
v_exp_f32 v77, v77
v_add_f32 v35, v35, v76
v_cvt_pk_bf16_f32 v230, v236, v237
v_mul_f32 v238, v14, v238
v_mul_f32 v239, v14, v239
v_mfma_f32_32x32x16_bf16 a[192:207], a[96:99], v[88:91], a[192:207]
ds_read_b64_tr_b16 a[96:97], v10 offset:16384
ds_read_b64_tr_b16 a[98:99], v10 offset:17408
v_exp_f32 v78, v78
v_add_f32 v35, v35, v77
v_cvt_pk_bf16_f32 v94, v76, v77
v_mfma_f32_32x32x16_bf16 a[208:223], a[100:103], v[88:91], a[208:223]
ds_read_b64_tr_b16 a[100:101], v11 offset:16384
ds_read_b64_tr_b16 a[102:103], v11 offset:17408
v_exp_f32 v79, v79
v_add_f32 v35, v35, v78
v_cvt_pk_bf16_f32 v231, v238, v239
v_mfma_f32_32x32x16_bf16 a[224:239], a[104:107], v[88:91], a[224:239]
ds_read_b64_tr_b16 a[104:105], v12 offset:16384
ds_read_b64_tr_b16 a[106:107], v12 offset:17408
v_exp_f32 v48, v48
v_add_f32 v35, v35, v79
v_cvt_pk_bf16_f32 v95, v78, v79
v_mfma_f32_16x16x32_bf16 v[40:43], v[224:227], v[228:231], v[40:43]
v_mfma_f32_32x32x16_bf16 a[240:255], a[108:111], v[88:91], a[240:255]
ds_read_b64_tr_b16 a[108:109], v13 offset:16384
ds_read_b64_tr_b16 a[110:111], v13 offset:17408
v_exp_f32 v49, v49
v_add_f32 v34, v34, v48
v_mul_f32 v144, v15, v144
v_mfma_f32_32x32x16_bf16 a[192:207], a[112:115], v[92:95], a[192:207]
ds_read_b64_tr_b16 a[112:113], v10 offset:20480
ds_read_b64_tr_b16 a[114:115], v10 offset:21504
v_exp_f32 v50, v50
v_add_f32 v34, v34, v49
v_cvt_pk_bf16_f32 v80, v48, v49
v_mfma_f32_32x32x16_bf16 a[208:223], a[116:119], v[92:95], a[208:223]
ds_read_b64_tr_b16 a[116:117], v11 offset:20480
ds_read_b64_tr_b16 a[118:119], v11 offset:21504
v_exp_f32 v51, v51
v_add_f32 v34, v34, v50
v_mul_f32 v145, v15, v145
v_mfma_f32_32x32x16_bf16 a[224:239], a[120:123], v[92:95], a[224:239]
ds_read_b64_tr_b16 a[120:121], v12 offset:20480
ds_read_b64_tr_b16 a[122:123], v12 offset:21504
v_exp_f32 v52, v52
v_add_f32 v34, v34, v51
v_cvt_pk_bf16_f32 v81, v50, v51
v_mfma_f32_32x32x16_bf16 a[240:255], a[124:127], v[92:95], a[240:255]
ds_read_b64_tr_b16 a[124:125], v13 offset:20480
ds_read_b64_tr_b16 a[126:127], v13 offset:21504
v_exp_f32 v53, v53
v_add_f32 v34, v34, v52
v_cvt_pk_bf16_f32 v144, v144, v145
s_waitcnt vmcnt(19)
s_barrier
v_mfma_f32_32x32x16_bf16 v[64:79], a[64:67], a[136:139], v[112:127]
ds_read_b128 a[64:67], v2 offset:24576
v_exp_f32 v54, v54
v_add_f32 v34, v34, v53
v_cvt_pk_bf16_f32 v82, v52, v53
v_mul_f32 v146, v15, v146
v_mfma_f32_32x32x16_bf16 v[64:79], a[68:71], a[140:143], v[64:79]
ds_read_b128 a[68:71], v3 offset:24576
v_exp_f32 v55, v55
v_add_f32 v34, v34, v54
s_and_b32 s62, s92, 0xf0
v_mov_b32 v16, s62
v_mfma_f32_32x32x16_bf16 v[64:79], a[72:75], a[152:155], v[64:79]
ds_read_b128 a[72:75], v4 offset:24576
v_exp_f32 v56, v56
v_add_f32 v34, v34, v55
v_cvt_pk_bf16_f32 v83, v54, v55
v_mul_f32 v147, v15, v147
v_mfma_f32_32x32x16_bf16 v[64:79], a[76:79], a[156:159], v[64:79]
ds_read_b128 a[76:79], v5 offset:24576
global_load_dwordx4 v[36:39], v16, s[90:91] sc1
v_exp_f32 v57, v57
v_add_f32 v34, v34, v56
v_mfma_f32_32x32x16_bf16 v[64:79], a[80:83], a[168:171], v[64:79]
ds_read_b128 a[80:83], v6 offset:24576
v_exp_f32 v58, v58
v_add_f32 v34, v34, v57
v_cvt_pk_bf16_f32 v84, v56, v57
v_cvt_pk_bf16_f32 v145, v146, v147
v_mfma_f32_32x32x16_bf16 v[64:79], a[84:87], a[172:175], v[64:79]
ds_read_b128 a[84:87], v7 offset:24576
v_exp_f32 v59, v59
v_add_f32 v34, v34, v58
v_mul_f32 v148, v15, v148
v_mul_f32 v149, v15, v149
v_mfma_f32_32x32x16_bf16 v[64:79], a[88:91], a[184:187], v[64:79]
ds_read_b128 a[88:91], v8 offset:24576
v_exp_f32 v60, v60
v_add_f32 v34, v34, v59
v_cvt_pk_bf16_f32 v85, v58, v59
v_cvt_pk_bf16_f32 v146, v148, v149
v_mfma_f32_32x32x16_bf16 v[64:79], a[92:95], a[188:191], v[64:79]
ds_read_b128 a[92:95], v9 offset:24576
v_exp_f32 v61, v61
v_add_f32 v34, v34, v60
v_mul_f32 v150, v15, v150
v_mul_f32 v151, v15, v151
s_waitcnt lgkmcnt(8)
v_mfma_f32_32x32x16_bf16 a[0:15], a[96:99], v[80:83], a[0:15]
v_exp_f32 v62, v62
v_add_f32 v34, v34, v61
v_cvt_pk_bf16_f32 v86, v60, v61
s_add_u32 m0, s31, 131072
s_lshl1_add_u32 s79, s54, s36
v_mfma_f32_32x32x16_bf16 a[16:31], a[100:103], v[80:83], a[16:31]
buffer_load_dwordx4 v25, s[84:87], s79 offen offset:0 lds
v_exp_f32 v63, v63
v_add_f32 v34, v34, v62
v_cvt_pk_bf16_f32 v147, v150, v151
v_mfma_f32_32x32x16_bf16 a[32:47], a[104:107], v[80:83], a[32:47]
v_exp_f32 v64, v64
v_add_f32 v34, v34, v63
v_cvt_pk_bf16_f32 v87, v62, v63
v_mul_f32 v152, v15, v152
v_mul_f32 v153, v15, v153
v_mfma_f32_32x32x16_bf16 a[48:63], a[108:111], v[80:83], a[48:63]
buffer_load_dwordx4 v26, s[84:87], s79 offen offset:1024 lds
v_exp_f32 v65, v65
v_add_f32 v35, v35, v64
v_cvt_pk_bf16_f32 v148, v152, v153
v_mfma_f32_32x32x16_bf16 a[0:15], a[112:115], v[84:87], a[0:15]
v_exp_f32 v66, v66
v_add_f32 v35, v35, v65
v_cvt_pk_bf16_f32 v88, v64, v65
v_mul_f32 v154, v15, v154
v_mul_f32 v155, v15, v155
v_mfma_f32_32x32x16_bf16 a[16:31], a[116:119], v[84:87], a[16:31]
buffer_load_dwordx4 v27, s[84:87], s79 offen offset:2048 lds
v_exp_f32 v67, v67
v_add_f32 v35, v35, v66
v_cvt_pk_bf16_f32 v149, v154, v155
v_mfma_f32_32x32x16_bf16 a[32:47], a[120:123], v[84:87], a[32:47]
buffer_load_dwordx4 v28, s[84:87], s79 offen offset:3072 lds
v_exp_f32 v68, v68
v_add_f32 v35, v35, v67
v_cvt_pk_bf16_f32 v89, v66, v67
v_mfma_f32_32x32x16_bf16 a[48:63], a[124:127], v[84:87], a[48:63]
v_exp_f32 v69, v69
v_add_f32 v35, v35, v68
v_mul_f32 v156, v15, v156
v_mul_f32 v157, v15, v157
v_cvt_pk_bf16_f32 v150, v156, v157
s_waitcnt lgkmcnt(0)
v_mfma_f32_32x32x16_bf16 v[48:63], a[64:67], a[128:131], v[96:111]
v_exp_f32 v70, v70
v_add_f32 v35, v35, v69
v_cvt_pk_bf16_f32 v90, v68, v69
v_mul_f32 v158, v15, v158
v_mul_f32 v159, v15, v159
v_mfma_f32_32x32x16_bf16 v[48:63], a[68:71], a[132:135], v[48:63]
v_exp_f32 v71, v71
v_add_f32 v35, v35, v70
v_cvt_pk_bf16_f32 v151, v158, v159
v_mfma_f32_32x32x16_bf16 v[48:63], a[72:75], a[144:147], v[48:63]
v_exp_f32 v72, v72
v_add_f32 v35, v35, v71
v_cvt_pk_bf16_f32 v91, v70, v71
v_mfma_f32_16x16x32_bf16 v[40:43], v[144:147], v[148:151], v[40:43]
v_mfma_f32_32x32x16_bf16 v[48:63], a[76:79], a[148:151], v[48:63]
v_exp_f32 v73, v73
v_add_f32 v35, v35, v72
v_mul_f32 v176, v15, v176
v_mul_f32 v177, v15, v177
v_cvt_pk_bf16_f32 v176, v176, v177
v_mfma_f32_32x32x16_bf16 v[48:63], a[80:83], a[160:163], v[48:63]
v_exp_f32 v74, v74
v_add_f32 v35, v35, v73
v_cvt_pk_bf16_f32 v92, v72, v73
v_mul_f32 v178, v15, v178
v_mul_f32 v179, v15, v179
v_mfma_f32_32x32x16_bf16 v[48:63], a[84:87], a[164:167], v[48:63]
v_exp_f32 v75, v75
v_add_f32 v35, v35, v74
v_cvt_pk_bf16_f32 v177, v178, v179
v_mul_f32 v180, v15, v180
v_mul_f32 v181, v15, v181
v_mfma_f32_32x32x16_bf16 v[48:63], a[88:91], a[176:179], v[48:63]
v_exp_f32 v76, v76
v_add_f32 v35, v35, v75
v_cvt_pk_bf16_f32 v93, v74, v75
v_cvt_pk_bf16_f32 v178, v180, v181
v_mul_f32 v182, v15, v182
v_mfma_f32_32x32x16_bf16 v[48:63], a[92:95], a[180:183], v[48:63]
v_exp_f32 v77, v77
v_add_f32 v35, v35, v76
v_mul_f32 v183, v15, v183
v_cvt_pk_bf16_f32 v179, v182, v183
v_mul_f32 v184, v15, v184
v_mfma_f32_32x32x16_bf16 a[192:207], a[96:99], v[88:91], a[192:207]
ds_read_b64_tr_b16 a[96:97], v10 offset:24576
ds_read_b64_tr_b16 a[98:99], v10 offset:25600
v_exp_f32 v78, v78
v_add_f32 v35, v35, v77
v_cvt_pk_bf16_f32 v94, v76, v77
v_mfma_f32_32x32x16_bf16 a[208:223], a[100:103], v[88:91], a[208:223]
ds_read_b64_tr_b16 a[100:101], v11 offset:24576
ds_read_b64_tr_b16 a[102:103], v11 offset:25600
v_exp_f32 v79, v79
v_add_f32 v35, v35, v78
v_mul_f32 v185, v15, v185
v_mfma_f32_32x32x16_bf16 a[224:239], a[104:107], v[88:91], a[224:239]
ds_read_b64_tr_b16 a[104:105], v12 offset:24576
ds_read_b64_tr_b16 a[106:107], v12 offset:25600
v_exp_f32 v48, v48
v_add_f32 v35, v35, v79
v_cvt_pk_bf16_f32 v95, v78, v79
v_mfma_f32_32x32x16_bf16 a[240:255], a[108:111], v[88:91], a[240:255]
ds_read_b64_tr_b16 a[108:109], v13 offset:24576
ds_read_b64_tr_b16 a[110:111], v13 offset:25600
v_exp_f32 v49, v49
v_add_f32 v34, v34, v48
v_cvt_pk_bf16_f32 v180, v184, v185
v_mfma_f32_32x32x16_bf16 a[192:207], a[112:115], v[92:95], a[192:207]
ds_read_b64_tr_b16 a[112:113], v10 offset:28672
ds_read_b64_tr_b16 a[114:115], v10 offset:29696
v_exp_f32 v50, v50
v_add_f32 v34, v34, v49
v_cvt_pk_bf16_f32 v80, v48, v49
v_mfma_f32_32x32x16_bf16 a[208:223], a[116:119], v[92:95], a[208:223]
ds_read_b64_tr_b16 a[116:117], v11 offset:28672
ds_read_b64_tr_b16 a[118:119], v11 offset:29696
v_exp_f32 v51, v51
v_add_f32 v34, v34, v50
v_mul_f32 v186, v15, v186
v_mfma_f32_32x32x16_bf16 a[224:239], a[120:123], v[92:95], a[224:239]
ds_read_b64_tr_b16 a[120:121], v12 offset:28672
ds_read_b64_tr_b16 a[122:123], v12 offset:29696
v_exp_f32 v52, v52
v_add_f32 v34, v34, v51
v_cvt_pk_bf16_f32 v81, v50, v51
v_mfma_f32_32x32x16_bf16 a[240:255], a[124:127], v[92:95], a[240:255]
ds_read_b64_tr_b16 a[124:125], v13 offset:28672
ds_read_b64_tr_b16 a[126:127], v13 offset:29696
v_exp_f32 v53, v53
v_add_f32 v34, v34, v52
v_mul_f32 v187, v15, v187
s_waitcnt vmcnt(20)
s_barrier
v_mfma_f32_32x32x16_bf16 v[64:79], a[64:67], a[136:139], v[112:127]
ds_read_b128 a[64:67], v2 offset:49152
v_exp_f32 v54, v54
v_add_f32 v34, v34, v53
v_cvt_pk_bf16_f32 v82, v52, v53
v_cvt_pk_bf16_f32 v181, v186, v187
v_mfma_f32_32x32x16_bf16 v[64:79], a[68:71], a[140:143], v[64:79]
ds_read_b128 a[68:71], v3 offset:49152
v_exp_f32 v55, v55
v_add_f32 v34, v34, v54
v_mul_f32 v188, v15, v188
v_mul_f32 v189, v15, v189
v_mfma_f32_32x32x16_bf16 v[64:79], a[72:75], a[152:155], v[64:79]
ds_read_b128 a[72:75], v4 offset:49152
v_exp_f32 v56, v56
v_add_f32 v34, v34, v55
v_cvt_pk_bf16_f32 v83, v54, v55
v_cvt_pk_bf16_f32 v182, v188, v189
v_mfma_f32_32x32x16_bf16 v[64:79], a[76:79], a[156:159], v[64:79]
ds_read_b128 a[76:79], v5 offset:49152
v_exp_f32 v57, v57
v_add_f32 v34, v34, v56
v_mul_f32 v190, v15, v190
v_mul_f32 v191, v15, v191
v_mfma_f32_32x32x16_bf16 v[64:79], a[80:83], a[168:171], v[64:79]
ds_read_b128 a[80:83], v6 offset:49152
v_exp_f32 v58, v58
v_add_f32 v34, v34, v57
v_cvt_pk_bf16_f32 v84, v56, v57
v_cvt_pk_bf16_f32 v183, v190, v191
v_mfma_f32_32x32x16_bf16 v[64:79], a[84:87], a[172:175], v[64:79]
ds_read_b128 a[84:87], v7 offset:49152
v_exp_f32 v59, v59
v_add_f32 v34, v34, v58
v_mfma_f32_16x16x32_bf16 v[40:43], v[176:179], v[180:183], v[40:43]
v_mfma_f32_32x32x16_bf16 v[64:79], a[88:91], a[184:187], v[64:79]
ds_read_b128 a[88:91], v8 offset:49152
v_exp_f32 v60, v60
v_add_f32 v34, v34, v59
v_cvt_pk_bf16_f32 v85, v58, v59
v_mul_f32 v208, v15, v208
v_mfma_f32_32x32x16_bf16 v[64:79], a[92:95], a[188:191], v[64:79]
ds_read_b128 a[92:95], v9 offset:49152
v_exp_f32 v61, v61
v_add_f32 v34, v34, v60
v_mul_f32 v209, v15, v209
v_cvt_pk_bf16_f32 v208, v208, v209
s_waitcnt lgkmcnt(8)
v_mfma_f32_32x32x16_bf16 a[0:15], a[96:99], v[80:83], a[0:15]
v_exp_f32 v62, v62
v_add_f32 v34, v34, v61
v_cvt_pk_bf16_f32 v86, v60, v61
v_mul_f32 v210, v15, v210
v_mul_f32 v211, v15, v211
v_mfma_f32_32x32x16_bf16 a[16:31], a[100:103], v[80:83], a[16:31]
buffer_store_dwordx4 v[128:131], v33, s[20:23], s66 offen offset:0 sc1
v_exp_f32 v63, v63
v_add_f32 v34, v34, v62
v_cvt_pk_bf16_f32 v209, v210, v211
v_mul_f32 v212, v15, v212
v_mul_f32 v213, v15, v213
v_mfma_f32_32x32x16_bf16 a[32:47], a[104:107], v[80:83], a[32:47]
v_exp_f32 v64, v64
v_add_f32 v34, v34, v63
v_cvt_pk_bf16_f32 v87, v62, v63
v_cvt_pk_bf16_f32 v210, v212, v213
v_mul_f32 v214, v15, v214
v_mfma_f32_32x32x16_bf16 a[48:63], a[108:111], v[80:83], a[48:63]
v_exp_f32 v65, v65
v_add_f32 v35, v35, v64
v_mul_f32 v215, v15, v215
v_cvt_pk_bf16_f32 v211, v214, v215
v_mul_f32 v216, v15, v216
v_mfma_f32_32x32x16_bf16 a[0:15], a[112:115], v[84:87], a[0:15]
v_exp_f32 v66, v66
v_add_f32 v35, v35, v65
v_cvt_pk_bf16_f32 v88, v64, v65
v_mul_f32 v217, v15, v217
v_cvt_pk_bf16_f32 v212, v216, v217
v_mfma_f32_32x32x16_bf16 a[16:31], a[116:119], v[84:87], a[16:31]
buffer_store_dwordx4 v[132:135], v33, s[20:23], s66 offen offset:1024 sc1
v_exp_f32 v67, v67
v_add_f32 v35, v35, v66
v_mul_f32 v218, v15, v218
v_mul_f32 v219, v15, v219
v_cvt_pk_bf16_f32 v213, v218, v219
v_mfma_f32_32x32x16_bf16 a[32:47], a[120:123], v[84:87], a[32:47]
v_exp_f32 v68, v68
v_add_f32 v35, v35, v67
v_cvt_pk_bf16_f32 v89, v66, v67
v_mul_f32 v220, v15, v220
v_mul_f32 v221, v15, v221
v_mfma_f32_32x32x16_bf16 a[48:63], a[124:127], v[84:87], a[48:63]
v_exp_f32 v69, v69
v_add_f32 v35, v35, v68
v_cvt_pk_bf16_f32 v214, v220, v221
v_mul_f32 v222, v15, v222
v_mul_f32 v223, v15, v223
s_waitcnt lgkmcnt(0)
v_mfma_f32_32x32x16_bf16 v[48:63], a[64:67], a[128:131], v[96:111]
v_exp_f32 v70, v70
v_add_f32 v35, v35, v69
v_cvt_pk_bf16_f32 v90, v68, v69
v_cvt_pk_bf16_f32 v215, v222, v223
v_mfma_f32_32x32x16_bf16 v[48:63], a[68:71], a[132:135], v[48:63]
v_exp_f32 v71, v71
v_add_f32 v35, v35, v70
v_mfma_f32_16x16x32_bf16 v[40:43], v[208:211], v[212:215], v[40:43]
v_mfma_f32_32x32x16_bf16 v[48:63], a[72:75], a[144:147], v[48:63]
v_exp_f32 v72, v72
v_add_f32 v35, v35, v71
v_cvt_pk_bf16_f32 v91, v70, v71
v_mul_f32 v240, v15, v240
v_mul_f32 v241, v15, v241
v_mfma_f32_32x32x16_bf16 v[48:63], a[76:79], a[148:151], v[48:63]
v_exp_f32 v73, v73
v_add_f32 v35, v35, v72
v_cvt_pk_bf16_f32 v240, v240, v241
v_mul_f32 v242, v15, v242
v_mul_f32 v243, v15, v243
v_mfma_f32_32x32x16_bf16 v[48:63], a[80:83], a[160:163], v[48:63]
v_exp_f32 v74, v74
v_add_f32 v35, v35, v73
v_cvt_pk_bf16_f32 v92, v72, v73
v_cvt_pk_bf16_f32 v241, v242, v243
v_mul_f32 v244, v15, v244
v_mfma_f32_32x32x16_bf16 v[48:63], a[84:87], a[164:167], v[48:63]
buffer_store_dwordx4 v[160:163], v33, s[20:23], s66 offen offset:2048 sc1
v_exp_f32 v75, v75
v_add_f32 v35, v35, v74
v_mul_f32 v245, v15, v245
v_cvt_pk_bf16_f32 v242, v244, v245
v_mul_f32 v246, v15, v246
v_mfma_f32_32x32x16_bf16 v[48:63], a[88:91], a[176:179], v[48:63]
v_exp_f32 v76, v76
v_add_f32 v35, v35, v75
v_cvt_pk_bf16_f32 v93, v74, v75
v_mul_f32 v247, v15, v247
v_cvt_pk_bf16_f32 v243, v246, v247
v_mfma_f32_32x32x16_bf16 v[48:63], a[92:95], a[180:183], v[48:63]
v_exp_f32 v77, v77
v_add_f32 v35, v35, v76
v_mul_f32 v248, v15, v248
v_mul_f32 v249, v15, v249
v_cvt_pk_bf16_f32 v244, v248, v249
L1_pf1:
v_mfma_f32_32x32x16_bf16 a[192:207], a[96:99], v[88:91], a[192:207]
ds_read_b64_tr_b16 a[96:97], v10 offset:49152
ds_read_b64_tr_b16 a[98:99], v10 offset:50176
v_exp_f32 v78, v78
v_add_f32 v35, v35, v77
v_cvt_pk_bf16_f32 v94, v76, v77
v_mfma_f32_32x32x16_bf16 a[208:223], a[100:103], v[88:91], a[208:223]
ds_read_b64_tr_b16 a[100:101], v11 offset:49152
ds_read_b64_tr_b16 a[102:103], v11 offset:50176
v_exp_f32 v79, v79
v_add_f32 v35, v35, v78
v_mul_f32 v250, v15, v250
v_mfma_f32_32x32x16_bf16 a[224:239], a[104:107], v[88:91], a[224:239]
ds_read_b64_tr_b16 a[104:105], v12 offset:49152
ds_read_b64_tr_b16 a[106:107], v12 offset:50176
v_exp_f32 v48, v48
v_add_f32 v35, v35, v79
v_cvt_pk_bf16_f32 v95, v78, v79
v_mfma_f32_32x32x16_bf16 a[240:255], a[108:111], v[88:91], a[240:255]
ds_read_b64_tr_b16 a[108:109], v13 offset:49152
ds_read_b64_tr_b16 a[110:111], v13 offset:50176
v_exp_f32 v49, v49
v_add_f32 v34, v34, v48
v_mul_f32 v251, v15, v251
v_mfma_f32_32x32x16_bf16 a[192:207], a[112:115], v[92:95], a[192:207]
ds_read_b64_tr_b16 a[112:113], v10 offset:53248
ds_read_b64_tr_b16 a[114:115], v10 offset:54272
v_exp_f32 v50, v50
v_add_f32 v34, v34, v49
v_cvt_pk_bf16_f32 v80, v48, v49
v_mfma_f32_32x32x16_bf16 a[208:223], a[116:119], v[92:95], a[208:223]
ds_read_b64_tr_b16 a[116:117], v11 offset:53248
ds_read_b64_tr_b16 a[118:119], v11 offset:54272
v_exp_f32 v51, v51
v_add_f32 v34, v34, v50
v_cvt_pk_bf16_f32 v245, v250, v251
v_mfma_f32_32x32x16_bf16 a[224:239], a[120:123], v[92:95], a[224:239]
ds_read_b64_tr_b16 a[120:121], v12 offset:53248
ds_read_b64_tr_b16 a[122:123], v12 offset:54272
v_exp_f32 v52, v52
v_add_f32 v34, v34, v51
v_cvt_pk_bf16_f32 v81, v50, v51
v_mfma_f32_32x32x16_bf16 a[240:255], a[124:127], v[92:95], a[240:255]
ds_read_b64_tr_b16 a[124:125], v13 offset:53248
ds_read_b64_tr_b16 a[126:127], v13 offset:54272
v_exp_f32 v53, v53
v_add_f32 v34, v34, v52
v_mul_f32 v252, v15, v252
s_waitcnt vmcnt(19)
s_barrier
v_mfma_f32_32x32x16_bf16 v[64:79], a[64:67], a[136:139], v[112:127]
ds_read_b128 a[64:67], v2 offset:57344
v_exp_f32 v54, v54
v_add_f32 v34, v34, v53
v_cvt_pk_bf16_f32 v82, v52, v53
v_mul_f32 v253, v15, v253
v_mfma_f32_32x32x16_bf16 v[64:79], a[68:71], a[140:143], v[64:79]
ds_read_b128 a[68:71], v3 offset:57344
v_exp_f32 v55, v55
v_add_f32 v34, v34, v54
v_cvt_pk_bf16_f32 v246, v252, v253
v_mul_f32 v254, v15, v254
v_mfma_f32_32x32x16_bf16 v[64:79], a[72:75], a[152:155], v[64:79]
ds_read_b128 a[72:75], v4 offset:57344
v_exp_f32 v56, v56
v_add_f32 v34, v34, v55
v_cvt_pk_bf16_f32 v83, v54, v55
v_mul_f32 v255, v15, v255
v_mfma_f32_32x32x16_bf16 v[64:79], a[76:79], a[156:159], v[64:79]
ds_read_b128 a[76:79], v5 offset:57344
v_exp_f32 v57, v57
v_add_f32 v34, v34, v56
v_cvt_pk_bf16_f32 v247, v254, v255
v_mfma_f32_32x32x16_bf16 v[64:79], a[80:83], a[168:171], v[64:79]
ds_read_b128 a[80:83], v6 offset:57344
v_exp_f32 v58, v58
v_add_f32 v34, v34, v57
v_cvt_pk_bf16_f32 v84, v56, v57
v_mfma_f32_16x16x32_bf16 v[40:43], v[240:243], v[244:247], v[40:43]
v_mfma_f32_32x32x16_bf16 v[64:79], a[84:87], a[172:175], v[64:79]
ds_read_b128 a[84:87], v7 offset:57344
v_exp_f32 v59, v59
v_add_f32 v34, v34, v58
s_nop 0
v_mfma_f32_32x32x16_bf16 v[64:79], a[88:91], a[184:187], v[64:79]
ds_read_b128 a[88:91], v8 offset:57344
v_exp_f32 v60, v60
v_add_f32 v34, v34, v59
v_cvt_pk_bf16_f32 v85, v58, v59
s_nop 0
v_mfma_f32_32x32x16_bf16 v[64:79], a[92:95], a[188:191], v[64:79]
ds_read_b128 a[92:95], v9 offset:57344
v_exp_f32 v61, v61
v_add_f32 v34, v34, v60
v_add_f32 v40, v40, v41
v_add_f32 v42, v42, v43
s_waitcnt lgkmcnt(8)
v_mfma_f32_32x32x16_bf16 a[0:15], a[96:99], v[80:83], a[0:15]
v_exp_f32 v62, v62
v_add_f32 v34, v34, v61
v_cvt_pk_bf16_f32 v86, v60, v61
v_add_f32 v40, v40, v42
v_sub_f32 v40, v40, v40
v_mfma_f32_32x32x16_bf16 a[16:31], a[100:103], v[80:83], a[16:31]
buffer_store_dwordx4 v[164:167], v33, s[20:23], s66 offen offset:3072 sc1
v_exp_f32 v63, v63
v_add_f32 v34, v34, v62
s_add_u32 m0, s27, 0
v_cmp_u_f32_e64 s[70:71], v40, v40
v_mfma_f32_32x32x16_bf16 a[32:47], a[104:107], v[80:83], a[32:47]
v_exp_f32 v64, v64
v_add_f32 v34, v34, v63
v_cvt_pk_bf16_f32 v87, v62, v63
s_nop 1
v_mfma_f32_32x32x16_bf16 a[48:63], a[108:111], v[80:83], a[48:63]
buffer_load_dwordx4 v22, s[12:15], s58 offen nt lds
v_exp_f32 v65, v65
v_add_f32 v35, v35, v64
s_or_b64 s[74:75], s[74:75], s[70:71]
v_mfma_f32_32x32x16_bf16 a[0:15], a[112:115], v[84:87], a[0:15]
v_exp_f32 v66, v66
v_add_f32 v35, v35, v65
v_cvt_pk_bf16_f32 v88, v64, v65
v_mfma_f32_32x32x16_bf16 a[16:31], a[116:119], v[84:87], a[16:31]
buffer_store_dwordx4 v[192:195], v33, s[20:23], s67 offen offset:0 sc1
buffer_load_dwordx4 v23, s[12:15], s58 offen offset:1024 nt lds
v_exp_f32 v67, v67
v_add_f32 v35, v35, v66
v_mfma_f32_32x32x16_bf16 a[32:47], a[120:123], v[84:87], a[32:47]
v_exp_f32 v68, v68
v_add_f32 v35, v35, v67
v_cvt_pk_bf16_f32 v89, v66, v67
s_add_u32 s58, s58, 8192
v_mfma_f32_32x32x16_bf16 a[48:63], a[124:127], v[84:87], a[48:63]
v_exp_f32 v69, v69
v_add_f32 v35, v35, v68
s_add_u32 m0, s30, 0
s_waitcnt lgkmcnt(0)
v_mfma_f32_32x32x16_bf16 v[48:63], a[64:67], a[128:131], v[96:111]
v_exp_f32 v70, v70
v_add_f32 v35, v35, v69
v_cvt_pk_bf16_f32 v90, v68, v69
v_mfma_f32_32x32x16_bf16 v[48:63], a[68:71], a[132:135], v[48:63]
buffer_load_dwordx4 v24, s[16:19], s59 offen nt lds
v_exp_f32 v71, v71
v_add_f32 v35, v35, v70
v_mfma_f32_32x32x16_bf16 v[48:63], a[72:75], a[144:147], v[48:63]
v_exp_f32 v72, v72
v_add_f32 v35, v35, v71
v_cvt_pk_bf16_f32 v91, v70, v71
v_mfma_f32_32x32x16_bf16 v[48:63], a[76:79], a[148:151], v[48:63]
buffer_load_dwordx4 v24, s[16:19], s59 offen offset:1024 nt lds
v_exp_f32 v73, v73
v_add_f32 v35, v35, v72
v_mfma_f32_32x32x16_bf16 v[48:63], a[80:83], a[160:163], v[48:63]
v_exp_f32 v74, v74
v_add_f32 v35, v35, v73
v_cvt_pk_bf16_f32 v92, v72, v73
s_add_u32 s59, s59, 8192
v_mfma_f32_32x32x16_bf16 v[48:63], a[84:87], a[164:167], v[48:63]
buffer_store_dwordx4 v[196:199], v33, s[20:23], s67 offen offset:1024 sc1
v_exp_f32 v75, v75
v_add_f32 v35, v35, v74
v_mfma_f32_32x32x16_bf16 v[48:63], a[88:91], a[176:179], v[48:63]
v_exp_f32 v76, v76
v_add_f32 v35, v35, v75
v_cvt_pk_bf16_f32 v93, v74, v75
v_mfma_f32_32x32x16_bf16 v[48:63], a[92:95], a[180:183], v[48:63]
v_exp_f32 v77, v77
v_add_f32 v35, v35, v76
v_mfma_f32_32x32x16_bf16 a[192:207], a[96:99], v[88:91], a[192:207]
ds_read_b64_tr_b16 a[96:97], v10 offset:57344
ds_read_b64_tr_b16 a[98:99], v10 offset:58368
v_exp_f32 v78, v78
v_add_f32 v35, v35, v77
v_cvt_pk_bf16_f32 v94, v76, v77
v_mfma_f32_32x32x16_bf16 a[208:223], a[100:103], v[88:91], a[208:223]
ds_read_b64_tr_b16 a[100:101], v11 offset:57344
ds_read_b64_tr_b16 a[102:103], v11 offset:58368
v_exp_f32 v79, v79
v_add_f32 v35, v35, v78
v_mfma_f32_32x32x16_bf16 a[224:239], a[104:107], v[88:91], a[224:239]
ds_read_b64_tr_b16 a[104:105], v12 offset:57344
ds_read_b64_tr_b16 a[106:107], v12 offset:58368
v_exp_f32 v48, v48
v_add_f32 v35, v35, v79
v_cvt_pk_bf16_f32 v95, v78, v79
v_mfma_f32_32x32x16_bf16 a[240:255], a[108:111], v[88:91], a[240:255]
ds_read_b64_tr_b16 a[108:109], v13 offset:57344
ds_read_b64_tr_b16 a[110:111], v13 offset:58368
v_exp_f32 v49, v49
v_add_f32 v34, v34, v48
v_mfma_f32_32x32x16_bf16 a[192:207], a[112:115], v[92:95], a[192:207]
ds_read_b64_tr_b16 a[112:113], v10 offset:61440
ds_read_b64_tr_b16 a[114:115], v10 offset:62464
v_exp_f32 v50, v50
v_add_f32 v34, v34, v49
v_cvt_pk_bf16_f32 v80, v48, v49
v_mfma_f32_32x32x16_bf16 a[208:223], a[116:119], v[92:95], a[208:223]
ds_read_b64_tr_b16 a[116:117], v11 offset:61440
ds_read_b64_tr_b16 a[118:119], v11 offset:62464
v_exp_f32 v51, v51
v_add_f32 v34, v34, v50
v_mfma_f32_32x32x16_bf16 a[224:239], a[120:123], v[92:95], a[224:239]
ds_read_b64_tr_b16 a[120:121], v12 offset:61440
ds_read_b64_tr_b16 a[122:123], v12 offset:62464
v_exp_f32 v52, v52
v_add_f32 v34, v34, v51
v_cvt_pk_bf16_f32 v81, v50, v51
v_mfma_f32_32x32x16_bf16 a[240:255], a[124:127], v[92:95], a[240:255]
ds_read_b64_tr_b16 a[124:125], v13 offset:61440
ds_read_b64_tr_b16 a[126:127], v13 offset:62464
v_exp_f32 v53, v53
v_add_f32 v34, v34, v52
s_waitcnt vmcnt(21)
s_barrier
s_waitcnt vmcnt(14)
v_and_b32 v36, v36, v37
v_and_b32 v38, v38, v39
v_and_b32 v36, v36, v38
v_and_b32 v36, 0x01010101, v36
v_cmp_eq_u32 vcc, 0x01010101, v36
s_nop 3
s_cmp_eq_u64 vcc, -1
s_cbranch_scc1 L_okrdy
s_and_b32 s62, s92, 0xf0
v_mov_b32 v16, s62
s_mov_b32 s60, 0x200000
L_spinrdy:
global_load_dwordx4 v[36:39], v16, s[90:91] sc1
s_waitcnt vmcnt(0)
s_sub_u32 s60, s60, 1
s_cbranch_scc1 L_okrdy
v_and_b32 v36, v36, v37
v_and_b32 v38, v38, v39
v_and_b32 v36, v36, v38
v_and_b32 v36, 0x01010101, v36
v_cmp_eq_u32 vcc, 0x01010101, v36
s_nop 3
s_cmp_eq_u64 vcc, -1
s_cbranch_scc0 L_spinrdy
L_okrdy:
v_mfma_f32_32x32x16_bf16 v[64:79], a[64:67], a[136:139], v[112:127]
ds_read_b128 a[64:67], v2 offset:32768
v_exp_f32 v54, v54
v_add_f32 v34, v34, v53
v_cvt_pk_bf16_f32 v82, v52, v53
v_mfma_f32_32x32x16_bf16 v[64:79], a[68:71], a[140:143], v[64:79]
ds_read_b128 a[68:71], v3 offset:32768
v_exp_f32 v55, v55
v_add_f32 v34, v34, v54
v_mfma_f32_32x32x16_bf16 v[64:79], a[72:75], a[152:155], v[64:79]
ds_read_b128 a[72:75], v4 offset:32768
v_exp_f32 v56, v56
v_add_f32 v34, v34, v55
v_cvt_pk_bf16_f32 v83, v54, v55
v_mfma_f32_32x32x16_bf16 v[64:79], a[76:79], a[156:159], v[64:79]
ds_read_b128 a[76:79], v5 offset:32768
v_exp_f32 v57, v57
v_add_f32 v34, v34, v56
v_mfma_f32_32x32x16_bf16 v[64:79], a[80:83], a[168:171], v[64:79]
ds_read_b128 a[80:83], v6 offset:32768
v_exp_f32 v58, v58
v_add_f32 v34, v34, v57
v_cvt_pk_bf16_f32 v84, v56, v57
v_mfma_f32_32x32x16_bf16 v[64:79], a[84:87], a[172:175], v[64:79]
ds_read_b128 a[84:87], v7 offset:32768
v_exp_f32 v59, v59
v_add_f32 v34, v34, v58
v_mfma_f32_32x32x16_bf16 v[64:79], a[88:91], a[184:187], v[64:79]
ds_read_b128 a[88:91], v8 offset:32768
v_exp_f32 v60, v60
v_add_f32 v34, v34, v59
v_cvt_pk_bf16_f32 v85, v58, v59
v_mfma_f32_32x32x16_bf16 v[64:79], a[92:95], a[188:191], v[64:79]
ds_read_b128 a[92:95], v9 offset:32768
v_exp_f32 v61, v61
v_add_f32 v34, v34, v60
s_waitcnt lgkmcnt(8)
v_mfma_f32_32x32x16_bf16 a[0:15], a[96:99], v[80:83], a[0:15]
v_exp_f32 v62, v62
v_add_f32 v34, v34, v61
v_cvt_pk_bf16_f32 v86, v60, v61
v_mfma_f32_32x32x16_bf16 a[16:31], a[100:103], v[80:83], a[16:31]
buffer_store_dwordx4 v[224:227], v33, s[20:23], s67 offen offset:2048 sc1
v_exp_f32 v63, v63
v_add_f32 v34, v34, v62
s_add_u32 m0, s27, 8192
v_mfma_f32_32x32x16_bf16 a[32:47], a[104:107], v[80:83], a[32:47]
v_exp_f32 v64, v64
v_add_f32 v34, v34, v63
v_cvt_pk_bf16_f32 v87, v62, v63
v_mfma_f32_32x32x16_bf16 a[48:63], a[108:111], v[80:83], a[48:63]
buffer_load_dwordx4 v22, s[12:15], s58 offen nt lds
v_exp_f32 v65, v65
v_add_f32 v35, v35, v64
v_mfma_f32_32x32x16_bf16 a[0:15], a[112:115], v[84:87], a[0:15]
v_exp_f32 v66, v66
v_add_f32 v35, v35, v65
v_cvt_pk_bf16_f32 v88, v64, v65
v_mfma_f32_32x32x16_bf16 a[16:31], a[116:119], v[84:87], a[16:31]
buffer_store_dwordx4 v[228:231], v33, s[20:23], s67 offen offset:3072 sc1
buffer_load_dwordx4 v23, s[12:15], s58 offen offset:1024 nt lds
v_exp_f32 v67, v67
v_add_f32 v35, v35, v66
v_mfma_f32_32x32x16_bf16 a[32:47], a[120:123], v[84:87], a[32:47]
v_exp_f32 v68, v68
v_add_f32 v35, v35, v67
v_cvt_pk_bf16_f32 v89, v66, v67
s_add_u32 s58, s58, 8192
v_mfma_f32_32x32x16_bf16 a[48:63], a[124:127], v[84:87], a[48:63]
v_exp_f32 v69, v69
v_add_f32 v35, v35, v68
s_add_u32 m0, s30, 8192
s_waitcnt lgkmcnt(0)
v_mfma_f32_32x32x16_bf16 v[48:63], a[64:67], a[128:131], v[96:111]
v_exp_f32 v70, v70
v_add_f32 v35, v35, v69
v_cvt_pk_bf16_f32 v90, v68, v69
v_mfma_f32_32x32x16_bf16 v[48:63], a[68:71], a[132:135], v[48:63]
buffer_load_dwordx4 v24, s[16:19], s59 offen nt lds
v_exp_f32 v71, v71
v_add_f32 v35, v35, v70
v_mfma_f32_32x32x16_bf16 v[48:63], a[72:75], a[144:147], v[48:63]
v_exp_f32 v72, v72
v_add_f32 v35, v35, v71
v_cvt_pk_bf16_f32 v91, v70, v71
v_mfma_f32_32x32x16_bf16 v[48:63], a[76:79], a[148:151], v[48:63]
buffer_load_dwordx4 v24, s[16:19], s59 offen offset:1024 nt lds
v_exp_f32 v73, v73
v_add_f32 v35, v35, v72
v_mfma_f32_32x32x16_bf16 v[48:63], a[80:83], a[160:163], v[48:63]
v_exp_f32 v74, v74
v_add_f32 v35, v35, v73
v_cvt_pk_bf16_f32 v92, v72, v73
s_add_u32 s59, s59, 8192
v_mfma_f32_32x32x16_bf16 v[48:63], a[84:87], a[164:167], v[48:63]
buffer_store_dwordx4 v[144:147], v32, s[20:23], s68 offen offset:0 sc1
v_exp_f32 v75, v75
v_add_f32 v35, v35, v74
v_mfma_f32_32x32x16_bf16 v[48:63], a[88:91], a[176:179], v[48:63]
v_exp_f32 v76, v76
v_add_f32 v35, v35, v75
v_cvt_pk_bf16_f32 v93, v74, v75
v_mfma_f32_32x32x16_bf16 v[48:63], a[92:95], a[180:183], v[48:63]
v_exp_f32 v77, v77
v_add_f32 v35, v35, v76
s_lshr_b32 s94, s2, 5
s_xor_b32 s94, s94, s2
s_and_b32 s94, s94, 1
s_mul_i32 s94, s94, 33
s_xor_b32 s63, s2, s94
s_getpc_b64 s[94:95]
Lpc_p2:
s_add_u32 s94, s94, L1_pf2-Lpc_p2
s_addc_u32 s95, s95, 0
s_bfe_u32 s63, s63, 0x40003
s_lshl_b32 s63, s63, 2
s_add_u32 s63, s63, s24
s_mul_i32 s63, s63, 4
v_and_b32 v47, 63, v0
v_add_u32 v47, s63, v47
v_lshlrev_b32 v47, 7, v47
s_mov_b32 s63, L1_end-L1_pf2-4
v_min_u32 v47, s63, v47
s_mov_b64 exec, 15
global_load_dword v47, v47, s[94:95]
s_mov_b64 exec, -1
v_mfma_f32_32x32x16_bf16 a[192:207], a[96:99], v[88:91], a[192:207]
ds_read_b64_tr_b16 a[96:97], v10 offset:32768
ds_read_b64_tr_b16 a[98:99], v10 offset:33792
v_exp_f32 v78, v78
v_add_f32 v35, v35, v77
v_cvt_pk_bf16_f32 v94, v76, v77
v_mfma_f32_32x32x16_bf16 a[208:223], a[100:103], v[88:91], a[208:223]
ds_read_b64_tr_b16 a[100:101], v11 offset:32768
ds_read_b64_tr_b16 a[102:103], v11 offset:33792
v_exp_f32 v79, v79
v_add_f32 v35, v35, v78
v_mfma_f32_32x32x16_bf16 a[224:239], a[104:107], v[88:91], a[224:239]
ds_read_b64_tr_b16 a[104:105], v12 offset:32768
ds_read_b64_tr_b16 a[106:107], v12 offset:33792
v_exp_f32 v48, v48
v_add_f32 v35, v35, v79
v_cvt_pk_bf16_f32 v95, v78, v79
v_mfma_f32_32x32x16_bf16 a[240:255], a[108:111], v[88:91], a[240:255]
ds_read_b64_tr_b16 a[108:109], v13 offset:32768
ds_read_b64_tr_b16 a[110:111], v13 offset:33792
v_exp_f32 v49, v49
v_add_f32 v34, v34, v48
v_mfma_f32_32x32x16_bf16 a[192:207], a[112:115], v[92:95], a[192:207]
ds_read_b64_tr_b16 a[112:113], v10 offset:36864
ds_read_b64_tr_b16 a[114:115], v10 offset:37888
v_exp_f32 v50, v50
v_add_f32 v34, v34, v49
v_cvt_pk_bf16_f32 v80, v48, v49
v_mfma_f32_32x32x16_bf16 a[208:223], a[116:119], v[92:95], a[208:223]
ds_read_b64_tr_b16 a[116:117], v11 offset:36864
ds_read_b64_tr_b16 a[118:119], v11 offset:37888
v_exp_f32 v51, v51
v_add_f32 v34, v34, v50
v_mfma_f32_32x32x16_bf16 a[224:239], a[120:123], v[92:95], a[224:239]
ds_read_b64_tr_b16 a[120:121], v12 offset:36864
ds_read_b64_tr_b16 a[122:123], v12 offset:37888
v_exp_f32 v52, v52
v_add_f32 v34, v34, v51
v_cvt_pk_bf16_f32 v81, v50, v51
v_mfma_f32_32x32x16_bf16 a[240:255], a[124:127], v[92:95], a[240:255]
ds_read_b64_tr_b16 a[124:125], v13 offset:36864
ds_read_b64_tr_b16 a[126:127], v13 offset:37888
v_exp_f32 v53, v53
v_add_f32 v34, v34, v52
s_waitcnt vmcnt(63)
s_barrier
v_mfma_f32_32x32x16_bf16 v[64:79], a[64:67], a[136:139], v[112:127]
ds_read_b128 a[64:67], v2 offset:40960
v_exp_f32 v54, v54
v_add_f32 v34, v34, v53
v_cvt_pk_bf16_f32 v82, v52, v53
v_mfma_f32_32x32x16_bf16 v[64:79], a[68:71], a[140:143], v[64:79]
ds_read_b128 a[68:71], v3 offset:40960
v_exp_f32 v55, v55
v_add_f32 v34, v34, v54
v_mfma_f32_32x32x16_bf16 v[64:79], a[72:75], a[152:155], v[64:79]
ds_read_b128 a[72:75], v4 offset:40960
v_exp_f32 v56, v56
v_add_f32 v34, v34, v55
v_cvt_pk_bf16_f32 v83, v54, v55
v_mfma_f32_32x32x16_bf16 v[64:79], a[76:79], a[156:159], v[64:79]
ds_read_b128 a[76:79], v5 offset:40960
v_exp_f32 v57, v57
v_add_f32 v34, v34, v56
v_mfma_f32_32x32x16_bf16 v[64:79], a[80:83], a[168:171], v[64:79]
ds_read_b128 a[80:83], v6 offset:40960
v_exp_f32 v58, v58
v_add_f32 v34, v34, v57
v_cvt_pk_bf16_f32 v84, v56, v57
v_mfma_f32_32x32x16_bf16 v[64:79], a[84:87], a[172:175], v[64:79]
ds_read_b128 a[84:87], v7 offset:40960
v_exp_f32 v59, v59
v_add_f32 v34, v34, v58
v_mfma_f32_32x32x16_bf16 v[64:79], a[88:91], a[184:187], v[64:79]
ds_read_b128 a[88:91], v8 offset:40960
v_exp_f32 v60, v60
v_add_f32 v34, v34, v59
v_cvt_pk_bf16_f32 v85, v58, v59
v_mfma_f32_32x32x16_bf16 v[64:79], a[92:95], a[188:191], v[64:79]
ds_read_b128 a[92:95], v9 offset:40960
v_exp_f32 v61, v61
v_add_f32 v34, v34, v60
s_waitcnt lgkmcnt(8)
v_mfma_f32_32x32x16_bf16 a[0:15], a[96:99], v[80:83], a[0:15]
v_exp_f32 v62, v62
v_add_f32 v34, v34, v61
v_cvt_pk_bf16_f32 v86, v60, v61
v_mfma_f32_32x32x16_bf16 a[16:31], a[100:103], v[80:83], a[16:31]
buffer_store_dwordx4 v[148:151], v32, s[20:23], s68 offen offset:1024 sc1
v_exp_f32 v63, v63
v_add_f32 v34, v34, v62
s_add_u32 m0, s27, 16384
v_mfma_f32_32x32x16_bf16 a[32:47], a[104:107], v[80:83], a[32:47]
v_exp_f32 v64, v64
v_add_f32 v34, v34, v63
v_cvt_pk_bf16_f32 v87, v62, v63
v_mfma_f32_32x32x16_bf16 a[48:63], a[108:111], v[80:83], a[48:63]
buffer_load_dwordx4 v22, s[12:15], s58 offen nt lds
v_exp_f32 v65, v65
v_add_f32 v35, v35, v64
v_mfma_f32_32x32x16_bf16 a[0:15], a[112:115], v[84:87], a[0:15]
v_exp_f32 v66, v66
v_add_f32 v35, v35, v65
v_cvt_pk_bf16_f32 v88, v64, v65
v_mfma_f32_32x32x16_bf16 a[16:31], a[116:119], v[84:87], a[16:31]
buffer_store_dwordx4 v[176:179], v32, s[20:23], s68 offen offset:2048 sc1
buffer_load_dwordx4 v23, s[12:15], s58 offen offset:1024 nt lds
v_exp_f32 v67, v67
v_add_f32 v35, v35, v66
v_mfma_f32_32x32x16_bf16 a[32:47], a[120:123], v[84:87], a[32:47]
v_exp_f32 v68, v68
v_add_f32 v35, v35, v67
v_cvt_pk_bf16_f32 v89, v66, v67
s_add_u32 s58, s58, 8192
v_mfma_f32_32x32x16_bf16 a[48:63], a[124:127], v[84:87], a[48:63]
v_exp_f32 v69, v69
v_add_f32 v35, v35, v68
s_add_u32 m0, s30, 16384
s_waitcnt lgkmcnt(0)
v_mfma_f32_32x32x16_bf16 v[48:63], a[64:67], a[128:131], v[96:111]
v_exp_f32 v70, v70
v_add_f32 v35, v35, v69
v_cvt_pk_bf16_f32 v90, v68, v69
s_cmp_lg_u64 s[74:75], 0
s_cselect_b32 s62, 1, 0
s_lshl_b32 s63, s24, 2
s_add_u32 s63, s63, 49152
v_mfma_f32_32x32x16_bf16 v[48:63], a[68:71], a[132:135], v[48:63]
buffer_load_dwordx4 v24, s[16:19], s59 offen nt lds
v_exp_f32 v71, v71
v_add_f32 v35, v35, v70
v_mov_b32 v36, s62
v_mov_b32 v37, s63
ds_write_b32 v37, v36
v_mfma_f32_32x32x16_bf16 v[48:63], a[72:75], a[144:147], v[48:63]
v_exp_f32 v72, v72
v_add_f32 v35, v35, v71
v_cvt_pk_bf16_f32 v91, v70, v71
v_mfma_f32_32x32x16_bf16 v[48:63], a[76:79], a[148:151], v[48:63]
buffer_load_dwordx4 v24, s[16:19], s59 offen offset:1024 nt lds
v_exp_f32 v73, v73
v_add_f32 v35, v35, v72
v_mfma_f32_32x32x16_bf16 v[48:63], a[80:83], a[160:163], v[48:63]
v_exp_f32 v74, v74
v_add_f32 v35, v35, v73
v_cvt_pk_bf16_f32 v92, v72, v73
s_add_u32 s59, s59, 8192
v_mfma_f32_32x32x16_bf16 v[48:63], a[84:87], a[164:167], v[48:63]
buffer_store_dwordx4 v[180:183], v32, s[20:23], s68 offen offset:3072 sc1
v_exp_f32 v75, v75
v_add_f32 v35, v35, v74
v_mfma_f32_32x32x16_bf16 v[48:63], a[88:91], a[176:179], v[48:63]
v_exp_f32 v76, v76
v_add_f32 v35, v35, v75
v_cvt_pk_bf16_f32 v93, v74, v75
v_mfma_f32_32x32x16_bf16 v[48:63], a[92:95], a[180:183], v[48:63]
v_exp_f32 v77, v77
v_add_f32 v35, v35, v76
v_mfma_f32_32x32x16_bf16 a[192:207], a[96:99], v[88:91], a[192:207]
ds_read_b64_tr_b16 a[96:97], v10 offset:40960
ds_read_b64_tr_b16 a[98:99], v10 offset:41984
v_exp_f32 v78, v78
v_add_f32 v35, v35, v77
v_cvt_pk_bf16_f32 v94, v76, v77
v_mfma_f32_32x32x16_bf16 a[208:223], a[100:103], v[88:91], a[208:223]
ds_read_b64_tr_b16 a[100:101], v11 offset:40960
ds_read_b64_tr_b16 a[102:103], v11 offset:41984
v_exp_f32 v79, v79
v_add_f32 v35, v35, v78
v_mfma_f32_32x32x16_bf16 a[224:239], a[104:107], v[88:91], a[224:239]
ds_read_b64_tr_b16 a[104:105], v12 offset:40960
ds_read_b64_tr_b16 a[106:107], v12 offset:41984
v_exp_f32 v48, v48
v_add_f32 v35, v35, v79
v_cvt_pk_bf16_f32 v95, v78, v79
v_mfma_f32_32x32x16_bf16 a[240:255], a[108:111], v[88:91], a[240:255]
ds_read_b64_tr_b16 a[108:109], v13 offset:40960
ds_read_b64_tr_b16 a[110:111], v13 offset:41984
v_exp_f32 v49, v49
v_add_f32 v34, v34, v48
v_mfma_f32_32x32x16_bf16 a[192:207], a[112:115], v[92:95], a[192:207]
ds_read_b64_tr_b16 a[112:113], v10 offset:45056
ds_read_b64_tr_b16 a[114:115], v10 offset:46080
v_exp_f32 v50, v50
v_add_f32 v34, v34, v49
v_cvt_pk_bf16_f32 v80, v48, v49
v_mfma_f32_32x32x16_bf16 a[208:223], a[116:119], v[92:95], a[208:223]
ds_read_b64_tr_b16 a[116:117], v11 offset:45056
ds_read_b64_tr_b16 a[118:119], v11 offset:46080
v_exp_f32 v51, v51
v_add_f32 v34, v34, v50
v_mfma_f32_32x32x16_bf16 a[224:239], a[120:123], v[92:95], a[224:239]
ds_read_b64_tr_b16 a[120:121], v12 offset:45056
ds_read_b64_tr_b16 a[122:123], v12 offset:46080
v_exp_f32 v52, v52
v_add_f32 v34, v34, v51
v_cvt_pk_bf16_f32 v81, v50, v51
v_mfma_f32_32x32x16_bf16 a[240:255], a[124:127], v[92:95], a[240:255]
ds_read_b64_tr_b16 a[124:125], v13 offset:45056
ds_read_b64_tr_b16 a[126:127], v13 offset:46080
v_exp_f32 v53, v53
v_add_f32 v34, v34, v52
s_waitcnt vmcnt(16) lgkmcnt(15)
s_barrier
v_mfma_f32_32x32x16_bf16 v[64:79], a[64:67], a[136:139], v[112:127]
ds_read_b128 a[64:67], v2 offset:0
v_exp_f32 v54, v54
v_add_f32 v34, v34, v53
v_cvt_pk_bf16_f32 v82, v52, v53
v_mov_b32 v40, 49152
v_mfma_f32_32x32x16_bf16 v[64:79], a[68:71], a[140:143], v[64:79]
ds_read_b128 a[68:71], v3 offset:0
v_exp_f32 v55, v55
v_add_f32 v34, v34, v54
v_mfma_f32_32x32x16_bf16 v[64:79], a[72:75], a[152:155], v[64:79]
ds_read_b128 a[72:75], v4 offset:0
v_exp_f32 v56, v56
v_add_f32 v34, v34, v55
v_cvt_pk_bf16_f32 v83, v54, v55
v_mfma_f32_32x32x16_bf16 v[64:79], a[76:79], a[156:159], v[64:79]
ds_read_b128 a[76:79], v5 offset:0
v_exp_f32 v57, v57
v_add_f32 v34, v34, v56
v_mfma_f32_32x32x16_bf16 v[64:79], a[80:83], a[168:171], v[64:79]
ds_read_b128 a[80:83], v6 offset:0
ds_read_b128 v[40:43], v40
v_exp_f32 v58, v58
v_add_f32 v34, v34, v57
v_cvt_pk_bf16_f32 v84, v56, v57
v_mfma_f32_32x32x16_bf16 v[64:79], a[84:87], a[172:175], v[64:79]
ds_read_b128 a[84:87], v7 offset:0
v_exp_f32 v59, v59
v_add_f32 v34, v34, v58
v_mfma_f32_32x32x16_bf16 v[64:79], a[88:91], a[184:187], v[64:79]
ds_read_b128 a[88:91], v8 offset:0
v_exp_f32 v60, v60
v_add_f32 v34, v34, v59
v_cvt_pk_bf16_f32 v85, v58, v59
v_mfma_f32_32x32x16_bf16 v[64:79], a[92:95], a[188:191], v[64:79]
ds_read_b128 a[92:95], v9 offset:0
v_exp_f32 v61, v61
v_add_f32 v34, v34, v60
s_waitcnt lgkmcnt(9)
v_mfma_f32_32x32x16_bf16 a[0:15], a[96:99], v[80:83], a[0:15]
v_exp_f32 v62, v62
v_add_f32 v34, v34, v61
v_cvt_pk_bf16_f32 v86, v60, v61
v_mfma_f32_32x32x16_bf16 a[16:31], a[100:103], v[80:83], a[16:31]
buffer_store_dwordx4 v[208:211], v32, s[20:23], s69 offen offset:0 sc1
v_exp_f32 v63, v63
v_add_f32 v34, v34, v62
s_add_u32 m0, s27, 24576
v_mfma_f32_32x32x16_bf16 a[32:47], a[104:107], v[80:83], a[32:47]
v_exp_f32 v64, v64
v_add_f32 v34, v34, v63
v_cvt_pk_bf16_f32 v87, v62, v63
v_mfma_f32_32x32x16_bf16 a[48:63], a[108:111], v[80:83], a[48:63]
buffer_load_dwordx4 v22, s[12:15], s58 offen nt lds
v_exp_f32 v65, v65
v_add_f32 v35, v35, v64
v_mfma_f32_32x32x16_bf16 a[0:15], a[112:115], v[84:87], a[0:15]
v_exp_f32 v66, v66
v_add_f32 v35, v35, v65
v_cvt_pk_bf16_f32 v88, v64, v65
v_mfma_f32_32x32x16_bf16 a[16:31], a[116:119], v[84:87], a[16:31]
buffer_load_dwordx4 v23, s[12:15], s58 offen offset:1024 nt lds
v_exp_f32 v67, v67
v_add_f32 v35, v35, v66
v_mfma_f32_32x32x16_bf16 a[32:47], a[120:123], v[84:87], a[32:47]
v_exp_f32 v68, v68
v_add_f32 v35, v35, v67
v_cvt_pk_bf16_f32 v89, v66, v67
s_add_u32 s58, s58, 8192
v_mfma_f32_32x32x16_bf16 a[48:63], a[124:127], v[84:87], a[48:63]
v_exp_f32 v69, v69
v_add_f32 v35, v35, v68
s_add_u32 m0, s30, 24576
s_waitcnt lgkmcnt(0)
v_mfma_f32_32x32x16_bf16 v[48:63], a[64:67], a[128:131], v[96:111]
v_exp_f32 v70, v70
v_add_f32 v35, v35, v69
v_cvt_pk_bf16_f32 v90, v68, v69
v_mfma_f32_32x32x16_bf16 v[48:63], a[68:71], a[132:135], v[48:63]
buffer_load_dwordx4 v24, s[16:19], s59 offen nt lds
v_exp_f32 v71, v71
v_add_f32 v35, v35, v70
v_mfma_f32_32x32x16_bf16 v[48:63], a[72:75], a[144:147], v[48:63]
v_exp_f32 v72, v72
v_add_f32 v35, v35, v71
v_cvt_pk_bf16_f32 v91, v70, v71
v_mfma_f32_32x32x16_bf16 v[48:63], a[76:79], a[148:151], v[48:63]
buffer_load_dwordx4 v24, s[16:19], s59 offen offset:1024 nt lds
v_exp_f32 v73, v73
v_add_f32 v35, v35, v72
v_mfma_f32_32x32x16_bf16 v[48:63], a[80:83], a[160:163], v[48:63]
v_exp_f32 v74, v74
v_add_f32 v35, v35, v73
v_cvt_pk_bf16_f32 v92, v72, v73
s_add_u32 s59, s59, 8192
v_mfma_f32_32x32x16_bf16 v[48:63], a[84:87], a[164:167], v[48:63]
buffer_store_dwordx4 v[212:215], v32, s[20:23], s69 offen offset:1024 sc1
v_exp_f32 v75, v75
v_add_f32 v35, v35, v74
v_mfma_f32_32x32x16_bf16 v[48:63], a[88:91], a[176:179], v[48:63]
v_exp_f32 v76, v76
v_add_f32 v35, v35, v75
v_cvt_pk_bf16_f32 v93, v74, v75
v_mfma_f32_32x32x16_bf16 v[48:63], a[92:95], a[180:183], v[48:63]
v_exp_f32 v77, v77
v_add_f32 v35, v35, v76
v_mfma_f32_32x32x16_bf16 a[192:207], a[96:99], v[88:91], a[192:207]
ds_read_b64_tr_b16 a[96:97], v10 offset:0
ds_read_b64_tr_b16 a[98:99], v10 offset:1024
v_exp_f32 v78, v78
v_add_f32 v35, v35, v77
v_cvt_pk_bf16_f32 v94, v76, v77
v_mfma_f32_32x32x16_bf16 a[208:223], a[100:103], v[88:91], a[208:223]
ds_read_b64_tr_b16 a[100:101], v11 offset:0
ds_read_b64_tr_b16 a[102:103], v11 offset:1024
v_exp_f32 v79, v79
v_add_f32 v35, v35, v78
v_mfma_f32_32x32x16_bf16 a[224:239], a[104:107], v[88:91], a[224:239]
ds_read_b64_tr_b16 a[104:105], v12 offset:0
ds_read_b64_tr_b16 a[106:107], v12 offset:1024
v_exp_f32 v48, v48
v_add_f32 v35, v35, v79
v_cvt_pk_bf16_f32 v95, v78, v79
v_mfma_f32_32x32x16_bf16 a[240:255], a[108:111], v[88:91], a[240:255]
ds_read_b64_tr_b16 a[108:109], v13 offset:0
ds_read_b64_tr_b16 a[110:111], v13 offset:1024
v_exp_f32 v49, v49
v_add_f32 v34, v34, v48
v_mfma_f32_32x32x16_bf16 a[192:207], a[112:115], v[92:95], a[192:207]
ds_read_b64_tr_b16 a[112:113], v10 offset:4096
ds_read_b64_tr_b16 a[114:115], v10 offset:5120
v_exp_f32 v50, v50
v_add_f32 v34, v34, v49
v_cvt_pk_bf16_f32 v80, v48, v49
v_mfma_f32_32x32x16_bf16 a[208:223], a[116:119], v[92:95], a[208:223]
ds_read_b64_tr_b16 a[116:117], v11 offset:4096
ds_read_b64_tr_b16 a[118:119], v11 offset:5120
v_exp_f32 v51, v51
v_add_f32 v34, v34, v50
v_mfma_f32_32x32x16_bf16 a[224:239], a[120:123], v[92:95], a[224:239]
ds_read_b64_tr_b16 a[120:121], v12 offset:4096
ds_read_b64_tr_b16 a[122:123], v12 offset:5120
v_exp_f32 v52, v52
v_add_f32 v34, v34, v51
v_cvt_pk_bf16_f32 v81, v50, v51
v_mfma_f32_32x32x16_bf16 a[240:255], a[124:127], v[92:95], a[240:255]
ds_read_b64_tr_b16 a[124:125], v13 offset:4096
ds_read_b64_tr_b16 a[126:127], v13 offset:5120
v_exp_f32 v53, v53
v_add_f32 v34, v34, v52
s_waitcnt vmcnt(15)
s_barrier
s_cmp_lg_u32 s24, 0
s_cbranch_scc1 L_sigevenA
s_lshl_b32 s62, s92, 7
s_add_u32 s62, s62, 0x6000000
v_mov_b32 v44, s62
v_mov_b32 v45, 1
s_mov_b64 exec, 1
global_store_dword v44, v45, s[56:57] sc1
s_mov_b64 exec, -1
L_sigevenA:
s_waitcnt lgkmcnt(15)
v_or3_b32 v40, v40, v41, v42
v_or_b32 v40, v40, v43
s_nop 0
v_readfirstlane_b32 s62, v40
s_nop 3
s_andn2_b32 s62, s62, s25
s_cbranch_scc1 L1_redo
v_mfma_f32_32x32x16_bf16 v[64:79], a[64:67], a[136:139], v[112:127]
ds_read_b128 a[64:67], v2 offset:8192
v_exp_f32 v54, v54
v_add_f32 v34, v34, v53
v_cvt_pk_bf16_f32 v82, v52, v53
v_mfma_f32_32x32x16_bf16 v[64:79], a[68:71], a[140:143], v[64:79]
ds_read_b128 a[68:71], v3 offset:8192
v_exp_f32 v55, v55
v_add_f32 v34, v34, v54
v_mfma_f32_32x32x16_bf16 v[64:79], a[72:75], a[152:155], v[64:79]
ds_read_b128 a[72:75], v4 offset:8192
v_exp_f32 v56, v56
v_add_f32 v34, v34, v55
v_cvt_pk_bf16_f32 v83, v54, v55
v_mfma_f32_32x32x16_bf16 v[64:79], a[76:79], a[156:159], v[64:79]
ds_read_b128 a[76:79], v5 offset:8192
v_exp_f32 v57, v57
v_add_f32 v34, v34, v56
v_mfma_f32_32x32x16_bf16 v[64:79], a[80:83], a[168:171], v[64:79]
ds_read_b128 a[80:83], v6 offset:8192
v_exp_f32 v58, v58
v_add_f32 v34, v34, v57
v_cvt_pk_bf16_f32 v84, v56, v57
v_mfma_f32_32x32x16_bf16 v[64:79], a[84:87], a[172:175], v[64:79]
ds_read_b128 a[84:87], v7 offset:8192
v_exp_f32 v59, v59
v_add_f32 v34, v34, v58
v_mfma_f32_32x32x16_bf16 v[64:79], a[88:91], a[184:187], v[64:79]
ds_read_b128 a[88:91], v8 offset:8192
v_exp_f32 v60, v60
v_add_f32 v34, v34, v59
v_cvt_pk_bf16_f32 v85, v58, v59
v_mfma_f32_32x32x16_bf16 v[64:79], a[92:95], a[188:191], v[64:79]
ds_read_b128 a[92:95], v9 offset:8192
v_exp_f32 v61, v61
v_add_f32 v34, v34, v60
s_waitcnt lgkmcnt(8)
v_mfma_f32_32x32x16_bf16 a[0:15], a[96:99], v[80:83], a[0:15]
v_exp_f32 v62, v62
v_add_f32 v34, v34, v61
v_cvt_pk_bf16_f32 v86, v60, v61
v_mfma_f32_32x32x16_bf16 a[16:31], a[100:103], v[80:83], a[16:31]
buffer_store_dwordx4 v[240:243], v32, s[20:23], s69 offen offset:2048 sc1
v_exp_f32 v63, v63
v_add_f32 v34, v34, v62
s_add_u32 m0, s27, 49152
v_mfma_f32_32x32x16_bf16 a[32:47], a[104:107], v[80:83], a[32:47]
v_exp_f32 v64, v64
v_add_f32 v34, v34, v63
v_cvt_pk_bf16_f32 v87, v62, v63
v_mfma_f32_32x32x16_bf16 a[48:63], a[108:111], v[80:83], a[48:63]
buffer_load_dwordx4 v22, s[12:15], s58 offen nt lds
v_exp_f32 v65, v65
v_add_f32 v35, v35, v64
v_mfma_f32_32x32x16_bf16 a[0:15], a[112:115], v[84:87], a[0:15]
v_exp_f32 v66, v66
v_add_f32 v35, v35, v65
v_cvt_pk_bf16_f32 v88, v64, v65
v_mfma_f32_32x32x16_bf16 a[16:31], a[116:119], v[84:87], a[16:31]
buffer_load_dwordx4 v23, s[12:15], s58 offen offset:1024 nt lds
v_exp_f32 v67, v67
v_add_f32 v35, v35, v66
v_mfma_f32_32x32x16_bf16 a[32:47], a[120:123], v[84:87], a[32:47]
v_exp_f32 v68, v68
v_add_f32 v35, v35, v67
v_cvt_pk_bf16_f32 v89, v66, v67
s_add_u32 s58, s58, 8192
v_mfma_f32_32x32x16_bf16 a[48:63], a[124:127], v[84:87], a[48:63]
v_exp_f32 v69, v69
v_add_f32 v35, v35, v68
s_add_u32 m0, s30, 49152
s_waitcnt lgkmcnt(0)
v_mfma_f32_32x32x16_bf16 v[48:63], a[64:67], a[128:131], v[96:111]
v_exp_f32 v70, v70
v_add_f32 v35, v35, v69
v_cvt_pk_bf16_f32 v90, v68, v69
v_mfma_f32_32x32x16_bf16 v[48:63], a[68:71], a[132:135], v[48:63]
buffer_load_dwordx4 v24, s[16:19], s59 offen nt lds
v_exp_f32 v71, v71
v_add_f32 v35, v35, v70
v_mfma_f32_32x32x16_bf16 v[48:63], a[72:75], a[144:147], v[48:63]
v_exp_f32 v72, v72
v_add_f32 v35, v35, v71
v_cvt_pk_bf16_f32 v91, v70, v71
v_mfma_f32_32x32x16_bf16 v[48:63], a[76:79], a[148:151], v[48:63]
buffer_load_dwordx4 v24, s[16:19], s59 offen offset:1024 nt lds
v_exp_f32 v73, v73
v_add_f32 v35, v35, v72
v_mfma_f32_32x32x16_bf16 v[48:63], a[80:83], a[160:163], v[48:63]
v_exp_f32 v74, v74
v_add_f32 v35, v35, v73
v_cvt_pk_bf16_f32 v92, v72, v73
s_add_u32 s59, s59, 8192
v_mfma_f32_32x32x16_bf16 v[48:63], a[84:87], a[164:167], v[48:63]
buffer_store_dwordx4 v[244:247], v32, s[20:23], s69 offen offset:3072 sc1
v_exp_f32 v75, v75
v_add_f32 v35, v35, v74
v_mfma_f32_32x32x16_bf16 v[48:63], a[88:91], a[176:179], v[48:63]
v_exp_f32 v76, v76
v_add_f32 v35, v35, v75
v_cvt_pk_bf16_f32 v93, v74, v75
s_add_u32 s66, s66, 65536
s_add_u32 s67, s67, 65536
s_add_u32 s68, s68, 65536
v_mfma_f32_32x32x16_bf16 v[48:63], a[92:95], a[180:183], v[48:63]
v_exp_f32 v77, v77
v_add_f32 v35, v35, v76
s_add_u32 s69, s69, 65536
v_mfma_f32_32x32x16_bf16 a[192:207], a[96:99], v[88:91], a[192:207]
ds_read_b64_tr_b16 a[96:97], v10 offset:8192
ds_read_b64_tr_b16 a[98:99], v10 offset:9216
v_exp_f32 v78, v78
v_add_f32 v35, v35, v77
v_cvt_pk_bf16_f32 v94, v76, v77
v_mfma_f32_32x32x16_bf16 a[208:223], a[100:103], v[88:91], a[208:223]
ds_read_b64_tr_b16 a[100:101], v11 offset:8192
ds_read_b64_tr_b16 a[102:103], v11 offset:9216
v_exp_f32 v79, v79
v_add_f32 v35, v35, v78
v_mfma_f32_32x32x16_bf16 a[224:239], a[104:107], v[88:91], a[224:239]
ds_read_b64_tr_b16 a[104:105], v12 offset:8192
ds_read_b64_tr_b16 a[106:107], v12 offset:9216
v_exp_f32 v48, v48
v_add_f32 v35, v35, v79
v_cvt_pk_bf16_f32 v95, v78, v79
v_mfma_f32_32x32x16_bf16 a[240:255], a[108:111], v[88:91], a[240:255]
ds_read_b64_tr_b16 a[108:109], v13 offset:8192
ds_read_b64_tr_b16 a[110:111], v13 offset:9216
v_exp_f32 v49, v49
v_add_f32 v34, v34, v48
v_mfma_f32_32x32x16_bf16 a[192:207], a[112:115], v[92:95], a[192:207]
ds_read_b64_tr_b16 a[112:113], v10 offset:12288
ds_read_b64_tr_b16 a[114:115], v10 offset:13312
v_exp_f32 v50, v50
v_add_f32 v34, v34, v49
v_cvt_pk_bf16_f32 v80, v48, v49
v_mfma_f32_32x32x16_bf16 a[208:223], a[116:119], v[92:95], a[208:223]
ds_read_b64_tr_b16 a[116:117], v11 offset:12288
ds_read_b64_tr_b16 a[118:119], v11 offset:13312
v_exp_f32 v51, v51
v_add_f32 v34, v34, v50
v_mfma_f32_32x32x16_bf16 a[224:239], a[120:123], v[92:95], a[224:239]
ds_read_b64_tr_b16 a[120:121], v12 offset:12288
ds_read_b64_tr_b16 a[122:123], v12 offset:13312
v_exp_f32 v52, v52
v_add_f32 v34, v34, v51
v_cvt_pk_bf16_f32 v81, v50, v51
v_mfma_f32_32x32x16_bf16 a[240:255], a[124:127], v[92:95], a[240:255]
ds_read_b64_tr_b16 a[124:125], v13 offset:12288
ds_read_b64_tr_b16 a[126:127], v13 offset:13312
v_exp_f32 v53, v53
v_add_f32 v34, v34, v52
s_waitcnt vmcnt(13)
s_barrier
v_mfma_f32_32x32x16_bf16 v[64:79], a[64:67], a[136:139], v[112:127]
ds_read_b128 a[64:67], v2 offset:16384
v_exp_f32 v54, v54
v_add_f32 v34, v34, v53
v_cvt_pk_bf16_f32 v82, v52, v53
v_mfma_f32_32x32x16_bf16 v[64:79], a[68:71], a[140:143], v[64:79]
ds_read_b128 a[68:71], v3 offset:16384
v_exp_f32 v55, v55
v_add_f32 v34, v34, v54
v_mfma_f32_32x32x16_bf16 v[64:79], a[72:75], a[152:155], v[64:79]
ds_read_b128 a[72:75], v4 offset:16384
v_exp_f32 v56, v56
v_add_f32 v34, v34, v55
v_cvt_pk_bf16_f32 v83, v54, v55
v_mfma_f32_32x32x16_bf16 v[64:79], a[76:79], a[156:159], v[64:79]
ds_read_b128 a[76:79], v5 offset:16384
v_exp_f32 v57, v57
v_add_f32 v34, v34, v56
v_mfma_f32_32x32x16_bf16 v[64:79], a[80:83], a[168:171], v[64:79]
ds_read_b128 a[80:83], v6 offset:16384
v_exp_f32 v58, v58
v_add_f32 v34, v34, v57
v_cvt_pk_bf16_f32 v84, v56, v57
v_mfma_f32_32x32x16_bf16 v[64:79], a[84:87], a[172:175], v[64:79]
ds_read_b128 a[84:87], v7 offset:16384
v_exp_f32 v59, v59
v_add_f32 v34, v34, v58
v_mfma_f32_32x32x16_bf16 v[64:79], a[88:91], a[184:187], v[64:79]
ds_read_b128 a[88:91], v8 offset:16384
v_exp_f32 v60, v60
v_add_f32 v34, v34, v59
v_cvt_pk_bf16_f32 v85, v58, v59
v_mfma_f32_32x32x16_bf16 v[64:79], a[92:95], a[188:191], v[64:79]
ds_read_b128 a[92:95], v9 offset:16384
v_exp_f32 v61, v61
v_add_f32 v34, v34, v60
s_waitcnt lgkmcnt(8)
v_mfma_f32_32x32x16_bf16 a[0:15], a[96:99], v[80:83], a[0:15]
v_exp_f32 v62, v62
v_add_f32 v34, v34, v61
v_cvt_pk_bf16_f32 v86, v60, v61
v_mfma_f32_32x32x16_bf16 a[16:31], a[100:103], v[80:83], a[16:31]
v_exp_f32 v63, v63
v_add_f32 v34, v34, v62
s_add_u32 m0, s27, 57344
v_mfma_f32_32x32x16_bf16 a[32:47], a[104:107], v[80:83], a[32:47]
v_exp_f32 v64, v64
v_add_f32 v34, v34, v63
v_cvt_pk_bf16_f32 v87, v62, v63
v_mfma_f32_32x32x16_bf16 a[48:63], a[108:111], v[80:83], a[48:63]
buffer_load_dwordx4 v22, s[12:15], s58 offen nt lds
v_exp_f32 v65, v65
v_add_f32 v35, v35, v64
v_mfma_f32_32x32x16_bf16 a[0:15], a[112:115], v[84:87], a[0:15]
v_exp_f32 v66, v66
v_add_f32 v35, v35, v65
v_cvt_pk_bf16_f32 v88, v64, v65
v_mfma_f32_32x32x16_bf16 a[16:31], a[116:119], v[84:87], a[16:31]
buffer_load_dwordx4 v23, s[12:15], s58 offen offset:1024 nt lds
v_exp_f32 v67, v67
v_add_f32 v35, v35, v66
v_mfma_f32_32x32x16_bf16 a[32:47], a[120:123], v[84:87], a[32:47]
v_exp_f32 v68, v68
v_add_f32 v35, v35, v67
v_cvt_pk_bf16_f32 v89, v66, v67
s_add_u32 s58, s58, 8192
v_mfma_f32_32x32x16_bf16 a[48:63], a[124:127], v[84:87], a[48:63]
v_exp_f32 v69, v69
v_add_f32 v35, v35, v68
s_add_u32 m0, s30, 57344
s_waitcnt lgkmcnt(0)
v_mfma_f32_32x32x16_bf16 v[48:63], a[64:67], a[128:131], v[96:111]
v_exp_f32 v70, v70
v_add_f32 v35, v35, v69
v_cvt_pk_bf16_f32 v90, v68, v69
v_mfma_f32_32x32x16_bf16 v[48:63], a[68:71], a[132:135], v[48:63]
buffer_load_dwordx4 v24, s[16:19], s59 offen nt lds
v_exp_f32 v71, v71
v_add_f32 v35, v35, v70
v_mfma_f32_32x32x16_bf16 v[48:63], a[72:75], a[144:147], v[48:63]
v_exp_f32 v72, v72
v_add_f32 v35, v35, v71
v_cvt_pk_bf16_f32 v91, v70, v71
v_mfma_f32_32x32x16_bf16 v[48:63], a[76:79], a[148:151], v[48:63]
buffer_load_dwordx4 v24, s[16:19], s59 offen offset:1024 nt lds
v_exp_f32 v73, v73
v_add_f32 v35, v35, v72
v_mfma_f32_32x32x16_bf16 v[48:63], a[80:83], a[160:163], v[48:63]
v_exp_f32 v74, v74
v_add_f32 v35, v35, v73
v_cvt_pk_bf16_f32 v92, v72, v73
s_add_u32 s59, s59, 8192
v_mfma_f32_32x32x16_bf16 v[48:63], a[84:87], a[164:167], v[48:63]
v_exp_f32 v75, v75
v_add_f32 v35, v35, v74
v_mfma_f32_32x32x16_bf16 v[48:63], a[88:91], a[176:179], v[48:63]
v_exp_f32 v76, v76
v_add_f32 v35, v35, v75
v_cvt_pk_bf16_f32 v93, v74, v75
v_mfma_f32_32x32x16_bf16 v[48:63], a[92:95], a[180:183], v[48:63]
v_exp_f32 v77, v77
v_add_f32 v35, v35, v76
v_mfma_f32_32x32x16_bf16 a[192:207], a[96:99], v[88:91], a[192:207]
ds_read_b64_tr_b16 a[96:97], v10 offset:16384
ds_read_b64_tr_b16 a[98:99], v10 offset:17408
v_exp_f32 v78, v78
v_add_f32 v35, v35, v77
v_cvt_pk_bf16_f32 v94, v76, v77
v_mfma_f32_32x32x16_bf16 a[208:223], a[100:103], v[88:91], a[208:223]
ds_read_b64_tr_b16 a[100:101], v11 offset:16384
ds_read_b64_tr_b16 a[102:103], v11 offset:17408
v_exp_f32 v79, v79
v_add_f32 v35, v35, v78
v_mfma_f32_32x32x16_bf16 a[224:239], a[104:107], v[88:91], a[224:239]
ds_read_b64_tr_b16 a[104:105], v12 offset:16384
ds_read_b64_tr_b16 a[106:107], v12 offset:17408
v_exp_f32 v48, v48
v_add_f32 v35, v35, v79
v_cvt_pk_bf16_f32 v95, v78, v79
v_mfma_f32_32x32x16_bf16 a[240:255], a[108:111], v[88:91], a[240:255]
ds_read_b64_tr_b16 a[108:109], v13 offset:16384
ds_read_b64_tr_b16 a[110:111], v13 offset:17408
v_exp_f32 v49, v49
v_add_f32 v34, v34, v48
v_mfma_f32_32x32x16_bf16 a[192:207], a[112:115], v[92:95], a[192:207]
ds_read_b64_tr_b16 a[112:113], v10 offset:20480
ds_read_b64_tr_b16 a[114:115], v10 offset:21504
v_exp_f32 v50, v50
v_add_f32 v34, v34, v49
v_cvt_pk_bf16_f32 v80, v48, v49
v_mfma_f32_32x32x16_bf16 a[208:223], a[116:119], v[92:95], a[208:223]
ds_read_b64_tr_b16 a[116:117], v11 offset:20480
ds_read_b64_tr_b16 a[118:119], v11 offset:21504
v_exp_f32 v51, v51
v_add_f32 v34, v34, v50
v_mfma_f32_32x32x16_bf16 a[224:239], a[120:123], v[92:95], a[224:239]
ds_read_b64_tr_b16 a[120:121], v12 offset:20480
ds_read_b64_tr_b16 a[122:123], v12 offset:21504
v_exp_f32 v52, v52
v_add_f32 v34, v34, v51
v_cvt_pk_bf16_f32 v81, v50, v51
v_mfma_f32_32x32x16_bf16 a[240:255], a[124:127], v[92:95], a[240:255]
ds_read_b64_tr_b16 a[124:125], v13 offset:20480
ds_read_b64_tr_b16 a[126:127], v13 offset:21504
v_exp_f32 v53, v53
v_add_f32 v34, v34, v52
s_waitcnt vmcnt(11)
s_barrier
v_mfma_f32_32x32x16_bf16 v[64:79], a[64:67], a[136:139], v[112:127]
ds_read_b128 a[64:67], v2 offset:24576
v_exp_f32 v54, v54
v_add_f32 v34, v34, v53
v_cvt_pk_bf16_f32 v82, v52, v53
v_mfma_f32_32x32x16_bf16 v[64:79], a[68:71], a[140:143], v[64:79]
ds_read_b128 a[68:71], v3 offset:24576
v_exp_f32 v55, v55
v_add_f32 v34, v34, v54
v_mfma_f32_32x32x16_bf16 v[64:79], a[72:75], a[152:155], v[64:79]
ds_read_b128 a[72:75], v4 offset:24576
v_exp_f32 v56, v56
v_add_f32 v34, v34, v55
v_cvt_pk_bf16_f32 v83, v54, v55
v_mfma_f32_32x32x16_bf16 v[64:79], a[76:79], a[156:159], v[64:79]
ds_read_b128 a[76:79], v5 offset:24576
v_exp_f32 v57, v57
v_add_f32 v34, v34, v56
v_mfma_f32_32x32x16_bf16 v[64:79], a[80:83], a[168:171], v[64:79]
ds_read_b128 a[80:83], v6 offset:24576
v_exp_f32 v58, v58
v_add_f32 v34, v34, v57
v_cvt_pk_bf16_f32 v84, v56, v57
v_mfma_f32_32x32x16_bf16 v[64:79], a[84:87], a[172:175], v[64:79]
ds_read_b128 a[84:87], v7 offset:24576
v_exp_f32 v59, v59
v_add_f32 v34, v34, v58
v_mfma_f32_32x32x16_bf16 v[64:79], a[88:91], a[184:187], v[64:79]
ds_read_b128 a[88:91], v8 offset:24576
v_exp_f32 v60, v60
v_add_f32 v34, v34, v59
v_cvt_pk_bf16_f32 v85, v58, v59
v_mfma_f32_32x32x16_bf16 v[64:79], a[92:95], a[188:191], v[64:79]
ds_read_b128 a[92:95], v9 offset:24576
v_exp_f32 v61, v61
v_add_f32 v34, v34, v60
s_waitcnt lgkmcnt(8)
v_mfma_f32_32x32x16_bf16 a[0:15], a[96:99], v[80:83], a[0:15]
v_exp_f32 v62, v62
v_add_f32 v34, v34, v61
v_cvt_pk_bf16_f32 v86, v60, v61
v_mfma_f32_32x32x16_bf16 a[16:31], a[100:103], v[80:83], a[16:31]
v_exp_f32 v63, v63
v_add_f32 v34, v34, v62
s_add_u32 m0, s27, 32768
v_mfma_f32_32x32x16_bf16 a[32:47], a[104:107], v[80:83], a[32:47]
v_exp_f32 v64, v64
v_add_f32 v34, v34, v63
v_cvt_pk_bf16_f32 v87, v62, v63
v_mfma_f32_32x32x16_bf16 a[48:63], a[108:111], v[80:83], a[48:63]
buffer_load_dwordx4 v22, s[12:15], s58 offen nt lds
v_exp_f32 v65, v65
v_add_f32 v35, v35, v64
v_mfma_f32_32x32x16_bf16 a[0:15], a[112:115], v[84:87], a[0:15]
v_exp_f32 v66, v66
v_add_f32 v35, v35, v65
v_cvt_pk_bf16_f32 v88, v64, v65
v_mfma_f32_32x32x16_bf16 a[16:31], a[116:119], v[84:87], a[16:31]
buffer_load_dwordx4 v23, s[12:15], s58 offen offset:1024 nt lds
v_exp_f32 v67, v67
v_add_f32 v35, v35, v66
v_mfma_f32_32x32x16_bf16 a[32:47], a[120:123], v[84:87], a[32:47]
v_exp_f32 v68, v68
v_add_f32 v35, v35, v67
v_cvt_pk_bf16_f32 v89, v66, v67
s_add_u32 s58, s58, 8192
v_mfma_f32_32x32x16_bf16 a[48:63], a[124:127], v[84:87], a[48:63]
v_exp_f32 v69, v69
v_add_f32 v35, v35, v68
s_add_u32 m0, s30, 32768
s_waitcnt lgkmcnt(0)
v_mfma_f32_32x32x16_bf16 v[48:63], a[64:67], a[128:131], v[96:111]
v_exp_f32 v70, v70
v_add_f32 v35, v35, v69
v_cvt_pk_bf16_f32 v90, v68, v69
v_mfma_f32_32x32x16_bf16 v[48:63], a[68:71], a[132:135], v[48:63]
buffer_load_dwordx4 v24, s[16:19], s59 offen nt lds
v_exp_f32 v71, v71
v_add_f32 v35, v35, v70
v_mfma_f32_32x32x16_bf16 v[48:63], a[72:75], a[144:147], v[48:63]
v_exp_f32 v72, v72
v_add_f32 v35, v35, v71
v_cvt_pk_bf16_f32 v91, v70, v71
v_mfma_f32_32x32x16_bf16 v[48:63], a[76:79], a[148:151], v[48:63]
buffer_load_dwordx4 v24, s[16:19], s59 offen offset:1024 nt lds
v_exp_f32 v73, v73
v_add_f32 v35, v35, v72
v_mfma_f32_32x32x16_bf16 v[48:63], a[80:83], a[160:163], v[48:63]
v_exp_f32 v74, v74
v_add_f32 v35, v35, v73
v_cvt_pk_bf16_f32 v92, v72, v73
s_add_u32 s59, s59, 8192
v_mfma_f32_32x32x16_bf16 v[48:63], a[84:87], a[164:167], v[48:63]
v_exp_f32 v75, v75
v_add_f32 v35, v35, v74
v_mfma_f32_32x32x16_bf16 v[48:63], a[88:91], a[176:179], v[48:63]
v_exp_f32 v76, v76
v_add_f32 v35, v35, v75
v_cvt_pk_bf16_f32 v93, v74, v75
v_mfma_f32_32x32x16_bf16 v[48:63], a[92:95], a[180:183], v[48:63]
v_exp_f32 v77, v77
v_add_f32 v35, v35, v76
v_mfma_f32_32x32x16_bf16 a[192:207], a[96:99], v[88:91], a[192:207]
ds_read_b64_tr_b16 a[96:97], v10 offset:24576
ds_read_b64_tr_b16 a[98:99], v10 offset:25600
v_exp_f32 v78, v78
v_add_f32 v35, v35, v77
v_cvt_pk_bf16_f32 v94, v76, v77
v_mfma_f32_32x32x16_bf16 a[208:223], a[100:103], v[88:91], a[208:223]
ds_read_b64_tr_b16 a[100:101], v11 offset:24576
ds_read_b64_tr_b16 a[102:103], v11 offset:25600
v_exp_f32 v79, v79
v_add_f32 v35, v35, v78
v_mfma_f32_32x32x16_bf16 a[224:239], a[104:107], v[88:91], a[224:239]
ds_read_b64_tr_b16 a[104:105], v12 offset:24576
ds_read_b64_tr_b16 a[106:107], v12 offset:25600
v_exp_f32 v48, v48
v_add_f32 v35, v35, v79
v_cvt_pk_bf16_f32 v95, v78, v79
v_mfma_f32_32x32x16_bf16 a[240:255], a[108:111], v[88:91], a[240:255]
ds_read_b64_tr_b16 a[108:109], v13 offset:24576
ds_read_b64_tr_b16 a[110:111], v13 offset:25600
v_exp_f32 v49, v49
v_add_f32 v34, v34, v48
v_mfma_f32_32x32x16_bf16 a[192:207], a[112:115], v[92:95], a[192:207]
ds_read_b64_tr_b16 a[112:113], v10 offset:28672
ds_read_b64_tr_b16 a[114:115], v10 offset:29696
v_exp_f32 v50, v50
v_add_f32 v34, v34, v49
v_cvt_pk_bf16_f32 v80, v48, v49
v_mfma_f32_32x32x16_bf16 a[208:223], a[116:119], v[92:95], a[208:223]
ds_read_b64_tr_b16 a[116:117], v11 offset:28672
ds_read_b64_tr_b16 a[118:119], v11 offset:29696
v_exp_f32 v51, v51
v_add_f32 v34, v34, v50
v_mfma_f32_32x32x16_bf16 a[224:239], a[120:123], v[92:95], a[224:239]
ds_read_b64_tr_b16 a[120:121], v12 offset:28672
ds_read_b64_tr_b16 a[122:123], v12 offset:29696
v_exp_f32 v52, v52
v_add_f32 v34, v34, v51
v_cvt_pk_bf16_f32 v81, v50, v51
v_mfma_f32_32x32x16_bf16 a[240:255], a[124:127], v[92:95], a[240:255]
ds_read_b64_tr_b16 a[124:125], v13 offset:28672
ds_read_b64_tr_b16 a[126:127], v13 offset:29696
v_exp_f32 v53, v53
v_add_f32 v34, v34, v52
s_waitcnt vmcnt(8)
s_barrier
s_cmp_lg_u32 s24, 0
s_cbranch_scc1 L_sigevenB
s_lshl_b32 s62, s92, 7
s_add_u32 s62, s62, 0x6000000
v_mov_b32 v44, s62
v_mov_b32 v45, 9
s_mov_b64 exec, 1
global_store_dword v44, v45, s[56:57] sc1
s_mov_b64 exec, -1
L_sigevenB:
v_mfma_f32_32x32x16_bf16 v[64:79], a[64:67], a[136:139], v[112:127]
ds_read_b128 a[64:67], v2 offset:49152
v_exp_f32 v54, v54
v_add_f32 v34, v34, v53
v_cvt_pk_bf16_f32 v82, v52, v53
v_mfma_f32_32x32x16_bf16 v[64:79], a[68:71], a[140:143], v[64:79]
ds_read_b128 a[68:71], v3 offset:49152
v_exp_f32 v55, v55
v_add_f32 v34, v34, v54
v_mfma_f32_32x32x16_bf16 v[64:79], a[72:75], a[152:155], v[64:79]
ds_read_b128 a[72:75], v4 offset:49152
v_exp_f32 v56, v56
v_add_f32 v34, v34, v55
v_cvt_pk_bf16_f32 v83, v54, v55
v_mfma_f32_32x32x16_bf16 v[64:79], a[76:79], a[156:159], v[64:79]
ds_read_b128 a[76:79], v5 offset:49152
v_exp_f32 v57, v57
v_add_f32 v34, v34, v56
v_mfma_f32_32x32x16_bf16 v[64:79], a[80:83], a[168:171], v[64:79]
ds_read_b128 a[80:83], v6 offset:49152
v_exp_f32 v58, v58
v_add_f32 v34, v34, v57
v_cvt_pk_bf16_f32 v84, v56, v57
v_mfma_f32_32x32x16_bf16 v[64:79], a[84:87], a[172:175], v[64:79]
ds_read_b128 a[84:87], v7 offset:49152
v_exp_f32 v59, v59
v_add_f32 v34, v34, v58
v_mfma_f32_32x32x16_bf16 v[64:79], a[88:91], a[184:187], v[64:79]
ds_read_b128 a[88:91], v8 offset:49152
v_exp_f32 v60, v60
v_add_f32 v34, v34, v59
v_cvt_pk_bf16_f32 v85, v58, v59
v_mfma_f32_32x32x16_bf16 v[64:79], a[92:95], a[188:191], v[64:79]
ds_read_b128 a[92:95], v9 offset:49152
v_exp_f32 v61, v61
v_add_f32 v34, v34, v60
s_waitcnt lgkmcnt(8)
v_mfma_f32_32x32x16_bf16 a[0:15], a[96:99], v[80:83], a[0:15]
v_exp_f32 v62, v62
v_add_f32 v34, v34, v61
v_cvt_pk_bf16_f32 v86, v60, v61
v_mfma_f32_32x32x16_bf16 a[16:31], a[100:103], v[80:83], a[16:31]
v_exp_f32 v63, v63
v_add_f32 v34, v34, v62
s_add_u32 m0, s27, 40960
v_mfma_f32_32x32x16_bf16 a[32:47], a[104:107], v[80:83], a[32:47]
v_exp_f32 v64, v64
v_add_f32 v34, v34, v63
v_cvt_pk_bf16_f32 v87, v62, v63
v_mfma_f32_32x32x16_bf16 a[48:63], a[108:111], v[80:83], a[48:63]
buffer_load_dwordx4 v22, s[12:15], s58 offen nt lds
v_exp_f32 v65, v65
v_add_f32 v35, v35, v64
v_mfma_f32_32x32x16_bf16 a[0:15], a[112:115], v[84:87], a[0:15]
v_exp_f32 v66, v66
v_add_f32 v35, v35, v65
v_cvt_pk_bf16_f32 v88, v64, v65
v_mfma_f32_32x32x16_bf16 a[16:31], a[116:119], v[84:87], a[16:31]
buffer_load_dwordx4 v23, s[12:15], s58 offen offset:1024 nt lds
v_exp_f32 v67, v67
v_add_f32 v35, v35, v66
v_mfma_f32_32x32x16_bf16 a[32:47], a[120:123], v[84:87], a[32:47]
v_exp_f32 v68, v68
v_add_f32 v35, v35, v67
v_cvt_pk_bf16_f32 v89, v66, v67
s_add_u32 s58, s58, 8192
v_mfma_f32_32x32x16_bf16 a[48:63], a[124:127], v[84:87], a[48:63]
v_exp_f32 v69, v69
v_add_f32 v35, v35, v68
s_add_u32 m0, s30, 40960
s_waitcnt lgkmcnt(0)
v_mfma_f32_32x32x16_bf16 v[48:63], a[64:67], a[128:131], v[96:111]
v_exp_f32 v70, v70
v_add_f32 v35, v35, v69
v_cvt_pk_bf16_f32 v90, v68, v69
v_mfma_f32_32x32x16_bf16 v[48:63], a[68:71], a[132:135], v[48:63]
buffer_load_dwordx4 v24, s[16:19], s59 offen nt lds
v_exp_f32 v71, v71
v_add_f32 v35, v35, v70
v_mfma_f32_32x32x16_bf16 v[48:63], a[72:75], a[144:147], v[48:63]
v_exp_f32 v72, v72
v_add_f32 v35, v35, v71
v_cvt_pk_bf16_f32 v91, v70, v71
v_mfma_f32_32x32x16_bf16 v[48:63], a[76:79], a[148:151], v[48:63]
buffer_load_dwordx4 v24, s[16:19], s59 offen offset:1024 nt lds
v_exp_f32 v73, v73
v_add_f32 v35, v35, v72
v_mfma_f32_32x32x16_bf16 v[48:63], a[80:83], a[160:163], v[48:63]
v_exp_f32 v74, v74
v_add_f32 v35, v35, v73
v_cvt_pk_bf16_f32 v92, v72, v73
s_add_u32 s59, s59, 8192
v_mfma_f32_32x32x16_bf16 v[48:63], a[84:87], a[164:167], v[48:63]
v_exp_f32 v75, v75
v_add_f32 v35, v35, v74
v_mfma_f32_32x32x16_bf16 v[48:63], a[88:91], a[176:179], v[48:63]
v_exp_f32 v76, v76
v_add_f32 v35, v35, v75
v_cvt_pk_bf16_f32 v93, v74, v75
v_mfma_f32_32x32x16_bf16 v[48:63], a[92:95], a[180:183], v[48:63]
v_exp_f32 v77, v77
v_add_f32 v35, v35, v76
v_mfma_f32_32x32x16_bf16 a[192:207], a[96:99], v[88:91], a[192:207]
ds_read_b64_tr_b16 a[96:97], v10 offset:49152
ds_read_b64_tr_b16 a[98:99], v10 offset:50176
v_exp_f32 v78, v78
v_add_f32 v35, v35, v77
v_cvt_pk_bf16_f32 v94, v76, v77
v_mfma_f32_32x32x16_bf16 a[208:223], a[100:103], v[88:91], a[208:223]
ds_read_b64_tr_b16 a[100:101], v11 offset:49152
ds_read_b64_tr_b16 a[102:103], v11 offset:50176
v_exp_f32 v79, v79
v_add_f32 v35, v35, v78
v_mfma_f32_32x32x16_bf16 a[224:239], a[104:107], v[88:91], a[224:239]
ds_read_b64_tr_b16 a[104:105], v12 offset:49152
ds_read_b64_tr_b16 a[106:107], v12 offset:50176
v_exp_f32 v48, v48
v_add_f32 v35, v35, v79
v_cvt_pk_bf16_f32 v95, v78, v79
v_mfma_f32_32x32x16_bf16 a[240:255], a[108:111], v[88:91], a[240:255]
ds_read_b64_tr_b16 a[108:109], v13 offset:49152
ds_read_b64_tr_b16 a[110:111], v13 offset:50176
v_exp_f32 v49, v49
v_add_f32 v34, v34, v48
v_mfma_f32_32x32x16_bf16 a[192:207], a[112:115], v[92:95], a[192:207]
ds_read_b64_tr_b16 a[112:113], v10 offset:53248
ds_read_b64_tr_b16 a[114:115], v10 offset:54272
v_exp_f32 v50, v50
v_add_f32 v34, v34, v49
v_cvt_pk_bf16_f32 v80, v48, v49
v_mfma_f32_32x32x16_bf16 a[208:223], a[116:119], v[92:95], a[208:223]
ds_read_b64_tr_b16 a[116:117], v11 offset:53248
ds_read_b64_tr_b16 a[118:119], v11 offset:54272
v_exp_f32 v51, v51
v_add_f32 v34, v34, v50
v_mfma_f32_32x32x16_bf16 a[224:239], a[120:123], v[92:95], a[224:239]
ds_read_b64_tr_b16 a[120:121], v12 offset:53248
ds_read_b64_tr_b16 a[122:123], v12 offset:54272
v_exp_f32 v52, v52
v_add_f32 v34, v34, v51
v_cvt_pk_bf16_f32 v81, v50, v51
v_mfma_f32_32x32x16_bf16 a[240:255], a[124:127], v[92:95], a[240:255]
ds_read_b64_tr_b16 a[124:125], v13 offset:53248
ds_read_b64_tr_b16 a[126:127], v13 offset:54272
v_exp_f32 v53, v53
v_add_f32 v34, v34, v52
s_waitcnt vmcnt(8)
s_barrier
s_add_u32 s12, s56, 0x4000000
s_addc_u32 s13, s57, 0
s_mov_b32 s14, 8388608
s_mov_b32 s15, 0x20000
v_mfma_f32_32x32x16_bf16 v[64:79], a[64:67], a[136:139], v[112:127]
ds_read_b128 a[64:67], v2 offset:57344
v_exp_f32 v54, v54
v_add_f32 v34, v34, v53
v_cvt_pk_bf16_f32 v82, v52, v53
v_and_b32 v39, 3, v0
v_lshl_add_u32 v39, v39, 1, s93
v_lshlrev_b32 v39, 7, v39
v_add_u32 v39, 0x6000000, v39
v_mfma_f32_32x32x16_bf16 v[64:79], a[68:71], a[140:143], v[64:79]
ds_read_b128 a[68:71], v3 offset:57344
v_exp_f32 v55, v55
v_add_f32 v34, v34, v54
v_mfma_f32_32x32x16_bf16 v[64:79], a[72:75], a[152:155], v[64:79]
ds_read_b128 a[72:75], v4 offset:57344
global_load_dword v38, v39, s[56:57] sc1
v_exp_f32 v56, v56
v_add_f32 v34, v34, v55
v_cvt_pk_bf16_f32 v83, v54, v55
v_mfma_f32_32x32x16_bf16 v[64:79], a[76:79], a[156:159], v[64:79]
ds_read_b128 a[76:79], v5 offset:57344
v_exp_f32 v57, v57
v_add_f32 v34, v34, v56
v_mfma_f32_32x32x16_bf16 v[64:79], a[80:83], a[168:171], v[64:79]
ds_read_b128 a[80:83], v6 offset:57344
v_exp_f32 v58, v58
v_add_f32 v34, v34, v57
v_cvt_pk_bf16_f32 v84, v56, v57
v_mfma_f32_32x32x16_bf16 v[64:79], a[84:87], a[172:175], v[64:79]
ds_read_b128 a[84:87], v7 offset:57344
v_exp_f32 v59, v59
v_add_f32 v34, v34, v58
v_mfma_f32_32x32x16_bf16 v[64:79], a[88:91], a[184:187], v[64:79]
ds_read_b128 a[88:91], v8 offset:57344
v_exp_f32 v60, v60
v_add_f32 v34, v34, v59
v_cvt_pk_bf16_f32 v85, v58, v59
v_mfma_f32_32x32x16_bf16 v[64:79], a[92:95], a[188:191], v[64:79]
ds_read_b128 a[92:95], v9 offset:57344
v_exp_f32 v61, v61
v_add_f32 v34, v34, v60
s_waitcnt lgkmcnt(8)
v_mfma_f32_32x32x16_bf16 a[0:15], a[96:99], v[80:83], a[0:15]
v_exp_f32 v62, v62
v_add_f32 v34, v34, v61
v_cvt_pk_bf16_f32 v86, v60, v61
s_add_u32 m0, s31, 0
s_lshl1_add_u32 s79, s54, s38
v_mfma_f32_32x32x16_bf16 a[16:31], a[100:103], v[80:83], a[16:31]
buffer_load_dwordx4 v25, s[84:87], s79 offen offset:0 lds
v_exp_f32 v63, v63
v_add_f32 v34, v34, v62
v_mfma_f32_32x32x16_bf16 a[32:47], a[104:107], v[80:83], a[32:47]
v_exp_f32 v64, v64
v_add_f32 v34, v34, v63
v_cvt_pk_bf16_f32 v87, v62, v63
v_mfma_f32_32x32x16_bf16 a[48:63], a[108:111], v[80:83], a[48:63]
buffer_load_dwordx4 v26, s[84:87], s79 offen offset:1024 lds
v_exp_f32 v65, v65
v_add_f32 v35, v35, v64
v_mfma_f32_32x32x16_bf16 a[0:15], a[112:115], v[84:87], a[0:15]
v_exp_f32 v66, v66
v_add_f32 v35, v35, v65
v_cvt_pk_bf16_f32 v88, v64, v65
v_mfma_f32_32x32x16_bf16 a[16:31], a[116:119], v[84:87], a[16:31]
buffer_load_dwordx4 v27, s[84:87], s79 offen offset:2048 lds
v_exp_f32 v67, v67
v_add_f32 v35, v35, v66
v_mfma_f32_32x32x16_bf16 a[32:47], a[120:123], v[84:87], a[32:47]
buffer_load_dwordx4 v28, s[84:87], s79 offen offset:3072 lds
v_exp_f32 v68, v68
v_add_f32 v35, v35, v67
v_cvt_pk_bf16_f32 v89, v66, v67
v_mfma_f32_32x32x16_bf16 a[48:63], a[124:127], v[84:87], a[48:63]
v_exp_f32 v69, v69
v_add_f32 v35, v35, v68
s_add_u32 m0, s31, 65536
s_lshl1_add_u32 s79, s54, s39
s_waitcnt lgkmcnt(0)
v_mfma_f32_32x32x16_bf16 v[48:63], a[64:67], a[128:131], v[96:111]
v_exp_f32 v70, v70
v_add_f32 v35, v35, v69
v_cvt_pk_bf16_f32 v90, v68, v69
v_mfma_f32_32x32x16_bf16 v[48:63], a[68:71], a[132:135], v[48:63]
buffer_load_dwordx4 v25, s[84:87], s79 offen offset:0 lds
v_exp_f32 v71, v71
v_add_f32 v35, v35, v70
v_mfma_f32_32x32x16_bf16 v[48:63], a[72:75], a[144:147], v[48:63]
v_exp_f32 v72, v72
v_add_f32 v35, v35, v71
v_cvt_pk_bf16_f32 v91, v70, v71
v_mfma_f32_32x32x16_bf16 v[48:63], a[76:79], a[148:151], v[48:63]
buffer_load_dwordx4 v26, s[84:87], s79 offen offset:1024 lds
v_exp_f32 v73, v73
v_add_f32 v35, v35, v72
v_mfma_f32_32x32x16_bf16 v[48:63], a[80:83], a[160:163], v[48:63]
v_exp_f32 v74, v74
v_add_f32 v35, v35, v73
v_cvt_pk_bf16_f32 v92, v72, v73
v_mfma_f32_32x32x16_bf16 v[48:63], a[84:87], a[164:167], v[48:63]
buffer_load_dwordx4 v27, s[84:87], s79 offen offset:2048 lds
v_exp_f32 v75, v75
v_add_f32 v35, v35, v74
v_mfma_f32_32x32x16_bf16 v[48:63], a[88:91], a[176:179], v[48:63]
v_exp_f32 v76, v76
v_add_f32 v35, v35, v75
v_cvt_pk_bf16_f32 v93, v74, v75
v_mfma_f32_32x32x16_bf16 v[48:63], a[92:95], a[180:183], v[48:63]
buffer_load_dwordx4 v28, s[84:87], s79 offen offset:3072 lds
v_exp_f32 v77, v77
v_add_f32 v35, v35, v76
v_mfma_f32_32x32x16_bf16 a[192:207], a[96:99], v[88:91], a[192:207]
ds_read_b64_tr_b16 a[96:97], v10 offset:57344
ds_read_b64_tr_b16 a[98:99], v10 offset:58368
v_exp_f32 v78, v78
v_add_f32 v35, v35, v77
v_cvt_pk_bf16_f32 v94, v76, v77
v_mfma_f32_32x32x16_bf16 a[208:223], a[100:103], v[88:91], a[208:223]
ds_read_b64_tr_b16 a[100:101], v11 offset:57344
ds_read_b64_tr_b16 a[102:103], v11 offset:58368
v_exp_f32 v79, v79
v_add_f32 v35, v35, v78
v_mfma_f32_32x32x16_bf16 a[224:239], a[104:107], v[88:91], a[224:239]
ds_read_b64_tr_b16 a[104:105], v12 offset:57344
ds_read_b64_tr_b16 a[106:107], v12 offset:58368
v_exp_f32 v48, v48
v_add_f32 v35, v35, v79
v_cvt_pk_bf16_f32 v95, v78, v79
v_mfma_f32_32x32x16_bf16 a[240:255], a[108:111], v[88:91], a[240:255]
ds_read_b64_tr_b16 a[108:109], v13 offset:57344
ds_read_b64_tr_b16 a[110:111], v13 offset:58368
v_exp_f32 v49, v49
v_add_f32 v34, v34, v48
v_mfma_f32_32x32x16_bf16 a[192:207], a[112:115], v[92:95], a[192:207]
ds_read_b64_tr_b16 a[112:113], v10 offset:61440
ds_read_b64_tr_b16 a[114:115], v10 offset:62464
v_exp_f32 v50, v50
v_add_f32 v34, v34, v49
v_cvt_pk_bf16_f32 v80, v48, v49
v_mfma_f32_32x32x16_bf16 a[208:223], a[116:119], v[92:95], a[208:223]
ds_read_b64_tr_b16 a[116:117], v11 offset:61440
ds_read_b64_tr_b16 a[118:119], v11 offset:62464
v_exp_f32 v51, v51
v_add_f32 v34, v34, v50
v_mfma_f32_32x32x16_bf16 a[224:239], a[120:123], v[92:95], a[224:239]
ds_read_b64_tr_b16 a[120:121], v12 offset:61440
ds_read_b64_tr_b16 a[122:123], v12 offset:62464
v_exp_f32 v52, v52
v_add_f32 v34, v34, v51
v_cvt_pk_bf16_f32 v81, v50, v51
v_mfma_f32_32x32x16_bf16 a[240:255], a[124:127], v[92:95], a[240:255]
ds_read_b64_tr_b16 a[124:125], v13 offset:61440
ds_read_b64_tr_b16 a[126:127], v13 offset:62464
v_exp_f32 v53, v53
v_add_f32 v34, v34, v52
s_waitcnt vmcnt(13)
s_barrier
v_mfma_f32_32x32x16_bf16 v[64:79], a[64:67], a[136:139], v[112:127]
ds_read_b128 a[64:67], v2 offset:32768
v_exp_f32 v54, v54
v_add_f32 v34, v34, v53
v_cvt_pk_bf16_f32 v82, v52, v53
v_mfma_f32_32x32x16_bf16 v[64:79], a[68:71], a[140:143], v[64:79]
ds_read_b128 a[68:71], v3 offset:32768
v_exp_f32 v55, v55
v_add_f32 v34, v34, v54
v_mfma_f32_32x32x16_bf16 v[64:79], a[72:75], a[152:155], v[64:79]
ds_read_b128 a[72:75], v4 offset:32768
v_exp_f32 v56, v56
v_add_f32 v34, v34, v55
v_cvt_pk_bf16_f32 v83, v54, v55
v_mfma_f32_32x32x16_bf16 v[64:79], a[76:79], a[156:159], v[64:79]
ds_read_b128 a[76:79], v5 offset:32768
v_exp_f32 v57, v57
v_add_f32 v34, v34, v56
v_mfma_f32_32x32x16_bf16 v[64:79], a[80:83], a[168:171], v[64:79]
ds_read_b128 a[80:83], v6 offset:32768
v_exp_f32 v58, v58
v_add_f32 v34, v34, v57
v_cvt_pk_bf16_f32 v84, v56, v57
v_mfma_f32_32x32x16_bf16 v[64:79], a[84:87], a[172:175], v[64:79]
ds_read_b128 a[84:87], v7 offset:32768
v_exp_f32 v59, v59
v_add_f32 v34, v34, v58
v_mfma_f32_32x32x16_bf16 v[64:79], a[88:91], a[184:187], v[64:79]
ds_read_b128 a[88:91], v8 offset:32768
v_exp_f32 v60, v60
v_add_f32 v34, v34, v59
v_cvt_pk_bf16_f32 v85, v58, v59
v_mfma_f32_32x32x16_bf16 v[64:79], a[92:95], a[188:191], v[64:79]
ds_read_b128 a[92:95], v9 offset:32768
v_exp_f32 v61, v61
v_add_f32 v34, v34, v60
s_waitcnt lgkmcnt(8)
v_mfma_f32_32x32x16_bf16 a[0:15], a[96:99], v[80:83], a[0:15]
v_exp_f32 v62, v62
v_add_f32 v34, v34, v61
v_cvt_pk_bf16_f32 v86, v60, v61
s_add_u32 m0, s31, 16384
s_lshl1_add_u32 s79, s47, s36
v_mfma_f32_32x32x16_bf16 a[16:31], a[100:103], v[80:83], a[16:31]
buffer_load_dwordx4 v25, s[84:87], s79 offen offset:0 lds
v_exp_f32 v63, v63
v_add_f32 v34, v34, v62
v_mfma_f32_32x32x16_bf16 a[32:47], a[104:107], v[80:83], a[32:47]
v_exp_f32 v64, v64
v_add_f32 v34, v34, v63
v_cvt_pk_bf16_f32 v87, v62, v63
v_mfma_f32_32x32x16_bf16 a[48:63], a[108:111], v[80:83], a[48:63]
buffer_load_dwordx4 v26, s[84:87], s79 offen offset:1024 lds
v_exp_f32 v65, v65
v_add_f32 v35, v35, v64
v_mfma_f32_32x32x16_bf16 a[0:15], a[112:115], v[84:87], a[0:15]
v_exp_f32 v66, v66
v_add_f32 v35, v35, v65
v_cvt_pk_bf16_f32 v88, v64, v65
v_mfma_f32_32x32x16_bf16 a[16:31], a[116:119], v[84:87], a[16:31]
buffer_load_dwordx4 v27, s[84:87], s79 offen offset:2048 lds
v_exp_f32 v67, v67
v_add_f32 v35, v35, v66
v_mfma_f32_32x32x16_bf16 a[32:47], a[120:123], v[84:87], a[32:47]
buffer_load_dwordx4 v28, s[84:87], s79 offen offset:3072 lds
v_exp_f32 v68, v68
v_add_f32 v35, v35, v67
v_cvt_pk_bf16_f32 v89, v66, v67
v_mfma_f32_32x32x16_bf16 a[48:63], a[124:127], v[84:87], a[48:63]
v_exp_f32 v69, v69
v_add_f32 v35, v35, v68
s_add_u32 m0, s31, 81920
s_lshl1_add_u32 s79, s47, s37
s_waitcnt lgkmcnt(0)
v_mfma_f32_32x32x16_bf16 v[48:63], a[64:67], a[128:131], v[96:111]
v_exp_f32 v70, v70
v_add_f32 v35, v35, v69
v_cvt_pk_bf16_f32 v90, v68, v69
v_mfma_f32_32x32x16_bf16 v[48:63], a[68:71], a[132:135], v[48:63]
buffer_load_dwordx4 v25, s[84:87], s79 offen offset:0 lds
v_exp_f32 v71, v71
v_add_f32 v35, v35, v70
v_mfma_f32_32x32x16_bf16 v[48:63], a[72:75], a[144:147], v[48:63]
v_exp_f32 v72, v72
v_add_f32 v35, v35, v71
v_cvt_pk_bf16_f32 v91, v70, v71
v_mfma_f32_32x32x16_bf16 v[48:63], a[76:79], a[148:151], v[48:63]
buffer_load_dwordx4 v26, s[84:87], s79 offen offset:1024 lds
v_exp_f32 v73, v73
v_add_f32 v35, v35, v72
v_mfma_f32_32x32x16_bf16 v[48:63], a[80:83], a[160:163], v[48:63]
v_exp_f32 v74, v74
v_add_f32 v35, v35, v73
v_cvt_pk_bf16_f32 v92, v72, v73
v_mfma_f32_32x32x16_bf16 v[48:63], a[84:87], a[164:167], v[48:63]
buffer_load_dwordx4 v27, s[84:87], s79 offen offset:2048 lds
v_exp_f32 v75, v75
v_add_f32 v35, v35, v74
v_mfma_f32_32x32x16_bf16 v[48:63], a[88:91], a[176:179], v[48:63]
v_exp_f32 v76, v76
v_add_f32 v35, v35, v75
v_cvt_pk_bf16_f32 v93, v74, v75
v_mfma_f32_32x32x16_bf16 v[48:63], a[92:95], a[180:183], v[48:63]
buffer_load_dwordx4 v28, s[84:87], s79 offen offset:3072 lds
v_exp_f32 v77, v77
v_add_f32 v35, v35, v76
v_mfma_f32_32x32x16_bf16 a[192:207], a[96:99], v[88:91], a[192:207]
ds_read_b64_tr_b16 a[96:97], v10 offset:32768
ds_read_b64_tr_b16 a[98:99], v10 offset:33792
v_exp_f32 v78, v78
v_add_f32 v35, v35, v77
v_cvt_pk_bf16_f32 v94, v76, v77
v_mfma_f32_32x32x16_bf16 a[208:223], a[100:103], v[88:91], a[208:223]
ds_read_b64_tr_b16 a[100:101], v11 offset:32768
ds_read_b64_tr_b16 a[102:103], v11 offset:33792
v_exp_f32 v79, v79
v_add_f32 v35, v35, v78
v_mfma_f32_32x32x16_bf16 a[224:239], a[104:107], v[88:91], a[224:239]
ds_read_b64_tr_b16 a[104:105], v12 offset:32768
ds_read_b64_tr_b16 a[106:107], v12 offset:33792
v_exp_f32 v48, v48
v_add_f32 v35, v35, v79
v_cvt_pk_bf16_f32 v95, v78, v79
v_mfma_f32_32x32x16_bf16 a[240:255], a[108:111], v[88:91], a[240:255]
ds_read_b64_tr_b16 a[108:109], v13 offset:32768
ds_read_b64_tr_b16 a[110:111], v13 offset:33792
v_exp_f32 v49, v49
v_add_f32 v34, v34, v48
v_mfma_f32_32x32x16_bf16 a[192:207], a[112:115], v[92:95], a[192:207]
ds_read_b64_tr_b16 a[112:113], v10 offset:36864
ds_read_b64_tr_b16 a[114:115], v10 offset:37888
v_exp_f32 v50, v50
v_add_f32 v34, v34, v49
v_cvt_pk_bf16_f32 v80, v48, v49
v_mfma_f32_32x32x16_bf16 a[208:223], a[116:119], v[92:95], a[208:223]
ds_read_b64_tr_b16 a[116:117], v11 offset:36864
ds_read_b64_tr_b16 a[118:119], v11 offset:37888
v_exp_f32 v51, v51
v_add_f32 v34, v34, v50
v_mfma_f32_32x32x16_bf16 a[224:239], a[120:123], v[92:95], a[224:239]
ds_read_b64_tr_b16 a[120:121], v12 offset:36864
ds_read_b64_tr_b16 a[122:123], v12 offset:37888
v_exp_f32 v52, v52
v_add_f32 v34, v34, v51
v_cvt_pk_bf16_f32 v81, v50, v51
v_mfma_f32_32x32x16_bf16 a[240:255], a[124:127], v[92:95], a[240:255]
ds_read_b64_tr_b16 a[124:125], v13 offset:36864
ds_read_b64_tr_b16 a[126:127], v13 offset:37888
v_exp_f32 v53, v53
v_add_f32 v34, v34, v52
s_waitcnt vmcnt(17)
s_barrier
s_waitcnt vmcnt(16)
v_and_b32 v38, 1, v38
v_cmp_eq_u32 vcc, 1, v38
s_nop 3
s_cmp_eq_u64 vcc, -1
s_cbranch_scc1 L_okevenA
v_and_b32 v39, 3, v0
v_lshl_add_u32 v39, v39, 1, s93
v_lshlrev_b32 v39, 7, v39
v_add_u32 v39, 0x6000000, v39
s_mov_b32 s60, 0x200000
L_spinevenA:
global_load_dword v38, v39, s[56:57] sc1
s_waitcnt vmcnt(0)
s_sub_u32 s60, s60, 1
s_cbranch_scc1 L_okevenA
v_and_b32 v38, 1, v38
v_cmp_eq_u32 vcc, 1, v38
s_nop 3
s_cmp_eq_u64 vcc, -1
s_cbranch_scc0 L_spinevenA
L_okevenA:
v_mfma_f32_32x32x16_bf16 v[64:79], a[64:67], a[136:139], v[112:127]
ds_read_b128 a[64:67], v2 offset:40960
v_exp_f32 v54, v54
v_add_f32 v34, v34, v53
v_cvt_pk_bf16_f32 v82, v52, v53
v_mfma_f32_32x32x16_bf16 v[64:79], a[68:71], a[140:143], v[64:79]
ds_read_b128 a[68:71], v3 offset:40960
v_exp_f32 v55, v55
v_add_f32 v34, v34, v54
v_mfma_f32_32x32x16_bf16 v[64:79], a[72:75], a[152:155], v[64:79]
ds_read_b128 a[72:75], v4 offset:40960
v_exp_f32 v56, v56
v_add_f32 v34, v34, v55
v_cvt_pk_bf16_f32 v83, v54, v55
v_mfma_f32_32x32x16_bf16 v[64:79], a[76:79], a[156:159], v[64:79]
ds_read_b128 a[76:79], v5 offset:40960
v_exp_f32 v57, v57
v_add_f32 v34, v34, v56
v_mfma_f32_32x32x16_bf16 v[64:79], a[80:83], a[168:171], v[64:79]
ds_read_b128 a[80:83], v6 offset:40960
v_exp_f32 v58, v58
v_add_f32 v34, v34, v57
v_cvt_pk_bf16_f32 v84, v56, v57
v_mfma_f32_32x32x16_bf16 v[64:79], a[84:87], a[172:175], v[64:79]
ds_read_b128 a[84:87], v7 offset:40960
v_exp_f32 v59, v59
v_add_f32 v34, v34, v58
v_mfma_f32_32x32x16_bf16 v[64:79], a[88:91], a[184:187], v[64:79]
ds_read_b128 a[88:91], v8 offset:40960
v_exp_f32 v60, v60
v_add_f32 v34, v34, v59
v_cvt_pk_bf16_f32 v85, v58, v59
v_mfma_f32_32x32x16_bf16 v[64:79], a[92:95], a[188:191], v[64:79]
ds_read_b128 a[92:95], v9 offset:40960
v_exp_f32 v61, v61
v_add_f32 v34, v34, v60
s_add_u32 s80, s47, 0
s_add_u32 s81, s47, 4096
s_waitcnt lgkmcnt(8)
v_mfma_f32_32x32x16_bf16 a[0:15], a[96:99], v[80:83], a[0:15]
buffer_load_dwordx4 v[144:147], v33, s[4:7], s80 offen offset:0 sc1
v_exp_f32 v62, v62
v_add_f32 v34, v34, v61
v_cvt_pk_bf16_f32 v86, v60, v61
s_add_u32 m0, s31, 49152
s_lshl1_add_u32 s79, s48, s36
v_mfma_f32_32x32x16_bf16 a[16:31], a[100:103], v[80:83], a[16:31]
buffer_load_dwordx4 v25, s[84:87], s79 offen offset:0 lds
v_exp_f32 v63, v63
v_add_f32 v34, v34, v62
v_mfma_f32_32x32x16_bf16 a[32:47], a[104:107], v[80:83], a[32:47]
buffer_load_dwordx4 v[148:151], v33, s[4:7], s80 offen offset:1024 sc1
v_exp_f32 v64, v64
v_add_f32 v34, v34, v63
v_cvt_pk_bf16_f32 v87, v62, v63
v_mfma_f32_32x32x16_bf16 a[48:63], a[108:111], v[80:83], a[48:63]
buffer_load_dwordx4 v26, s[84:87], s79 offen offset:1024 lds
v_exp_f32 v65, v65
v_add_f32 v35, v35, v64
v_mfma_f32_32x32x16_bf16 a[0:15], a[112:115], v[84:87], a[0:15]
buffer_load_dwordx4 v[176:179], v33, s[4:7], s80 offen offset:2048 sc1
v_exp_f32 v66, v66
v_add_f32 v35, v35, v65
v_cvt_pk_bf16_f32 v88, v64, v65
v_mfma_f32_32x32x16_bf16 a[16:31], a[116:119], v[84:87], a[16:31]
buffer_load_dwordx4 v27, s[84:87], s79 offen offset:2048 lds
v_exp_f32 v67, v67
v_add_f32 v35, v35, v66
v_mfma_f32_32x32x16_bf16 a[32:47], a[120:123], v[84:87], a[32:47]
buffer_load_dwordx4 v28, s[84:87], s79 offen offset:3072 lds
v_exp_f32 v68, v68
v_add_f32 v35, v35, v67
v_cvt_pk_bf16_f32 v89, v66, v67
v_mfma_f32_32x32x16_bf16 a[48:63], a[124:127], v[84:87], a[48:63]
buffer_load_dwordx4 v[180:183], v33, s[4:7], s80 offen offset:3072 sc1
v_exp_f32 v69, v69
v_add_f32 v35, v35, v68
s_waitcnt lgkmcnt(0)
v_mfma_f32_32x32x16_bf16 v[48:63], a[64:67], a[128:131], v[96:111]
buffer_load_dwordx4 v[208:211], v33, s[4:7], s81 offen offset:0 sc1
v_exp_f32 v70, v70
v_add_f32 v35, v35, v69
v_cvt_pk_bf16_f32 v90, v68, v69
v_mfma_f32_32x32x16_bf16 v[48:63], a[68:71], a[132:135], v[48:63]
v_exp_f32 v71, v71
v_add_f32 v35, v35, v70
v_mfma_f32_32x32x16_bf16 v[48:63], a[72:75], a[144:147], v[48:63]
buffer_load_dwordx4 v[212:215], v33, s[4:7], s81 offen offset:1024 sc1
v_exp_f32 v72, v72
v_add_f32 v35, v35, v71
v_cvt_pk_bf16_f32 v91, v70, v71
v_mfma_f32_32x32x16_bf16 v[48:63], a[76:79], a[148:151], v[48:63]
v_exp_f32 v73, v73
v_add_f32 v35, v35, v72
v_mfma_f32_32x32x16_bf16 v[48:63], a[80:83], a[160:163], v[48:63]
buffer_load_dwordx4 v[240:243], v33, s[4:7], s81 offen offset:2048 sc1
v_exp_f32 v74, v74
v_add_f32 v35, v35, v73
v_cvt_pk_bf16_f32 v92, v72, v73
v_mfma_f32_32x32x16_bf16 v[48:63], a[84:87], a[164:167], v[48:63]
v_exp_f32 v75, v75
v_add_f32 v35, v35, v74
v_mfma_f32_32x32x16_bf16 v[48:63], a[88:91], a[176:179], v[48:63]
buffer_load_dwordx4 v[244:247], v33, s[4:7], s81 offen offset:3072 sc1
v_exp_f32 v76, v76
v_add_f32 v35, v35, v75
v_cvt_pk_bf16_f32 v93, v74, v75
v_mfma_f32_32x32x16_bf16 v[48:63], a[92:95], a[180:183], v[48:63]
v_exp_f32 v77, v77
v_add_f32 v35, v35, v76
L1_pf2:
v_mfma_f32_32x32x16_bf16 a[192:207], a[96:99], v[88:91], a[192:207]
ds_read_b64_tr_b16 a[96:97], v10 offset:40960
ds_read_b64_tr_b16 a[98:99], v10 offset:41984
v_exp_f32 v78, v78
v_add_f32 v35, v35, v77
v_cvt_pk_bf16_f32 v94, v76, v77
v_mfma_f32_32x32x16_bf16 a[208:223], a[100:103], v[88:91], a[208:223]
ds_read_b64_tr_b16 a[100:101], v11 offset:40960
ds_read_b64_tr_b16 a[102:103], v11 offset:41984
v_exp_f32 v79, v79
v_add_f32 v35, v35, v78
v_mfma_f32_32x32x16_bf16 a[224:239], a[104:107], v[88:91], a[224:239]
ds_read_b64_tr_b16 a[104:105], v12 offset:40960
ds_read_b64_tr_b16 a[106:107], v12 offset:41984
v_exp_f32 v48, v48
v_add_f32 v35, v35, v79
v_cvt_pk_bf16_f32 v95, v78, v79
v_mfma_f32_32x32x16_bf16 a[240:255], a[108:111], v[88:91], a[240:255]
ds_read_b64_tr_b16 a[108:109], v13 offset:40960
ds_read_b64_tr_b16 a[110:111], v13 offset:41984
v_exp_f32 v49, v49
v_add_f32 v34, v34, v48
v_mfma_f32_32x32x16_bf16 a[192:207], a[112:115], v[92:95], a[192:207]
ds_read_b64_tr_b16 a[112:113], v10 offset:45056
ds_read_b64_tr_b16 a[114:115], v10 offset:46080
v_exp_f32 v50, v50
v_add_f32 v34, v34, v49
v_cvt_pk_bf16_f32 v80, v48, v49
v_mfma_f32_32x32x16_bf16 a[208:223], a[116:119], v[92:95], a[208:223]
ds_read_b64_tr_b16 a[116:117], v11 offset:45056
ds_read_b64_tr_b16 a[118:119], v11 offset:46080
v_exp_f32 v51, v51
v_add_f32 v34, v34, v50
v_mfma_f32_32x32x16_bf16 a[224:239], a[120:123], v[92:95], a[224:239]
ds_read_b64_tr_b16 a[120:121], v12 offset:45056
ds_read_b64_tr_b16 a[122:123], v12 offset:46080
v_exp_f32 v52, v52
v_add_f32 v34, v34, v51
v_cvt_pk_bf16_f32 v81, v50, v51
v_mfma_f32_32x32x16_bf16 a[240:255], a[124:127], v[92:95], a[240:255]
ds_read_b64_tr_b16 a[124:125], v13 offset:45056
ds_read_b64_tr_b16 a[126:127], v13 offset:46080
v_exp_f32 v53, v53
v_add_f32 v34, v34, v52
s_waitcnt vmcnt(63)
s_barrier
s_add_u32 m0, s31, 114688
s_lshl1_add_u32 s79, s48, s37
v_mfma_f32_32x32x16_bf16 v[64:79], a[64:67], a[136:139], v[112:127]
buffer_load_dwordx4 v25, s[84:87], s79 offen offset:0 lds
v_exp_f32 v54, v54
v_add_f32 v34, v34, v53
v_cvt_pk_bf16_f32 v82, v52, v53
s_add_u32 s80, s48, 0
s_add_u32 s81, s48, 4096
v_mfma_f32_32x32x16_bf16 v[64:79], a[68:71], a[140:143], v[64:79]
buffer_load_dwordx4 a[128:131], v33, s[4:7], s80 offen offset:0 sc1
v_exp_f32 v55, v55
v_add_f32 v34, v34, v54
v_mfma_f32_32x32x16_bf16 v[64:79], a[72:75], a[152:155], v[64:79]
buffer_load_dwordx4 v26, s[84:87], s79 offen offset:1024 lds
v_exp_f32 v56, v56
v_add_f32 v34, v34, v55
v_cvt_pk_bf16_f32 v83, v54, v55
v_mfma_f32_32x32x16_bf16 v[64:79], a[76:79], a[156:159], v[64:79]
buffer_load_dwordx4 a[132:135], v33, s[4:7], s80 offen offset:1024 sc1
v_exp_f32 v57, v57
v_add_f32 v34, v34, v56
v_mfma_f32_32x32x16_bf16 v[64:79], a[80:83], a[168:171], v[64:79]
buffer_load_dwordx4 v27, s[84:87], s79 offen offset:2048 lds
v_exp_f32 v58, v58
v_add_f32 v34, v34, v57
v_cvt_pk_bf16_f32 v84, v56, v57
v_mfma_f32_32x32x16_bf16 v[64:79], a[84:87], a[172:175], v[64:79]
buffer_load_dwordx4 a[144:147], v33, s[4:7], s80 offen offset:2048 sc1
v_exp_f32 v59, v59
v_add_f32 v34, v34, v58
v_mfma_f32_32x32x16_bf16 v[64:79], a[88:91], a[184:187], v[64:79]
buffer_load_dwordx4 v28, s[84:87], s79 offen offset:3072 lds
v_exp_f32 v60, v60
v_add_f32 v34, v34, v59
v_cvt_pk_bf16_f32 v85, v58, v59
v_mfma_f32_32x32x16_bf16 v[64:79], a[92:95], a[188:191], v[64:79]
buffer_load_dwordx4 a[148:151], v33, s[4:7], s80 offen offset:3072 sc1
v_exp_f32 v61, v61
v_add_f32 v34, v34, v60
s_waitcnt lgkmcnt(0)
v_mfma_f32_32x32x16_bf16 a[0:15], a[96:99], v[80:83], a[0:15]
v_exp_f32 v62, v62
v_add_f32 v34, v34, v61
v_cvt_pk_bf16_f32 v86, v60, v61
v_mfma_f32_32x32x16_bf16 a[16:31], a[100:103], v[80:83], a[16:31]
buffer_load_dwordx4 a[160:163], v33, s[4:7], s81 offen offset:0 sc1
v_exp_f32 v63, v63
v_add_f32 v34, v34, v62
s_nop 1
v_mfma_f32_32x32x16_bf16 a[32:47], a[104:107], v[80:83], a[32:47]
v_exp_f32 v64, v64
v_add_f32 v34, v34, v63
v_cvt_pk_bf16_f32 v87, v62, v63
v_mfma_f32_32x32x16_bf16 a[48:63], a[108:111], v[80:83], a[48:63]
buffer_load_dwordx4 a[164:167], v33, s[4:7], s81 offen offset:1024 sc1
v_exp_f32 v65, v65
v_add_f32 v35, v35, v64
v_mov_b32 v16, v34
v_mfma_f32_32x32x16_bf16 a[0:15], a[112:115], v[84:87], a[0:15]
v_exp_f32 v66, v66
v_add_f32 v35, v35, v65
v_cvt_pk_bf16_f32 v88, v64, v65
v_permlane32_swap_b32 v16, v34
v_mfma_f32_32x32x16_bf16 a[16:31], a[116:119], v[84:87], a[16:31]
buffer_load_dwordx4 a[176:179], v33, s[4:7], s81 offen offset:2048 sc1
v_exp_f32 v67, v67
v_add_f32 v35, v35, v66
v_add_f32 v17, v34, v16
v_cmp_nle_f32_e64 s[70:71], s33, v17
v_rcp_f32 v14, v17
v_mfma_f32_32x32x16_bf16 a[32:47], a[120:123], v[84:87], a[32:47]
v_exp_f32 v68, v68
v_add_f32 v35, v35, v67
v_cvt_pk_bf16_f32 v89, v66, v67
v_cmp_nge_f32_e64 s[72:73], s34, v17
v_mfma_f32_32x32x16_bf16 a[48:63], a[124:127], v[84:87], a[48:63]
buffer_load_dwordx4 a[180:183], v33, s[4:7], s81 offen offset:3072 sc1
v_exp_f32 v69, v69
v_add_f32 v35, v35, v68
s_nop 0
s_or_b64 s[74:75], s[74:75], s[70:71]
s_or_b64 s[74:75], s[74:75], s[72:73]
s_add_u32 s80, s49, 0
s_add_u32 s81, s49, 4096
buffer_load_dwordx4 a[136:139], v33, s[4:7], s80 offen offset:0 sc1
v_exp_f32 v70, v70
v_add_f32 v35, v35, v69
v_cvt_pk_bf16_f32 v90, v68, v69
v_exp_f32 v71, v71
v_add_f32 v35, v35, v70
buffer_load_dwordx4 a[140:143], v33, s[4:7], s80 offen offset:1024 sc1
v_exp_f32 v72, v72
v_add_f32 v35, v35, v71
v_cvt_pk_bf16_f32 v91, v70, v71
v_exp_f32 v73, v73
v_add_f32 v35, v35, v72
buffer_load_dwordx4 a[152:155], v33, s[4:7], s80 offen offset:2048 sc1
v_exp_f32 v74, v74
v_add_f32 v35, v35, v73
v_cvt_pk_bf16_f32 v92, v72, v73
v_exp_f32 v75, v75
v_add_f32 v35, v35, v74
buffer_load_dwordx4 a[156:159], v33, s[4:7], s80 offen offset:3072 sc1
v_exp_f32 v76, v76
v_add_f32 v35, v35, v75
v_cvt_pk_bf16_f32 v93, v74, v75
v_exp_f32 v77, v77
v_add_f32 v35, v35, v76
v_exp_f32 v78, v78
v_add_f32 v35, v35, v77
v_cvt_pk_bf16_f32 v94, v76, v77
v_exp_f32 v79, v79
v_add_f32 v35, v35, v78
v_add_f32 v35, v35, v79
v_cvt_pk_bf16_f32 v95, v78, v79
v_mfma_f32_32x32x16_bf16 a[192:207], a[96:99], v[88:91], a[192:207]
ds_read_b64_tr_b16 v[136:137], v29 offset:0
buffer_load_dwordx4 a[168:171], v33, s[4:7], s81 offen offset:0 sc1
v_mov_b32 v16, v35
v_accvgpr_read_b32 v112, a0
v_accvgpr_read_b32 v113, a1
v_accvgpr_read_b32 v114, a2
v_mfma_f32_32x32x16_bf16 a[208:223], a[100:103], v[88:91], a[208:223]
ds_read_b64_tr_b16 v[138:139], v29 offset:512
v_permlane32_swap_b32 v16, v35
v_accvgpr_read_b32 v115, a3
v_accvgpr_read_b32 v116, a4
v_accvgpr_read_b32 v117, a5
v_accvgpr_read_b32 v118, a6
v_accvgpr_read_b32 v119, a7
v_mfma_f32_32x32x16_bf16 a[224:239], a[104:107], v[88:91], a[224:239]
ds_read_b64_tr_b16 v[140:141], v30 offset:0
buffer_load_dwordx4 a[172:175], v33, s[4:7], s81 offen offset:1024 sc1
v_add_f32 v17, v35, v16
v_cmp_nle_f32_e64 s[70:71], s33, v17
v_rcp_f32 v15, v17
v_cmp_nge_f32_e64 s[72:73], s34, v17
v_mfma_f32_32x32x16_bf16 a[240:255], a[108:111], v[88:91], a[240:255]
ds_read_b64_tr_b16 v[142:143], v30 offset:512
s_nop 0
s_or_b64 s[74:75], s[74:75], s[70:71]
s_or_b64 s[74:75], s[74:75], s[72:73]
v_mul_f32 v112, v14, v112
v_mul_f32 v113, v14, v113
v_mul_f32 v114, v14, v114
v_mfma_f32_32x32x16_bf16 a[192:207], a[112:115], v[92:95], a[192:207]
ds_read_b64_tr_b16 v[152:153], v29 offset:2048
buffer_load_dwordx4 a[184:187], v33, s[4:7], s81 offen offset:2048 sc1
v_mul_f32 v115, v14, v115
v_mul_f32 v116, v14, v116
v_mul_f32 v117, v14, v117
v_mul_f32 v118, v14, v118
v_mfma_f32_32x32x16_bf16 a[208:223], a[116:119], v[92:95], a[208:223]
ds_read_b64_tr_b16 v[154:155], v29 offset:2560
v_mul_f32 v119, v14, v119
v_cvt_pk_bf16_f32 v200, v112, v113
v_cvt_pk_bf16_f32 v201, v114, v115
v_cvt_pk_bf16_f32 v202, v116, v117
v_cvt_pk_bf16_f32 v203, v118, v119
v_accvgpr_read_b32 v120, a8
v_mfma_f32_32x32x16_bf16 a[224:239], a[120:123], v[92:95], a[224:239]
buffer_store_dwordx4 v[200:203], v33, s[20:23], s66 offen offset:0 sc1
ds_read_b64_tr_b16 v[156:157], v30 offset:2048
buffer_load_dwordx4 a[188:191], v33, s[4:7], s81 offen offset:3072 sc1
v_accvgpr_read_b32 v121, a9
v_accvgpr_read_b32 v122, a10
v_accvgpr_read_b32 v123, a11
v_accvgpr_read_b32 v124, a12
v_mfma_f32_32x32x16_bf16 a[240:255], a[124:127], v[92:95], a[240:255]
ds_read_b64_tr_b16 v[158:159], v30 offset:2560
v_accvgpr_read_b32 v125, a13
v_accvgpr_read_b32 v126, a14
v_accvgpr_read_b32 v127, a15
v_mul_f32 v120, v14, v120
v_mul_f32 v121, v14, v121
v_mul_f32 v122, v14, v122
s_add_u32 m0, s31, 32768
s_lshl1_add_u32 s79, s49, s36
s_nop 0
buffer_load_dwordx4 v25, s[84:87], s79 offen offset:0 lds
buffer_load_dwordx4 v26, s[84:87], s79 offen offset:1024 lds
buffer_load_dwordx4 v27, s[84:87], s79 offen offset:2048 lds
buffer_load_dwordx4 v28, s[84:87], s79 offen offset:3072 lds
s_waitcnt vmcnt(63) lgkmcnt(4)
v_mfma_f32_32x32x16_bf16 v[80:95], v[136:139], v[128:131], 0
ds_read_b64_tr_b16 v[168:169], v29 offset:4096
ds_read_b64_tr_b16 v[170:171], v29 offset:4608
v_mul_f32 v123, v14, v123
v_mul_f32 v124, v14, v124
v_mul_f32 v125, v14, v125
v_mul_f32 v126, v14, v126
v_mul_f32 v127, v14, v127
v_mfma_f32_32x32x16_bf16 v[96:111], v[140:143], v[128:131], 0
ds_read_b64_tr_b16 v[172:173], v30 offset:4096
ds_read_b64_tr_b16 v[174:175], v30 offset:4608
v_cvt_pk_bf16_f32 v204, v120, v121
v_cvt_pk_bf16_f32 v205, v122, v123
v_cvt_pk_bf16_f32 v206, v124, v125
v_cvt_pk_bf16_f32 v207, v126, v127
s_nop 1
v_mfma_f32_16x16x32_bf16 v[40:43], v[200:203], v[204:207], 0
s_waitcnt vmcnt(63) lgkmcnt(4)
v_mfma_f32_32x32x16_bf16 v[80:95], v[152:155], v[132:135], v[80:95]
ds_read_b64_tr_b16 v[184:185], v29 offset:6144
ds_read_b64_tr_b16 v[186:187], v29 offset:6656
v_accvgpr_read_b32 v112, a16
v_accvgpr_read_b32 v113, a17
v_accvgpr_read_b32 v114, a18
v_accvgpr_read_b32 v115, a19
v_accvgpr_read_b32 v116, a20
v_mfma_f32_32x32x16_bf16 v[96:111], v[156:159], v[132:135], v[96:111]
ds_read_b64_tr_b16 v[188:189], v30 offset:6144
ds_read_b64_tr_b16 v[190:191], v30 offset:6656
v_accvgpr_read_b32 v117, a21
v_accvgpr_read_b32 v118, a22
v_accvgpr_read_b32 v119, a23
v_mul_f32 v112, v14, v112
v_mul_f32 v113, v14, v113
s_waitcnt vmcnt(63) lgkmcnt(4)
v_mfma_f32_32x32x16_bf16 v[80:95], v[168:171], v[160:163], v[80:95]
ds_read_b64_tr_b16 v[136:137], v29 offset:8192
ds_read_b64_tr_b16 v[138:139], v29 offset:8704
v_mul_f32 v114, v14, v114
v_mul_f32 v115, v14, v115
v_mul_f32 v116, v14, v116
v_mul_f32 v117, v14, v117
v_mul_f32 v118, v14, v118
v_mfma_f32_32x32x16_bf16 v[96:111], v[172:175], v[160:163], v[96:111]
ds_read_b64_tr_b16 v[140:141], v30 offset:8192
ds_read_b64_tr_b16 v[142:143], v30 offset:8704
v_mul_f32 v119, v14, v119
v_cvt_pk_bf16_f32 v216, v112, v113
v_cvt_pk_bf16_f32 v217, v114, v115
v_cvt_pk_bf16_f32 v218, v116, v117
v_cvt_pk_bf16_f32 v219, v118, v119
s_waitcnt vmcnt(63) lgkmcnt(4)
v_mfma_f32_32x32x16_bf16 v[80:95], v[184:187], v[164:167], v[80:95]
ds_read_b64_tr_b16 v[152:153], v29 offset:10240
ds_read_b64_tr_b16 v[154:155], v29 offset:10752
v_accvgpr_read_b32 v120, a24
v_accvgpr_read_b32 v121, a25
v_accvgpr_read_b32 v122, a26
v_accvgpr_read_b32 v123, a27
v_accvgpr_read_b32 v124, a28
v_mfma_f32_32x32x16_bf16 v[96:111], v[188:191], v[164:167], v[96:111]
ds_read_b64_tr_b16 v[156:157], v30 offset:10240
ds_read_b64_tr_b16 v[158:159], v30 offset:10752
v_accvgpr_read_b32 v125, a29
v_accvgpr_read_b32 v126, a30
v_accvgpr_read_b32 v127, a31
v_mul_f32 v120, v14, v120
v_mul_f32 v121, v14, v121
s_waitcnt vmcnt(63) lgkmcnt(4)
v_mfma_f32_32x32x16_bf16 v[80:95], v[136:139], v[192:195], v[80:95]
ds_read_b64_tr_b16 v[168:169], v29 offset:12288
ds_read_b64_tr_b16 v[170:171], v29 offset:12800
v_mul_f32 v122, v14, v122
v_mul_f32 v123, v14, v123
v_mul_f32 v124, v14, v124
v_mul_f32 v125, v14, v125
v_mul_f32 v126, v14, v126
v_mfma_f32_32x32x16_bf16 v[96:111], v[140:143], v[192:195], v[96:111]
ds_read_b64_tr_b16 v[172:173], v30 offset:12288
ds_read_b64_tr_b16 v[174:175], v30 offset:12800
v_mul_f32 v127, v14, v127
v_cvt_pk_bf16_f32 v220, v120, v121
v_cvt_pk_bf16_f32 v221, v122, v123
v_cvt_pk_bf16_f32 v222, v124, v125
v_cvt_pk_bf16_f32 v223, v126, v127
s_waitcnt vmcnt(63) lgkmcnt(4)
v_mfma_f32_32x32x16_bf16 v[80:95], v[152:155], v[196:199], v[80:95]
buffer_store_dwordx4 v[204:207], v33, s[20:23], s66 offen offset:1024 sc1
ds_read_b64_tr_b16 v[184:185], v29 offset:14336
ds_read_b64_tr_b16 v[186:187], v29 offset:14848
s_nop 1
v_mfma_f32_16x16x32_bf16 v[40:43], v[216:219], v[220:223], v[40:43]
v_mfma_f32_32x32x16_bf16 v[96:111], v[156:159], v[196:199], v[96:111]
ds_read_b64_tr_b16 v[188:189], v30 offset:14336
ds_read_b64_tr_b16 v[190:191], v30 offset:14848
v_accvgpr_read_b32 v112, a32
v_accvgpr_read_b32 v113, a33
v_accvgpr_read_b32 v114, a34
v_accvgpr_read_b32 v115, a35
v_accvgpr_read_b32 v116, a36
s_waitcnt vmcnt(63) lgkmcnt(4)
s_barrier
v_mfma_f32_32x32x16_bf16 v[80:95], v[168:171], v[224:227], v[80:95]
ds_read_b64_tr_b16 v[136:137], v29 offset:16384
ds_read_b64_tr_b16 v[138:139], v29 offset:16896
v_accvgpr_read_b32 v117, a37
v_accvgpr_read_b32 v118, a38
v_accvgpr_read_b32 v119, a39
v_mul_f32 v112, v14, v112
v_mul_f32 v113, v14, v113
v_mfma_f32_32x32x16_bf16 v[96:111], v[172:175], v[224:227], v[96:111]
ds_read_b64_tr_b16 v[140:141], v30 offset:16384
ds_read_b64_tr_b16 v[142:143], v30 offset:16896
v_mul_f32 v114, v14, v114
v_mul_f32 v115, v14, v115
v_mul_f32 v116, v14, v116
v_mul_f32 v117, v14, v117
v_mul_f32 v118, v14, v118
s_waitcnt vmcnt(63) lgkmcnt(4)
v_mfma_f32_32x32x16_bf16 v[80:95], v[184:187], v[228:231], v[80:95]
ds_read_b64_tr_b16 v[152:153], v29 offset:18432
ds_read_b64_tr_b16 v[154:155], v29 offset:18944
v_mul_f32 v119, v14, v119
v_cvt_pk_bf16_f32 v232, v112, v113
v_cvt_pk_bf16_f32 v233, v114, v115
v_cvt_pk_bf16_f32 v234, v116, v117
v_cvt_pk_bf16_f32 v235, v118, v119
v_mfma_f32_32x32x16_bf16 v[96:111], v[188:191], v[228:231], v[96:111]
ds_read_b64_tr_b16 v[156:157], v30 offset:18432
ds_read_b64_tr_b16 v[158:159], v30 offset:18944
v_accvgpr_read_b32 v120, a40
v_accvgpr_read_b32 v121, a41
v_accvgpr_read_b32 v122, a42
v_accvgpr_read_b32 v123, a43
v_accvgpr_read_b32 v124, a44
v_and_b32 v39, 3, v0
v_lshl_add_u32 v39, v39, 1, s93
v_xor_b32 v39, 1, v39
v_lshlrev_b32 v39, 7, v39
v_add_u32 v39, 0x6000000, v39
global_load_dword v38, v39, s[56:57] sc1
s_waitcnt vmcnt(63) lgkmcnt(4)
v_mfma_f32_32x32x16_bf16 v[48:63], v[136:139], v[128:131], 0
ds_read_b64_tr_b16 v[168:169], v29 offset:20480
ds_read_b64_tr_b16 v[170:171], v29 offset:20992
v_accvgpr_read_b32 v125, a45
v_accvgpr_read_b32 v126, a46
v_accvgpr_read_b32 v127, a47
v_mul_f32 v120, v14, v120
v_mul_f32 v121, v14, v121
v_mfma_f32_32x32x16_bf16 v[64:79], v[140:143], v[128:131], 0
ds_read_b64_tr_b16 v[172:173], v30 offset:20480
ds_read_b64_tr_b16 v[174:175], v30 offset:20992
v_mul_f32 v122, v14, v122
v_mul_f32 v123, v14, v123
v_mul_f32 v124, v14, v124
v_mul_f32 v125, v14, v125
v_mul_f32 v126, v14, v126
s_waitcnt vmcnt(63) lgkmcnt(4)
v_mfma_f32_32x32x16_bf16 v[48:63], v[152:155], v[132:135], v[48:63]
ds_read_b64_tr_b16 v[184:185], v29 offset:22528
ds_read_b64_tr_b16 v[186:187], v29 offset:23040
v_mul_f32 v127, v14, v127
v_cvt_pk_bf16_f32 v236, v120, v121
v_cvt_pk_bf16_f32 v237, v122, v123
v_cvt_pk_bf16_f32 v238, v124, v125
v_cvt_pk_bf16_f32 v239, v126, v127
v_mfma_f32_32x32x16_bf16 v[64:79], v[156:159], v[132:135], v[64:79]
ds_read_b64_tr_b16 v[188:189], v30 offset:22528
ds_read_b64_tr_b16 v[190:191], v30 offset:23040
s_nop 1
v_mfma_f32_16x16x32_bf16 v[40:43], v[232:235], v[236:239], v[40:43]
s_waitcnt vmcnt(63) lgkmcnt(4)
v_mfma_f32_32x32x16_bf16 v[48:63], v[168:171], v[160:163], v[48:63]
buffer_store_dwordx4 v[216:219], v33, s[20:23], s66 offen offset:2048 sc1
ds_read_b64_tr_b16 v[136:137], v29 offset:24576
ds_read_b64_tr_b16 v[138:139], v29 offset:25088
v_accvgpr_read_b32 v112, a48
v_accvgpr_read_b32 v113, a49
v_accvgpr_read_b32 v114, a50
v_accvgpr_read_b32 v115, a51
v_accvgpr_read_b32 v116, a52
v_mfma_f32_32x32x16_bf16 v[64:79], v[172:175], v[160:163], v[64:79]
ds_read_b64_tr_b16 v[140:141], v30 offset:24576
ds_read_b64_tr_b16 v[142:143], v30 offset:25088
v_accvgpr_read_b32 v117, a53
v_accvgpr_read_b32 v118, a54
v_accvgpr_read_b32 v119, a55
v_mul_f32 v112, v14, v112
v_mul_f32 v113, v14, v113
s_waitcnt vmcnt(63) lgkmcnt(4)
v_mfma_f32_32x32x16_bf16 v[48:63], v[184:187], v[164:167], v[48:63]
ds_read_b64_tr_b16 v[152:153], v29 offset:26624
ds_read_b64_tr_b16 v[154:155], v29 offset:27136
v_mul_f32 v114, v14, v114
v_mul_f32 v115, v14, v115
v_mul_f32 v116, v14, v116
v_mul_f32 v117, v14, v117
v_mul_f32 v118, v14, v118
v_mfma_f32_32x32x16_bf16 v[64:79], v[188:191], v[164:167], v[64:79]
ds_read_b64_tr_b16 v[156:157], v30 offset:26624
ds_read_b64_tr_b16 v[158:159], v30 offset:27136
v_mul_f32 v119, v14, v119
v_cvt_pk_bf16_f32 v248, v112, v113
v_cvt_pk_bf16_f32 v249, v114, v115
v_cvt_pk_bf16_f32 v250, v116, v117
v_cvt_pk_bf16_f32 v251, v118, v119
s_waitcnt vmcnt(63) lgkmcnt(4)
v_mfma_f32_32x32x16_bf16 v[48:63], v[136:139], v[192:195], v[48:63]
ds_read_b64_tr_b16 v[168:169], v29 offset:28672
ds_read_b64_tr_b16 v[170:171], v29 offset:29184
v_accvgpr_read_b32 v120, a56
v_accvgpr_read_b32 v121, a57
v_accvgpr_read_b32 v122, a58
v_accvgpr_read_b32 v123, a59
v_accvgpr_read_b32 v124, a60
v_mfma_f32_32x32x16_bf16 v[64:79], v[140:143], v[192:195], v[64:79]
ds_read_b64_tr_b16 v[172:173], v30 offset:28672
ds_read_b64_tr_b16 v[174:175], v30 offset:29184
v_accvgpr_read_b32 v125, a61
v_accvgpr_read_b32 v126, a62
v_accvgpr_read_b32 v127, a63
v_mul_f32 v120, v14, v120
v_mul_f32 v121, v14, v121
s_waitcnt vmcnt(63) lgkmcnt(4)
v_mfma_f32_32x32x16_bf16 v[48:63], v[152:155], v[196:199], v[48:63]
ds_read_b64_tr_b16 v[184:185], v29 offset:30720
ds_read_b64_tr_b16 v[186:187], v29 offset:31232
v_mul_f32 v122, v14, v122
v_mul_f32 v123, v14, v123
v_mul_f32 v124, v14, v124
v_mul_f32 v125, v14, v125
v_mul_f32 v126, v14, v126
v_mfma_f32_32x32x16_bf16 v[64:79], v[156:159], v[196:199], v[64:79]
ds_read_b64_tr_b16 v[188:189], v30 offset:30720
ds_read_b64_tr_b16 v[190:191], v30 offset:31232
v_mul_f32 v127, v14, v127
v_cvt_pk_bf16_f32 v252, v120, v121
v_cvt_pk_bf16_f32 v253, v122, v123
v_cvt_pk_bf16_f32 v254, v124, v125
v_cvt_pk_bf16_f32 v255, v126, v127
s_waitcnt vmcnt(52) lgkmcnt(4)
s_barrier
v_mfma_f32_32x32x16_bf16 v[48:63], v[168:171], v[224:227], v[48:63]
ds_read_b64_tr_b16 v[136:137], v18 offset:0
ds_read_b64_tr_b16 v[138:139], v18 offset:512
s_nop 1
v_mfma_f32_16x16x32_bf16 v[40:43], v[248:251], v[252:255], v[40:43]
v_mfma_f32_32x32x16_bf16 v[64:79], v[172:175], v[224:227], v[64:79]
ds_read_b64_tr_b16 v[140:141], v19 offset:0
ds_read_b64_tr_b16 v[142:143], v19 offset:512
s_nop 0
s_waitcnt vmcnt(52) lgkmcnt(4)
v_mfma_f32_32x32x16_bf16 v[48:63], v[184:187], v[228:231], v[48:63]
buffer_store_dwordx4 v[220:223], v33, s[20:23], s66 offen offset:3072 sc1
ds_read_b64_tr_b16 v[152:153], v18 offset:2048
ds_read_b64_tr_b16 v[154:155], v18 offset:2560
s_nop 0
v_mfma_f32_32x32x16_bf16 v[64:79], v[188:191], v[228:231], v[64:79]
ds_read_b64_tr_b16 v[156:157], v19 offset:2048
ds_read_b64_tr_b16 v[158:159], v19 offset:2560
v_add_f32 v40, v40, v41
v_add_f32 v42, v42, v43
v_add_f32 v40, v40, v42
v_sub_f32 v40, v40, v40
v_cmp_u_f32_e64 s[70:71], v40, v40
s_waitcnt vmcnt(2)
v_and_b32 v38, 8, v38
v_cmp_eq_u32 vcc, 8, v38
s_nop 3
s_cmp_eq_u64 vcc, -1
s_cbranch_scc1 L_okevenB
v_and_b32 v39, 3, v0
v_lshl_add_u32 v39, v39, 1, s93
v_xor_b32 v39, 1, v39
v_lshlrev_b32 v39, 7, v39
v_add_u32 v39, 0x6000000, v39
s_mov_b32 s60, 0x200000
L_spinevenB:
global_load_dword v38, v39, s[56:57] sc1
s_waitcnt vmcnt(0)
s_sub_u32 s60, s60, 1
s_cbranch_scc1 L_okevenB
v_and_b32 v38, 8, v38
v_cmp_eq_u32 vcc, 8, v38
s_nop 3
s_cmp_eq_u64 vcc, -1
s_cbranch_scc0 L_spinevenB
L_okevenB:
s_waitcnt vmcnt(63) lgkmcnt(4)
v_mfma_f32_32x32x16_bf16 v[80:95], v[136:139], v[200:203], v[80:95]
ds_read_b64_tr_b16 v[168:169], v18 offset:4096
ds_read_b64_tr_b16 v[170:171], v18 offset:4608
s_add_u32 m0, s31, 131072
s_lshl1_add_u32 s79, s49, s37
s_nop 1
v_mfma_f32_32x32x16_bf16 v[96:111], v[140:143], v[200:203], v[96:111]
ds_read_b64_tr_b16 v[172:173], v19 offset:4096
ds_read_b64_tr_b16 v[174:175], v19 offset:4608
s_add_u32 s80, s50, 0
s_add_u32 s81, s50, 4096
buffer_load_dwordx4 a[64:67], v33, s[4:7], s80 offen offset:0 sc1
s_or_b64 s[74:75], s[74:75], s[70:71]
s_waitcnt vmcnt(63) lgkmcnt(4)
v_mfma_f32_32x32x16_bf16 v[80:95], v[152:155], v[204:207], v[80:95]
ds_read_b64_tr_b16 v[184:185], v18 offset:6144
ds_read_b64_tr_b16 v[186:187], v18 offset:6656
buffer_load_dwordx4 v25, s[84:87], s79 offen offset:0 lds
v_accvgpr_read_b32 v112, a192
v_accvgpr_read_b32 v113, a193
v_accvgpr_read_b32 v114, a194
v_mfma_f32_32x32x16_bf16 v[96:111], v[156:159], v[204:207], v[96:111]
ds_read_b64_tr_b16 v[188:189], v19 offset:6144
ds_read_b64_tr_b16 v[190:191], v19 offset:6656
v_accvgpr_read_b32 v115, a195
v_accvgpr_read_b32 v116, a196
v_accvgpr_read_b32 v117, a197
v_accvgpr_read_b32 v118, a198
v_accvgpr_read_b32 v119, a199
s_waitcnt vmcnt(63) lgkmcnt(4)
v_mfma_f32_32x32x16_bf16 v[80:95], v[168:171], v[216:219], v[80:95]
ds_read_b64_tr_b16 v[136:137], v18 offset:8192
ds_read_b64_tr_b16 v[138:139], v18 offset:8704
v_mul_f32 v112, v15, v112
v_mul_f32 v113, v15, v113
v_mul_f32 v114, v15, v114
v_mul_f32 v115, v15, v115
v_mul_f32 v116, v15, v116
v_mfma_f32_32x32x16_bf16 v[96:111], v[172:175], v[216:219], v[96:111]
ds_read_b64_tr_b16 v[140:141], v19 offset:8192
ds_read_b64_tr_b16 v[142:143], v19 offset:8704
buffer_load_dwordx4 a[68:71], v33, s[4:7], s80 offen offset:1024 sc1
v_mul_f32 v117, v15, v117
v_mul_f32 v118, v15, v118
v_mul_f32 v119, v15, v119
s_waitcnt vmcnt(63) lgkmcnt(4)
v_mfma_f32_32x32x16_bf16 v[80:95], v[184:187], v[220:223], v[80:95]
ds_read_b64_tr_b16 v[152:153], v18 offset:10240
ds_read_b64_tr_b16 v[154:155], v18 offset:10752
buffer_load_dwordx4 v26, s[84:87], s79 offen offset:1024 lds
v_cvt_pk_bf16_f32 v112, v112, v113
v_cvt_pk_bf16_f32 v113, v114, v115
v_cvt_pk_bf16_f32 v114, v116, v117
v_mfma_f32_32x32x16_bf16 v[96:111], v[188:191], v[220:223], v[96:111]
ds_read_b64_tr_b16 v[156:157], v19 offset:10240
ds_read_b64_tr_b16 v[158:159], v19 offset:10752
v_cvt_pk_bf16_f32 v115, v118, v119
s_waitcnt vmcnt(63) lgkmcnt(4)
v_mfma_f32_32x32x16_bf16 v[80:95], v[136:139], v[232:235], v[80:95]
buffer_store_dwordx4 v[232:235], v33, s[20:23], s67 offen offset:0 sc1
ds_read_b64_tr_b16 v[168:169], v18 offset:12288
ds_read_b64_tr_b16 v[170:171], v18 offset:12800
v_mfma_f32_32x32x16_bf16 v[96:111], v[140:143], v[232:235], v[96:111]
ds_read_b64_tr_b16 v[172:173], v19 offset:12288
ds_read_b64_tr_b16 v[174:175], v19 offset:12800
buffer_load_dwordx4 a[72:75], v33, s[4:7], s80 offen offset:2048 sc1
s_waitcnt vmcnt(63) lgkmcnt(4)
v_mfma_f32_32x32x16_bf16 v[80:95], v[152:155], v[236:239], v[80:95]
ds_read_b64_tr_b16 v[184:185], v18 offset:14336
ds_read_b64_tr_b16 v[186:187], v18 offset:14848
buffer_load_dwordx4 v27, s[84:87], s79 offen offset:2048 lds
v_mfma_f32_32x32x16_bf16 v[96:111], v[156:159], v[236:239], v[96:111]
ds_read_b64_tr_b16 v[188:189], v19 offset:14336
ds_read_b64_tr_b16 v[190:191], v19 offset:14848
s_waitcnt vmcnt(63) lgkmcnt(4)
s_barrier
v_mfma_f32_32x32x16_bf16 v[80:95], v[168:171], v[248:251], v[80:95]
ds_read_b64_tr_b16 v[136:137], v20 offset:0
ds_read_b64_tr_b16 v[138:139], v20 offset:512
v_mfma_f32_32x32x16_bf16 v[96:111], v[172:175], v[248:251], v[96:111]
ds_read_b64_tr_b16 v[140:141], v21 offset:0
ds_read_b64_tr_b16 v[142:143], v21 offset:512
buffer_load_dwordx4 a[76:79], v33, s[4:7], s80 offen offset:3072 sc1
s_waitcnt vmcnt(63) lgkmcnt(4)
v_mfma_f32_32x32x16_bf16 v[80:95], v[184:187], v[252:255], v[80:95]
ds_read_b64_tr_b16 v[152:153], v20 offset:2048
ds_read_b64_tr_b16 v[154:155], v20 offset:2560
buffer_load_dwordx4 v28, s[84:87], s79 offen offset:3072 lds
v_mfma_f32_32x32x16_bf16 v[96:111], v[188:191], v[252:255], v[96:111]
ds_read_b64_tr_b16 v[156:157], v21 offset:2048
ds_read_b64_tr_b16 v[158:159], v21 offset:2560
s_waitcnt vmcnt(63) lgkmcnt(4)
v_mfma_f32_32x32x16_bf16 v[48:63], v[136:139], v[200:203], v[48:63]
ds_read_b64_tr_b16 v[168:169], v20 offset:4096
ds_read_b64_tr_b16 v[170:171], v20 offset:4608
s_add_u32 m0, s31, 147456
s_lshl1_add_u32 s79, s50, s36
v_mfma_f32_32x32x16_bf16 v[64:79], v[140:143], v[200:203], v[64:79]
ds_read_b64_tr_b16 v[172:173], v21 offset:4096
ds_read_b64_tr_b16 v[174:175], v21 offset:4608
buffer_load_dwordx4 a[80:83], v33, s[4:7], s81 offen offset:0 sc1
s_waitcnt vmcnt(63) lgkmcnt(4)
v_mfma_f32_32x32x16_bf16 v[48:63], v[152:155], v[204:207], v[48:63]
buffer_store_dwordx4 v[236:239], v33, s[20:23], s67 offen offset:1024 sc1
ds_read_b64_tr_b16 v[184:185], v20 offset:6144
ds_read_b64_tr_b16 v[186:187], v20 offset:6656
buffer_load_dwordx4 v25, s[84:87], s79 offen offset:0 lds
v_mfma_f32_32x32x16_bf16 v[64:79], v[156:159], v[204:207], v[64:79]
ds_read_b64_tr_b16 v[188:189], v21 offset:6144
ds_read_b64_tr_b16 v[190:191], v21 offset:6656
s_waitcnt vmcnt(63) lgkmcnt(4)
v_mfma_f32_32x32x16_bf16 v[48:63], v[168:171], v[216:219], v[48:63]
ds_read_b64_tr_b16 v[136:137], v20 offset:8192
ds_read_b64_tr_b16 v[138:139], v20 offset:8704
v_mfma_f32_32x32x16_bf16 v[64:79], v[172:175], v[216:219], v[64:79]
ds_read_b64_tr_b16 v[140:141], v21 offset:8192
ds_read_b64_tr_b16 v[142:143], v21 offset:8704
buffer_load_dwordx4 a[84:87], v33, s[4:7], s81 offen offset:1024 sc1
s_waitcnt vmcnt(63) lgkmcnt(4)
v_mfma_f32_32x32x16_bf16 v[48:63], v[184:187], v[220:223], v[48:63]
ds_read_b64_tr_b16 v[152:153], v20 offset:10240
ds_read_b64_tr_b16 v[154:155], v20 offset:10752
buffer_load_dwordx4 v26, s[84:87], s79 offen offset:1024 lds
v_mfma_f32_32x32x16_bf16 v[64:79], v[188:191], v[220:223], v[64:79]
ds_read_b64_tr_b16 v[156:157], v21 offset:10240
ds_read_b64_tr_b16 v[158:159], v21 offset:10752
s_waitcnt vmcnt(63) lgkmcnt(4)
v_mfma_f32_32x32x16_bf16 v[48:63], v[136:139], v[232:235], v[48:63]
ds_read_b64_tr_b16 v[168:169], v20 offset:12288
ds_read_b64_tr_b16 v[170:171], v20 offset:12800
v_mfma_f32_32x32x16_bf16 v[64:79], v[140:143], v[232:235], v[64:79]
ds_read_b64_tr_b16 v[172:173], v21 offset:12288
ds_read_b64_tr_b16 v[174:175], v21 offset:12800
buffer_load_dwordx4 a[88:91], v33, s[4:7], s81 offen offset:2048 sc1
s_waitcnt vmcnt(63) lgkmcnt(4)
v_mfma_f32_32x32x16_bf16 v[48:63], v[152:155], v[236:239], v[48:63]
ds_read_b64_tr_b16 v[184:185], v20 offset:14336
ds_read_b64_tr_b16 v[186:187], v20 offset:14848
buffer_load_dwordx4 v27, s[84:87], s79 offen offset:2048 lds
v_mfma_f32_32x32x16_bf16 v[64:79], v[156:159], v[236:239], v[64:79]
ds_read_b64_tr_b16 v[188:189], v21 offset:14336
ds_read_b64_tr_b16 v[190:191], v21 offset:14848
s_waitcnt vmcnt(63) lgkmcnt(4)
s_barrier
v_mfma_f32_32x32x16_bf16 v[48:63], v[168:171], v[248:251], v[48:63]
buffer_store_dwordx4 v[248:251], v33, s[20:23], s67 offen offset:2048 sc1
ds_read_b64_tr_b16 v[136:137], v18 offset:16384
ds_read_b64_tr_b16 v[138:139], v18 offset:16896
v_mfma_f32_32x32x16_bf16 v[64:79], v[172:175], v[248:251], v[64:79]
ds_read_b64_tr_b16 v[140:141], v19 offset:16384
ds_read_b64_tr_b16 v[142:143], v19 offset:16896
buffer_load_dwordx4 a[92:95], v33, s[4:7], s81 offen offset:3072 sc1
s_waitcnt vmcnt(63) lgkmcnt(4)
v_mfma_f32_32x32x16_bf16 v[48:63], v[184:187], v[252:255], v[48:63]
ds_read_b64_tr_b16 v[152:153], v18 offset:18432
ds_read_b64_tr_b16 v[154:155], v18 offset:18944
buffer_load_dwordx4 v28, s[84:87], s79 offen offset:3072 lds
v_mfma_f32_32x32x16_bf16 v[64:79], v[188:191], v[252:255], v[64:79]
ds_read_b64_tr_b16 v[156:157], v19 offset:18432
ds_read_b64_tr_b16 v[158:159], v19 offset:18944
s_waitcnt vmcnt(63) lgkmcnt(4)
v_mfma_f32_32x32x16_bf16 v[80:95], v[136:139], v[144:147], v[80:95]
ds_read_b64_tr_b16 v[168:169], v18 offset:20480
ds_read_b64_tr_b16 v[170:171], v18 offset:20992
s_add_u32 m0, s31, 0
s_lshl1_add_u32 s79, s50, s37
s_cmp_lg_u64 s[74:75], 0
s_cselect_b32 s62, 1, 0
s_lshl_b32 s63, s24, 2
v_mfma_f32_32x32x16_bf16 v[96:111], v[140:143], v[144:147], v[96:111]
ds_read_b64_tr_b16 v[172:173], v19 offset:20480
ds_read_b64_tr_b16 v[174:175], v19 offset:20992
s_add_u32 s80, s51, 0
s_add_u32 s81, s51, 4096
buffer_load_dwordx4 a[96:99], v33, s[4:7], s80 offen offset:0 sc1
s_add_u32 s63, s63, 98304
s_waitcnt vmcnt(63) lgkmcnt(4)
v_mfma_f32_32x32x16_bf16 v[80:95], v[152:155], v[148:151], v[80:95]
ds_read_b64_tr_b16 v[184:185], v18 offset:22528
ds_read_b64_tr_b16 v[186:187], v18 offset:23040
buffer_load_dwordx4 v25, s[84:87], s79 offen offset:0 lds
v_mov_b32 v36, s62
v_mov_b32 v37, s63
ds_write_b32 v37, v36
v_mfma_f32_32x32x16_bf16 v[96:111], v[156:159], v[148:151], v[96:111]
ds_read_b64_tr_b16 v[188:189], v19 offset:22528
ds_read_b64_tr_b16 v[190:191], v19 offset:23040
s_waitcnt vmcnt(63) lgkmcnt(5)
v_mfma_f32_32x32x16_bf16 v[80:95], v[168:171], v[176:179], v[80:95]
ds_read_b64_tr_b16 v[136:137], v18 offset:24576
ds_read_b64_tr_b16 v[138:139], v18 offset:25088
v_mfma_f32_32x32x16_bf16 v[96:111], v[172:175], v[176:179], v[96:111]
ds_read_b64_tr_b16 v[140:141], v19 offset:24576
ds_read_b64_tr_b16 v[142:143], v19 offset:25088
buffer_load_dwordx4 a[100:103], v33, s[4:7], s80 offen offset:1024 sc1
s_waitcnt vmcnt(63) lgkmcnt(4)
v_mfma_f32_32x32x16_bf16 v[80:95], v[184:187], v[180:183], v[80:95]
buffer_store_dwordx4 v[252:255], v33, s[20:23], s67 offen offset:3072 sc1
ds_read_b64_tr_b16 v[152:153], v18 offset:26624
ds_read_b64_tr_b16 v[154:155], v18 offset:27136
buffer_load_dwordx4 v26, s[84:87], s79 offen offset:1024 lds
v_mfma_f32_32x32x16_bf16 v[96:111], v[188:191], v[180:183], v[96:111]
ds_read_b64_tr_b16 v[156:157], v19 offset:26624
ds_read_b64_tr_b16 v[158:159], v19 offset:27136
s_waitcnt vmcnt(63) lgkmcnt(4)
v_mfma_f32_32x32x16_bf16 v[80:95], v[136:139], v[208:211], v[80:95]
ds_read_b64_tr_b16 v[168:169], v18 offset:28672
ds_read_b64_tr_b16 v[170:171], v18 offset:29184
v_mfma_f32_32x32x16_bf16 v[96:111], v[140:143], v[208:211], v[96:111]
ds_read_b64_tr_b16 v[172:173], v19 offset:28672
ds_read_b64_tr_b16 v[174:175], v19 offset:29184
buffer_load_dwordx4 a[104:107], v33, s[4:7], s80 offen offset:2048 sc1
s_waitcnt vmcnt(63) lgkmcnt(4)
v_mfma_f32_32x32x16_bf16 v[80:95], v[152:155], v[212:215], v[80:95]
ds_read_b64_tr_b16 v[184:185], v18 offset:30720
ds_read_b64_tr_b16 v[186:187], v18 offset:31232
buffer_load_dwordx4 v27, s[84:87], s79 offen offset:2048 lds
v_mfma_f32_32x32x16_bf16 v[96:111], v[156:159], v[212:215], v[96:111]
ds_read_b64_tr_b16 v[188:189], v19 offset:30720
ds_read_b64_tr_b16 v[190:191], v19 offset:31232
s_waitcnt vmcnt(63) lgkmcnt(4)
s_barrier
v_mfma_f32_32x32x16_bf16 v[80:95], v[168:171], v[240:243], v[80:95]
ds_read_b64_tr_b16 v[136:137], v20 offset:16384
ds_read_b64_tr_b16 v[138:139], v20 offset:16896
v_mfma_f32_32x32x16_bf16 v[96:111], v[172:175], v[240:243], v[96:111]
ds_read_b64_tr_b16 v[140:141], v21 offset:16384
ds_read_b64_tr_b16 v[142:143], v21 offset:16896
buffer_load_dwordx4 a[108:111], v33, s[4:7], s80 offen offset:3072 sc1
s_waitcnt vmcnt(63) lgkmcnt(4)
v_mfma_f32_32x32x16_bf16 v[80:95], v[184:187], v[244:247], v[80:95]
ds_read_b64_tr_b16 v[152:153], v20 offset:18432
ds_read_b64_tr_b16 v[154:155], v20 offset:18944
buffer_load_dwordx4 v28, s[84:87], s79 offen offset:3072 lds
v_mfma_f32_32x32x16_bf16 v[96:111], v[188:191], v[244:247], v[96:111]
ds_read_b64_tr_b16 v[156:157], v21 offset:18432
ds_read_b64_tr_b16 v[158:159], v21 offset:18944
v_mov_b32 v40, 98304
ds_read_b128 v[40:43], v40
s_waitcnt vmcnt(63) lgkmcnt(5)
v_mfma_f32_32x32x16_bf16 v[48:63], v[136:139], v[144:147], v[48:63]
ds_read_b64_tr_b16 v[168:169], v20 offset:20480
ds_read_b64_tr_b16 v[170:171], v20 offset:20992
s_add_u32 m0, s31, 65536
s_lshl1_add_u32 s79, s51, s36
buffer_store_dwordx4 v[112:115], v32, s[20:23], s68 offen offset:0 sc1
v_mfma_f32_32x32x16_bf16 v[64:79], v[140:143], v[144:147], v[64:79]
ds_read_b64_tr_b16 v[172:173], v21 offset:20480
ds_read_b64_tr_b16 v[174:175], v21 offset:20992
buffer_load_dwordx4 a[112:115], v33, s[4:7], s81 offen offset:0 sc1
v_accvgpr_read_b32 v120, a200
v_accvgpr_read_b32 v121, a201
s_waitcnt vmcnt(63) lgkmcnt(5)
v_mfma_f32_32x32x16_bf16 v[48:63], v[152:155], v[148:151], v[48:63]
ds_read_b64_tr_b16 v[184:185], v20 offset:22528
ds_read_b64_tr_b16 v[186:187], v20 offset:23040
buffer_load_dwordx4 v25, s[84:87], s79 offen offset:0 lds
v_accvgpr_read_b32 v122, a202
v_accvgpr_read_b32 v123, a203
v_mfma_f32_32x32x16_bf16 v[64:79], v[156:159], v[148:151], v[64:79]
ds_read_b64_tr_b16 v[188:189], v21 offset:22528
ds_read_b64_tr_b16 v[190:191], v21 offset:23040
v_accvgpr_read_b32 v124, a204
v_accvgpr_read_b32 v125, a205
v_accvgpr_read_b32 v126, a206
v_accvgpr_read_b32 v127, a207
s_waitcnt vmcnt(63) lgkmcnt(4)
v_mfma_f32_32x32x16_bf16 v[48:63], v[168:171], v[176:179], v[48:63]
ds_read_b64_tr_b16 v[136:137], v20 offset:24576
ds_read_b64_tr_b16 v[138:139], v20 offset:25088
v_mul_f32 v120, v15, v120
v_mul_f32 v121, v15, v121
v_mul_f32 v122, v15, v122
v_mul_f32 v123, v15, v123
v_mfma_f32_32x32x16_bf16 v[64:79], v[172:175], v[176:179], v[64:79]
ds_read_b64_tr_b16 v[140:141], v21 offset:24576
ds_read_b64_tr_b16 v[142:143], v21 offset:25088
buffer_load_dwordx4 a[116:119], v33, s[4:7], s81 offen offset:1024 sc1
v_mul_f32 v124, v15, v124
v_mul_f32 v125, v15, v125
s_waitcnt vmcnt(63) lgkmcnt(4)
v_mfma_f32_32x32x16_bf16 v[48:63], v[184:187], v[180:183], v[48:63]
ds_read_b64_tr_b16 v[152:153], v20 offset:26624
ds_read_b64_tr_b16 v[154:155], v20 offset:27136
buffer_load_dwordx4 v26, s[84:87], s79 offen offset:1024 lds
v_mul_f32 v126, v15, v126
v_mul_f32 v127, v15, v127
v_mfma_f32_32x32x16_bf16 v[64:79], v[188:191], v[180:183], v[64:79]
ds_read_b64_tr_b16 v[156:157], v21 offset:26624
ds_read_b64_tr_b16 v[158:159], v21 offset:27136
v_cvt_pk_bf16_f32 v120, v120, v121
v_cvt_pk_bf16_f32 v121, v122, v123
v_cvt_pk_bf16_f32 v122, v124, v125
v_cvt_pk_bf16_f32 v123, v126, v127
s_waitcnt vmcnt(63) lgkmcnt(15)
s_waitcnt lgkmcnt(4)
v_or3_b32 v40, v40, v41, v42
v_or_b32 v40, v40, v43
s_nop 0
v_readfirstlane_b32 s62, v40
s_nop 3
s_andn2_b32 s62, s62, s25
s_cbranch_scc1 L1_redo
v_mfma_f32_32x32x16_bf16 v[48:63], v[136:139], v[208:211], v[48:63]
ds_read_b64_tr_b16 v[168:169], v20 offset:28672
ds_read_b64_tr_b16 v[170:171], v20 offset:29184
v_mfma_f32_32x32x16_bf16 v[64:79], v[140:143], v[208:211], v[64:79]
ds_read_b64_tr_b16 v[172:173], v21 offset:28672
ds_read_b64_tr_b16 v[174:175], v21 offset:29184
buffer_load_dwordx4 a[120:123], v33, s[4:7], s81 offen offset:2048 sc1
s_waitcnt vmcnt(63) lgkmcnt(4)
v_mfma_f32_32x32x16_bf16 v[48:63], v[152:155], v[212:215], v[48:63]
ds_read_b64_tr_b16 v[184:185], v20 offset:30720
ds_read_b64_tr_b16 v[186:187], v20 offset:31232
buffer_load_dwordx4 v27, s[84:87], s79 offen offset:2048 lds
buffer_store_dwordx4 v[120:123], v32, s[20:23], s68 offen offset:1024 sc1
v_mfma_f32_32x32x16_bf16 v[64:79], v[156:159], v[212:215], v[64:79]
ds_read_b64_tr_b16 v[188:189], v21 offset:30720
ds_read_b64_tr_b16 v[190:191], v21 offset:31232
s_nop 0
v_mfma_f32_16x16x32_bf16 v[44:47], v[112:115], v[120:123], 0
s_waitcnt vmcnt(63) lgkmcnt(4)
s_barrier
v_mfma_f32_32x32x16_bf16 v[48:63], v[168:171], v[240:243], v[48:63]
ds_read_b64_tr_b16 v[136:137], v18 offset:49152
ds_read_b64_tr_b16 v[138:139], v18 offset:49664
v_accvgpr_read_b32 v112, a208
v_accvgpr_read_b32 v113, a209
v_accvgpr_read_b32 v114, a210
v_accvgpr_read_b32 v115, a211
v_mfma_f32_32x32x16_bf16 v[64:79], v[172:175], v[240:243], v[64:79]
ds_read_b64_tr_b16 v[140:141], v19 offset:49152
ds_read_b64_tr_b16 v[142:143], v19 offset:49664
buffer_load_dwordx4 a[124:127], v33, s[4:7], s81 offen offset:3072 sc1
v_accvgpr_read_b32 v116, a212
v_accvgpr_read_b32 v117, a213
s_waitcnt vmcnt(63) lgkmcnt(4)
v_mfma_f32_32x32x16_bf16 v[48:63], v[184:187], v[244:247], v[48:63]
ds_read_b64_tr_b16 v[152:153], v18 offset:51200
ds_read_b64_tr_b16 v[154:155], v18 offset:51712
buffer_load_dwordx4 v28, s[84:87], s79 offen offset:3072 lds
v_accvgpr_read_b32 v118, a214
v_accvgpr_read_b32 v119, a215
v_mfma_f32_32x32x16_bf16 v[64:79], v[188:191], v[244:247], v[64:79]
ds_read_b64_tr_b16 v[156:157], v19 offset:51200
ds_read_b64_tr_b16 v[158:159], v19 offset:51712
v_mul_f32 v112, v15, v112
v_mul_f32 v113, v15, v113
v_mul_f32 v114, v15, v114
v_mul_f32 v115, v15, v115
s_waitcnt vmcnt(63) lgkmcnt(4)
v_mfma_f32_32x32x16_bf16 v[80:95], v[136:139], a[128:131], v[80:95]
ds_read_b64_tr_b16 v[168:169], v18 offset:53248
ds_read_b64_tr_b16 v[170:171], v18 offset:53760
s_add_u32 m0, s31, 16384
s_lshl1_add_u32 s79, s51, s37
v_mul_f32 v116, v15, v116
v_mul_f32 v117, v15, v117
v_mfma_f32_32x32x16_bf16 v[96:111], v[140:143], a[128:131], v[96:111]
ds_read_b64_tr_b16 v[172:173], v19 offset:53248
ds_read_b64_tr_b16 v[174:175], v19 offset:53760
s_add_u32 s80, s52, 0
s_add_u32 s81, s52, 4096
buffer_load_dwordx4 a[0:3], v33, s[4:7], s80 offen offset:0 sc1
s_waitcnt vmcnt(63) lgkmcnt(4)
v_mfma_f32_32x32x16_bf16 v[80:95], v[152:155], a[132:135], v[80:95]
ds_read_b64_tr_b16 v[184:185], v18 offset:55296
ds_read_b64_tr_b16 v[186:187], v18 offset:55808
buffer_load_dwordx4 v25, s[84:87], s79 offen offset:0 lds
v_mul_f32 v118, v15, v118
v_mul_f32 v119, v15, v119
v_mfma_f32_32x32x16_bf16 v[96:111], v[156:159], a[132:135], v[96:111]
ds_read_b64_tr_b16 v[188:189], v19 offset:55296
ds_read_b64_tr_b16 v[190:191], v19 offset:55808
v_cvt_pk_bf16_f32 v112, v112, v113
v_cvt_pk_bf16_f32 v113, v114, v115
v_cvt_pk_bf16_f32 v114, v116, v117
v_cvt_pk_bf16_f32 v115, v118, v119
s_waitcnt vmcnt(63) lgkmcnt(4)
v_mfma_f32_32x32x16_bf16 v[80:95], v[168:171], a[144:147], v[80:95]
ds_read_b64_tr_b16 v[136:137], v18 offset:57344
ds_read_b64_tr_b16 v[138:139], v18 offset:57856
buffer_store_dwordx4 v[112:115], v32, s[20:23], s68 offen offset:2048 sc1
v_accvgpr_read_b32 v120, a216
v_accvgpr_read_b32 v121, a217
v_mfma_f32_32x32x16_bf16 v[96:111], v[172:175], a[144:147], v[96:111]
ds_read_b64_tr_b16 v[140:141], v19 offset:57344
ds_read_b64_tr_b16 v[142:143], v19 offset:57856
buffer_load_dwordx4 a[4:7], v33, s[4:7], s80 offen offset:1024 sc1
v_accvgpr_read_b32 v122, a218
v_accvgpr_read_b32 v123, a219
s_waitcnt vmcnt(63) lgkmcnt(4)
v_mfma_f32_32x32x16_bf16 v[80:95], v[184:187], a[148:151], v[80:95]
ds_read_b64_tr_b16 v[152:153], v18 offset:59392
ds_read_b64_tr_b16 v[154:155], v18 offset:59904
buffer_load_dwordx4 v26, s[84:87], s79 offen offset:1024 lds
v_accvgpr_read_b32 v124, a220
v_accvgpr_read_b32 v125, a221
v_mfma_f32_32x32x16_bf16 v[96:111], v[188:191], a[148:151], v[96:111]
ds_read_b64_tr_b16 v[156:157], v19 offset:59392
ds_read_b64_tr_b16 v[158:159], v19 offset:59904
v_accvgpr_read_b32 v126, a222
v_accvgpr_read_b32 v127, a223
v_mul_f32 v120, v15, v120
v_mul_f32 v121, v15, v121
s_waitcnt vmcnt(63) lgkmcnt(4)
v_mfma_f32_32x32x16_bf16 v[80:95], v[136:139], a[160:163], v[80:95]
ds_read_b64_tr_b16 v[168:169], v18 offset:61440
ds_read_b64_tr_b16 v[170:171], v18 offset:61952
v_mul_f32 v122, v15, v122
v_mul_f32 v123, v15, v123
v_mul_f32 v124, v15, v124
v_mul_f32 v125, v15, v125
v_mfma_f32_32x32x16_bf16 v[96:111], v[140:143], a[160:163], v[96:111]
ds_read_b64_tr_b16 v[172:173], v19 offset:61440
ds_read_b64_tr_b16 v[174:175], v19 offset:61952
buffer_load_dwordx4 a[8:11], v33, s[4:7], s80 offen offset:2048 sc1
v_mul_f32 v126, v15, v126
v_mul_f32 v127, v15, v127
s_waitcnt vmcnt(63) lgkmcnt(4)
v_mfma_f32_32x32x16_bf16 v[80:95], v[152:155], a[164:167], v[80:95]
ds_read_b64_tr_b16 v[184:185], v18 offset:63488
ds_read_b64_tr_b16 v[186:187], v18 offset:64000
buffer_load_dwordx4 v27, s[84:87], s79 offen offset:2048 lds
v_cvt_pk_bf16_f32 v120, v120, v121
v_cvt_pk_bf16_f32 v121, v122, v123
v_mfma_f32_32x32x16_bf16 v[96:111], v[156:159], a[164:167], v[96:111]
ds_read_b64_tr_b16 v[188:189], v19 offset:63488
ds_read_b64_tr_b16 v[190:191], v19 offset:64000
v_cvt_pk_bf16_f32 v122, v124, v125
v_cvt_pk_bf16_f32 v123, v126, v127
s_waitcnt vmcnt(22) lgkmcnt(4)
s_barrier
s_cmp_lg_u32 s24, 0
s_cbranch_scc1 L_sigoddA
s_lshl_b32 s62, s92, 7
s_add_u32 s62, s62, 0x6000000
v_mov_b32 v16, s62
v_mov_b32 v17, 11
s_mov_b64 exec, 1
global_store_dword v16, v17, s[56:57] sc1
s_mov_b64 exec, -1
L_sigoddA:
v_mfma_f32_32x32x16_bf16 v[80:95], v[168:171], a[176:179], v[80:95]
ds_read_b64_tr_b16 v[136:137], v20 offset:49152
ds_read_b64_tr_b16 v[138:139], v20 offset:49664
v_mfma_f32_32x32x16_bf16 v[96:111], v[172:175], a[176:179], v[96:111]
ds_read_b64_tr_b16 v[140:141], v21 offset:49152
ds_read_b64_tr_b16 v[142:143], v21 offset:49664
buffer_load_dwordx4 a[12:15], v33, s[4:7], s80 offen offset:3072 sc1
s_waitcnt vmcnt(63) lgkmcnt(4)
v_mfma_f32_32x32x16_bf16 v[80:95], v[184:187], a[180:183], v[80:95]
ds_read_b64_tr_b16 v[152:153], v20 offset:51200
ds_read_b64_tr_b16 v[154:155], v20 offset:51712
buffer_load_dwordx4 v28, s[84:87], s79 offen offset:3072 lds
buffer_store_dwordx4 v[120:123], v32, s[20:23], s68 offen offset:3072 sc1
v_mfma_f32_32x32x16_bf16 v[96:111], v[188:191], a[180:183], v[96:111]
ds_read_b64_tr_b16 v[156:157], v21 offset:51200
ds_read_b64_tr_b16 v[158:159], v21 offset:51712
s_nop 0
v_mfma_f32_16x16x32_bf16 v[44:47], v[112:115], v[120:123], v[44:47]
s_waitcnt vmcnt(63) lgkmcnt(4)
v_mfma_f32_32x32x16_bf16 v[48:63], v[136:139], a[128:131], v[48:63]
ds_read_b64_tr_b16 v[168:169], v20 offset:53248
ds_read_b64_tr_b16 v[170:171], v20 offset:53760
s_add_u32 m0, s31, 81920
s_lshl1_add_u32 s79, s52, s36
v_accvgpr_read_b32 v112, a224
v_accvgpr_read_b32 v113, a225
v_mfma_f32_32x32x16_bf16 v[64:79], v[140:143], a[128:131], v[64:79]
ds_read_b64_tr_b16 v[172:173], v21 offset:53248
ds_read_b64_tr_b16 v[174:175], v21 offset:53760
buffer_load_dwordx4 a[16:19], v33, s[4:7], s81 offen offset:0 sc1
v_accvgpr_read_b32 v114, a226
v_accvgpr_read_b32 v115, a227
s_waitcnt vmcnt(63) lgkmcnt(4)
v_mfma_f32_32x32x16_bf16 v[48:63], v[152:155], a[132:135], v[48:63]
ds_read_b64_tr_b16 v[184:185], v20 offset:55296
ds_read_b64_tr_b16 v[186:187], v20 offset:55808
buffer_load_dwordx4 v25, s[84:87], s79 offen offset:0 lds
v_accvgpr_read_b32 v116, a228
v_accvgpr_read_b32 v117, a229
v_mfma_f32_32x32x16_bf16 v[64:79], v[156:159], a[132:135], v[64:79]
ds_read_b64_tr_b16 v[188:189], v21 offset:55296
ds_read_b64_tr_b16 v[190:191], v21 offset:55808
v_accvgpr_read_b32 v118, a230
v_accvgpr_read_b32 v119, a231
v_mul_f32 v112, v15, v112
v_mul_f32 v113, v15, v113
s_waitcnt vmcnt(63) lgkmcnt(4)
v_mfma_f32_32x32x16_bf16 v[48:63], v[168:171], a[144:147], v[48:63]
ds_read_b64_tr_b16 v[136:137], v20 offset:57344
ds_read_b64_tr_b16 v[138:139], v20 offset:57856
v_mul_f32 v114, v15, v114
v_mul_f32 v115, v15, v115
v_mul_f32 v116, v15, v116
v_mul_f32 v117, v15, v117
v_mfma_f32_32x32x16_bf16 v[64:79], v[172:175], a[144:147], v[64:79]
ds_read_b64_tr_b16 v[140:141], v21 offset:57344
ds_read_b64_tr_b16 v[142:143], v21 offset:57856
buffer_load_dwordx4 a[20:23], v33, s[4:7], s81 offen offset:1024 sc1
v_mul_f32 v118, v15, v118
v_mul_f32 v119, v15, v119
s_waitcnt vmcnt(63) lgkmcnt(4)
v_mfma_f32_32x32x16_bf16 v[48:63], v[184:187], a[148:151], v[48:63]
ds_read_b64_tr_b16 v[152:153], v20 offset:59392
ds_read_b64_tr_b16 v[154:155], v20 offset:59904
buffer_load_dwordx4 v26, s[84:87], s79 offen offset:1024 lds
v_cvt_pk_bf16_f32 v112, v112, v113
v_cvt_pk_bf16_f32 v113, v114, v115
v_mfma_f32_32x32x16_bf16 v[64:79], v[188:191], a[148:151], v[64:79]
ds_read_b64_tr_b16 v[156:157], v21 offset:59392
ds_read_b64_tr_b16 v[158:159], v21 offset:59904
v_cvt_pk_bf16_f32 v114, v116, v117
v_cvt_pk_bf16_f32 v115, v118, v119
s_waitcnt vmcnt(63) lgkmcnt(4)
v_mfma_f32_32x32x16_bf16 v[48:63], v[136:139], a[160:163], v[48:63]
ds_read_b64_tr_b16 v[168:169], v20 offset:61440
ds_read_b64_tr_b16 v[170:171], v20 offset:61952
buffer_store_dwordx4 v[112:115], v32, s[20:23], s69 offen offset:0 sc1
v_accvgpr_read_b32 v120, a232
v_accvgpr_read_b32 v121, a233
v_mfma_f32_32x32x16_bf16 v[64:79], v[140:143], a[160:163], v[64:79]
ds_read_b64_tr_b16 v[172:173], v21 offset:61440
ds_read_b64_tr_b16 v[174:175], v21 offset:61952
buffer_load_dwordx4 a[24:27], v33, s[4:7], s81 offen offset:2048 sc1
v_accvgpr_read_b32 v122, a234
v_accvgpr_read_b32 v123, a235
s_waitcnt vmcnt(63) lgkmcnt(4)
v_mfma_f32_32x32x16_bf16 v[48:63], v[152:155], a[164:167], v[48:63]
ds_read_b64_tr_b16 v[184:185], v20 offset:63488
ds_read_b64_tr_b16 v[186:187], v20 offset:64000
buffer_load_dwordx4 v27, s[84:87], s79 offen offset:2048 lds
v_accvgpr_read_b32 v124, a236
v_accvgpr_read_b32 v125, a237
v_mfma_f32_32x32x16_bf16 v[64:79], v[156:159], a[164:167], v[64:79]
ds_read_b64_tr_b16 v[188:189], v21 offset:63488
ds_read_b64_tr_b16 v[190:191], v21 offset:64000
v_accvgpr_read_b32 v126, a238
v_accvgpr_read_b32 v127, a239
v_mul_f32 v120, v15, v120
v_mul_f32 v121, v15, v121
s_waitcnt vmcnt(63) lgkmcnt(4)
s_barrier
v_mfma_f32_32x32x16_bf16 v[48:63], v[168:171], a[176:179], v[48:63]
ds_read_b64_tr_b16 v[136:137], v18 offset:32768
ds_read_b64_tr_b16 v[138:139], v18 offset:33280
v_mul_f32 v122, v15, v122
v_mul_f32 v123, v15, v123
v_mul_f32 v124, v15, v124
v_mul_f32 v125, v15, v125
v_mfma_f32_32x32x16_bf16 v[64:79], v[172:175], a[176:179], v[64:79]
ds_read_b64_tr_b16 v[140:141], v19 offset:32768
ds_read_b64_tr_b16 v[142:143], v19 offset:33280
buffer_load_dwordx4 a[28:31], v33, s[4:7], s81 offen offset:3072 sc1
v_mul_f32 v126, v15, v126
v_mul_f32 v127, v15, v127
s_waitcnt vmcnt(63) lgkmcnt(4)
v_mfma_f32_32x32x16_bf16 v[48:63], v[184:187], a[180:183], v[48:63]
ds_read_b64_tr_b16 v[152:153], v18 offset:34816
ds_read_b64_tr_b16 v[154:155], v18 offset:35328
buffer_load_dwordx4 v28, s[84:87], s79 offen offset:3072 lds
v_cvt_pk_bf16_f32 v120, v120, v121
v_cvt_pk_bf16_f32 v121, v122, v123
v_mfma_f32_32x32x16_bf16 v[64:79], v[188:191], a[180:183], v[64:79]
ds_read_b64_tr_b16 v[156:157], v19 offset:34816
ds_read_b64_tr_b16 v[158:159], v19 offset:35328
v_cvt_pk_bf16_f32 v122, v124, v125
v_cvt_pk_bf16_f32 v123, v126, v127
s_waitcnt vmcnt(63) lgkmcnt(4)
v_mfma_f32_32x32x16_bf16 v[80:95], v[136:139], a[136:139], v[80:95]
ds_read_b64_tr_b16 v[168:169], v18 offset:36864
ds_read_b64_tr_b16 v[170:171], v18 offset:37376
s_add_u32 m0, s31, 49152
s_lshl1_add_u32 s79, s52, s37
v_mfma_f32_32x32x16_bf16 v[96:111], v[140:143], a[136:139], v[96:111]
ds_read_b64_tr_b16 v[172:173], v19 offset:36864
ds_read_b64_tr_b16 v[174:175], v19 offset:37376
s_add_u32 s80, s53, 0
s_add_u32 s81, s53, 4096
buffer_load_dwordx4 a[32:35], v33, s[4:7], s80 offen offset:0 sc1
s_waitcnt vmcnt(63) lgkmcnt(4)
v_mfma_f32_32x32x16_bf16 v[80:95], v[152:155], a[140:143], v[80:95]
ds_read_b64_tr_b16 v[184:185], v18 offset:38912
ds_read_b64_tr_b16 v[186:187], v18 offset:39424
buffer_load_dwordx4 v25, s[84:87], s79 offen offset:0 lds
buffer_store_dwordx4 v[120:123], v32, s[20:23], s69 offen offset:1024 sc1
v_mfma_f32_32x32x16_bf16 v[96:111], v[156:159], a[140:143], v[96:111]
ds_read_b64_tr_b16 v[188:189], v19 offset:38912
ds_read_b64_tr_b16 v[190:191], v19 offset:39424
s_nop 0
v_mfma_f32_16x16x32_bf16 v[44:47], v[112:115], v[120:123], v[44:47]
s_waitcnt vmcnt(63) lgkmcnt(4)
v_mfma_f32_32x32x16_bf16 v[80:95], v[168:171], a[152:155], v[80:95]
ds_read_b64_tr_b16 v[136:137], v18 offset:40960
ds_read_b64_tr_b16 v[138:139], v18 offset:41472
v_accvgpr_read_b32 v112, a240
v_accvgpr_read_b32 v113, a241
v_accvgpr_read_b32 v114, a242
v_accvgpr_read_b32 v115, a243
v_mfma_f32_32x32x16_bf16 v[96:111], v[172:175], a[152:155], v[96:111]
ds_read_b64_tr_b16 v[140:141], v19 offset:40960
ds_read_b64_tr_b16 v[142:143], v19 offset:41472
buffer_load_dwordx4 a[36:39], v33, s[4:7], s80 offen offset:1024 sc1
v_accvgpr_read_b32 v116, a244
v_accvgpr_read_b32 v117, a245
s_waitcnt vmcnt(63) lgkmcnt(4)
v_mfma_f32_32x32x16_bf16 v[80:95], v[184:187], a[156:159], v[80:95]
ds_read_b64_tr_b16 v[152:153], v18 offset:43008
ds_read_b64_tr_b16 v[154:155], v18 offset:43520
buffer_load_dwordx4 v26, s[84:87], s79 offen offset:1024 lds
v_accvgpr_read_b32 v118, a246
v_accvgpr_read_b32 v119, a247
v_mfma_f32_32x32x16_bf16 v[96:111], v[188:191], a[156:159], v[96:111]
ds_read_b64_tr_b16 v[156:157], v19 offset:43008
ds_read_b64_tr_b16 v[158:159], v19 offset:43520
v_mul_f32 v112, v15, v112
v_mul_f32 v113, v15, v113
v_mul_f32 v114, v15, v114
v_mul_f32 v115, v15, v115
s_waitcnt vmcnt(63) lgkmcnt(4)
v_mfma_f32_32x32x16_bf16 v[80:95], v[136:139], a[168:171], v[80:95]
ds_read_b64_tr_b16 v[168:169], v18 offset:45056
ds_read_b64_tr_b16 v[170:171], v18 offset:45568
v_mul_f32 v116, v15, v116
v_mul_f32 v117, v15, v117
v_mul_f32 v118, v15, v118
v_mul_f32 v119, v15, v119
v_mfma_f32_32x32x16_bf16 v[96:111], v[140:143], a[168:171], v[96:111]
ds_read_b64_tr_b16 v[172:173], v19 offset:45056
ds_read_b64_tr_b16 v[174:175], v19 offset:45568
buffer_load_dwordx4 a[40:43], v33, s[4:7], s80 offen offset:2048 sc1
v_cvt_pk_bf16_f32 v112, v112, v113
v_cvt_pk_bf16_f32 v113, v114, v115
s_waitcnt vmcnt(63) lgkmcnt(4)
v_mfma_f32_32x32x16_bf16 v[80:95], v[152:155], a[172:175], v[80:95]
ds_read_b64_tr_b16 v[184:185], v18 offset:47104
ds_read_b64_tr_b16 v[186:187], v18 offset:47616
buffer_load_dwordx4 v27, s[84:87], s79 offen offset:2048 lds
v_cvt_pk_bf16_f32 v114, v116, v117
v_cvt_pk_bf16_f32 v115, v118, v119
v_mfma_f32_32x32x16_bf16 v[96:111], v[156:159], a[172:175], v[96:111]
ds_read_b64_tr_b16 v[188:189], v19 offset:47104
ds_read_b64_tr_b16 v[190:191], v19 offset:47616
s_waitcnt vmcnt(63) lgkmcnt(4)
s_barrier
v_mfma_f32_32x32x16_bf16 v[80:95], v[168:171], a[184:187], v[80:95]
ds_read_b64_tr_b16 v[136:137], v29 offset:0
ds_read_b64_tr_b16 v[138:139], v29 offset:512
buffer_store_dwordx4 v[112:115], v32, s[20:23], s69 offen offset:2048 sc1
v_accvgpr_read_b32 v120, a248
v_accvgpr_read_b32 v121, a249
v_mfma_f32_32x32x16_bf16 v[96:111], v[172:175], a[184:187], v[96:111]
ds_read_b64_tr_b16 v[140:141], v30 offset:0
ds_read_b64_tr_b16 v[142:143], v30 offset:512
buffer_load_dwordx4 a[44:47], v33, s[4:7], s80 offen offset:3072 sc1
v_accvgpr_read_b32 v122, a250
v_accvgpr_read_b32 v123, a251
s_waitcnt vmcnt(63) lgkmcnt(4)
v_mfma_f32_32x32x16_bf16 v[80:95], v[184:187], a[188:191], v[80:95]
ds_read_b64_tr_b16 v[152:153], v29 offset:2048
ds_read_b64_tr_b16 v[154:155], v29 offset:2560
buffer_load_dwordx4 v28, s[84:87], s79 offen offset:3072 lds
v_accvgpr_read_b32 v124, a252
v_accvgpr_read_b32 v125, a253
v_mfma_f32_32x32x16_bf16 v[96:111], v[188:191], a[188:191], v[96:111]
ds_read_b64_tr_b16 v[156:157], v30 offset:2048
ds_read_b64_tr_b16 v[158:159], v30 offset:2560
v_accvgpr_read_b32 v126, a254
v_accvgpr_read_b32 v127, a255
v_mul_f32 v120, v15, v120
v_mul_f32 v121, v15, v121
s_waitcnt vmcnt(63) lgkmcnt(4)
v_mfma_f32_32x32x16_bf16 v[48:63], v[136:139], a[136:139], v[48:63]
ds_read_b64_tr_b16 v[168:169], v29 offset:4096
ds_read_b64_tr_b16 v[170:171], v29 offset:4608
s_add_u32 m0, s31, 114688
s_lshl1_add_u32 s79, s53, s36
v_mul_f32 v122, v15, v122
v_mul_f32 v123, v15, v123
v_mfma_f32_32x32x16_bf16 v[64:79], v[140:143], a[136:139], v[64:79]
ds_read_b64_tr_b16 v[172:173], v30 offset:4096
ds_read_b64_tr_b16 v[174:175], v30 offset:4608
buffer_load_dwordx4 a[48:51], v33, s[4:7], s81 offen offset:0 sc1
v_mul_f32 v124, v15, v124
v_mul_f32 v125, v15, v125
s_waitcnt vmcnt(63) lgkmcnt(4)
v_mfma_f32_32x32x16_bf16 v[48:63], v[152:155], a[140:143], v[48:63]
ds_read_b64_tr_b16 v[184:185], v29 offset:6144
ds_read_b64_tr_b16 v[186:187], v29 offset:6656
buffer_load_dwordx4 v25, s[84:87], s79 offen offset:0 lds
v_mul_f32 v126, v15, v126
v_mul_f32 v127, v15, v127
v_mfma_f32_32x32x16_bf16 v[64:79], v[156:159], a[140:143], v[64:79]
ds_read_b64_tr_b16 v[188:189], v30 offset:6144
ds_read_b64_tr_b16 v[190:191], v30 offset:6656
v_cvt_pk_bf16_f32 v120, v120, v121
v_cvt_pk_bf16_f32 v121, v122, v123
v_cvt_pk_bf16_f32 v122, v124, v125
v_cvt_pk_bf16_f32 v123, v126, v127
s_waitcnt vmcnt(63) lgkmcnt(4)
v_mfma_f32_32x32x16_bf16 v[48:63], v[168:171], a[152:155], v[48:63]
ds_read_b64_tr_b16 v[136:137], v29 offset:8192
ds_read_b64_tr_b16 v[138:139], v29 offset:8704
v_mfma_f32_32x32x16_bf16 v[64:79], v[172:175], a[152:155], v[64:79]
ds_read_b64_tr_b16 v[140:141], v30 offset:8192
ds_read_b64_tr_b16 v[142:143], v30 offset:8704
buffer_load_dwordx4 a[52:55], v33, s[4:7], s81 offen offset:1024 sc1
s_waitcnt vmcnt(63) lgkmcnt(4)
v_mfma_f32_32x32x16_bf16 v[48:63], v[184:187], a[156:159], v[48:63]
ds_read_b64_tr_b16 v[152:153], v29 offset:10240
ds_read_b64_tr_b16 v[154:155], v29 offset:10752
buffer_load_dwordx4 v26, s[84:87], s79 offen offset:1024 lds
buffer_store_dwordx4 v[120:123], v32, s[20:23], s69 offen offset:3072 sc1
v_mfma_f32_32x32x16_bf16 v[64:79], v[188:191], a[156:159], v[64:79]
ds_read_b64_tr_b16 v[156:157], v30 offset:10240
ds_read_b64_tr_b16 v[158:159], v30 offset:10752
s_nop 0
v_mfma_f32_16x16x32_bf16 v[44:47], v[112:115], v[120:123], v[44:47]
s_waitcnt vmcnt(63) lgkmcnt(4)
v_mfma_f32_32x32x16_bf16 v[48:63], v[136:139], a[168:171], v[48:63]
ds_read_b64_tr_b16 v[168:169], v29 offset:12288
ds_read_b64_tr_b16 v[170:171], v29 offset:12800
s_nop 0
v_mfma_f32_32x32x16_bf16 v[64:79], v[140:143], a[168:171], v[64:79]
ds_read_b64_tr_b16 v[172:173], v30 offset:12288
ds_read_b64_tr_b16 v[174:175], v30 offset:12800
buffer_load_dwordx4 a[56:59], v33, s[4:7], s81 offen offset:2048 sc1
s_nop 0
s_waitcnt vmcnt(63) lgkmcnt(4)
v_mfma_f32_32x32x16_bf16 v[48:63], v[152:155], a[172:175], v[48:63]
ds_read_b64_tr_b16 v[184:185], v29 offset:14336
ds_read_b64_tr_b16 v[186:187], v29 offset:14848
buffer_load_dwordx4 v27, s[84:87], s79 offen offset:2048 lds
v_add_f32 v44, v44, v45
v_add_f32 v46, v46, v47
v_mfma_f32_32x32x16_bf16 v[64:79], v[156:159], a[172:175], v[64:79]
ds_read_b64_tr_b16 v[188:189], v30 offset:14336
ds_read_b64_tr_b16 v[190:191], v30 offset:14848
v_add_f32 v44, v44, v46
v_sub_f32 v44, v44, v44
v_cmp_u_f32_e64 s[70:71], v44, v44
s_waitcnt vmcnt(63) lgkmcnt(4)
s_barrier
v_mfma_f32_32x32x16_bf16 v[48:63], v[168:171], a[184:187], v[48:63]
ds_read_b64_tr_b16 v[136:137], v29 offset:16384
ds_read_b64_tr_b16 v[138:139], v29 offset:16896
s_nop 1
v_mfma_f32_32x32x16_bf16 v[64:79], v[172:175], a[184:187], v[64:79]
ds_read_b64_tr_b16 v[140:141], v30 offset:16384
ds_read_b64_tr_b16 v[142:143], v30 offset:16896
buffer_load_dwordx4 a[60:63], v33, s[4:7], s81 offen offset:3072 sc1
s_or_b64 s[74:75], s[74:75], s[70:71]
s_waitcnt vmcnt(63) lgkmcnt(4)
v_mfma_f32_32x32x16_bf16 v[48:63], v[184:187], a[188:191], v[48:63]
ds_read_b64_tr_b16 v[152:153], v29 offset:18432
ds_read_b64_tr_b16 v[154:155], v29 offset:18944
buffer_load_dwordx4 v28, s[84:87], s79 offen offset:3072 lds
v_mfma_f32_32x32x16_bf16 v[64:79], v[188:191], a[188:191], v[64:79]
ds_read_b64_tr_b16 v[156:157], v30 offset:18432
ds_read_b64_tr_b16 v[158:159], v30 offset:18944
v_and_b32 v39, 3, v0
v_lshl_add_u32 v39, v39, 1, s93
v_lshlrev_b32 v39, 7, v39
v_add_u32 v39, 0x6000000, v39
global_load_dword v38, v39, s[56:57] sc1
s_waitcnt vmcnt(63) lgkmcnt(4)
v_mfma_f32_32x32x16_bf16 v[80:95], v[136:139], a[64:67], v[80:95]
ds_read_b64_tr_b16 v[168:169], v29 offset:20480
ds_read_b64_tr_b16 v[170:171], v29 offset:20992
s_add_u32 m0, s31, 32768
s_lshl1_add_u32 s79, s53, s37
v_mfma_f32_32x32x16_bf16 v[96:111], v[140:143], a[64:67], v[96:111]
ds_read_b64_tr_b16 v[172:173], v30 offset:20480
ds_read_b64_tr_b16 v[174:175], v30 offset:20992
s_waitcnt vmcnt(63) lgkmcnt(4)
v_mfma_f32_32x32x16_bf16 v[80:95], v[152:155], a[68:71], v[80:95]
ds_read_b64_tr_b16 v[184:185], v29 offset:22528
ds_read_b64_tr_b16 v[186:187], v29 offset:23040
buffer_load_dwordx4 v25, s[84:87], s79 offen offset:0 lds
v_mfma_f32_32x32x16_bf16 v[96:111], v[156:159], a[68:71], v[96:111]
ds_read_b64_tr_b16 v[188:189], v30 offset:22528
ds_read_b64_tr_b16 v[190:191], v30 offset:23040
s_waitcnt vmcnt(63) lgkmcnt(4)
v_mfma_f32_32x32x16_bf16 v[80:95], v[168:171], a[72:75], v[80:95]
ds_read_b64_tr_b16 v[136:137], v29 offset:24576
ds_read_b64_tr_b16 v[138:139], v29 offset:25088
v_mfma_f32_32x32x16_bf16 v[96:111], v[172:175], a[72:75], v[96:111]
ds_read_b64_tr_b16 v[140:141], v30 offset:24576
ds_read_b64_tr_b16 v[142:143], v30 offset:25088
s_waitcnt vmcnt(63) lgkmcnt(4)
v_mfma_f32_32x32x16_bf16 v[80:95], v[184:187], a[76:79], v[80:95]
ds_read_b64_tr_b16 v[152:153], v29 offset:26624
ds_read_b64_tr_b16 v[154:155], v29 offset:27136
buffer_load_dwordx4 v26, s[84:87], s79 offen offset:1024 lds
v_mfma_f32_32x32x16_bf16 v[96:111], v[188:191], a[76:79], v[96:111]
ds_read_b64_tr_b16 v[156:157], v30 offset:26624
ds_read_b64_tr_b16 v[158:159], v30 offset:27136
s_waitcnt vmcnt(63) lgkmcnt(4)
v_mfma_f32_32x32x16_bf16 v[80:95], v[136:139], a[80:83], v[80:95]
ds_read_b64_tr_b16 v[168:169], v29 offset:28672
ds_read_b64_tr_b16 v[170:171], v29 offset:29184
v_mfma_f32_32x32x16_bf16 v[96:111], v[140:143], a[80:83], v[96:111]
ds_read_b64_tr_b16 v[172:173], v30 offset:28672
ds_read_b64_tr_b16 v[174:175], v30 offset:29184
s_waitcnt vmcnt(63) lgkmcnt(4)
v_mfma_f32_32x32x16_bf16 v[80:95], v[152:155], a[84:87], v[80:95]
ds_read_b64_tr_b16 v[184:185], v29 offset:30720
ds_read_b64_tr_b16 v[186:187], v29 offset:31232
buffer_load_dwordx4 v27, s[84:87], s79 offen offset:2048 lds
v_mfma_f32_32x32x16_bf16 v[96:111], v[156:159], a[84:87], v[96:111]
ds_read_b64_tr_b16 v[188:189], v30 offset:30720
ds_read_b64_tr_b16 v[190:191], v30 offset:31232
s_waitcnt vmcnt(52) lgkmcnt(4)
s_barrier
v_mfma_f32_32x32x16_bf16 v[80:95], v[168:171], a[88:91], v[80:95]
ds_read_b64_tr_b16 v[136:137], v18 offset:0
ds_read_b64_tr_b16 v[138:139], v18 offset:512
v_mfma_f32_32x32x16_bf16 v[96:111], v[172:175], a[88:91], v[96:111]
ds_read_b64_tr_b16 v[140:141], v19 offset:0
ds_read_b64_tr_b16 v[142:143], v19 offset:512
s_waitcnt vmcnt(53) lgkmcnt(4)
v_mfma_f32_32x32x16_bf16 v[80:95], v[184:187], a[92:95], v[80:95]
ds_read_b64_tr_b16 v[152:153], v18 offset:2048
ds_read_b64_tr_b16 v[154:155], v18 offset:2560
buffer_load_dwordx4 v28, s[84:87], s79 offen offset:3072 lds
v_mfma_f32_32x32x16_bf16 v[96:111], v[188:191], a[92:95], v[96:111]
ds_read_b64_tr_b16 v[156:157], v19 offset:2048
ds_read_b64_tr_b16 v[158:159], v19 offset:2560
s_waitcnt vmcnt(4)
v_and_b32 v38, 2, v38
v_cmp_eq_u32 vcc, 2, v38
s_nop 3
s_cmp_eq_u64 vcc, -1
s_cbranch_scc1 L_okoddA
v_and_b32 v39, 3, v0
v_lshl_add_u32 v39, v39, 1, s93
v_lshlrev_b32 v39, 7, v39
v_add_u32 v39, 0x6000000, v39
s_mov_b32 s60, 0x200000
L_spinoddA:
global_load_dword v38, v39, s[56:57] sc1
s_waitcnt vmcnt(0)
s_sub_u32 s60, s60, 1
s_cbranch_scc1 L_okoddA
v_and_b32 v38, 2, v38
v_cmp_eq_u32 vcc, 2, v38
s_nop 3
s_cmp_eq_u64 vcc, -1
s_cbranch_scc0 L_spinoddA
L_okoddA:
s_waitcnt vmcnt(63) lgkmcnt(4)
v_mfma_f32_32x32x16_bf16 v[48:63], v[136:139], a[64:67], v[48:63]
ds_read_b64_tr_b16 v[168:169], v18 offset:4096
ds_read_b64_tr_b16 v[170:171], v18 offset:4608
s_add_u32 m0, s31, 131072
s_lshl1_add_u32 s79, s47, s38
s_cmp_lg_u64 s[74:75], 0
s_cselect_b32 s62, 1, 0
s_lshl_b32 s63, s24, 2
v_mfma_f32_32x32x16_bf16 v[64:79], v[140:143], a[64:67], v[64:79]
ds_read_b64_tr_b16 v[172:173], v19 offset:4096
ds_read_b64_tr_b16 v[174:175], v19 offset:4608
s_add_u32 s80, s47, 65536
s_add_u32 s81, s47, 69632
buffer_load_dwordx4 v[144:147], v33, s[4:7], s80 offen offset:0 sc1
s_add_u32 s63, s63, 98320
s_waitcnt vmcnt(63) lgkmcnt(4)
v_mfma_f32_32x32x16_bf16 v[48:63], v[152:155], a[68:71], v[48:63]
ds_read_b64_tr_b16 v[184:185], v18 offset:6144
ds_read_b64_tr_b16 v[186:187], v18 offset:6656
buffer_load_dwordx4 v25, s[84:87], s79 offen offset:0 lds
v_mov_b32 v36, s62
v_mov_b32 v37, s63
ds_write_b32 v37, v36
v_mfma_f32_32x32x16_bf16 v[64:79], v[156:159], a[68:71], v[64:79]
ds_read_b64_tr_b16 v[188:189], v19 offset:6144
ds_read_b64_tr_b16 v[190:191], v19 offset:6656
s_waitcnt vmcnt(63) lgkmcnt(5)
v_mfma_f32_32x32x16_bf16 v[48:63], v[168:171], a[72:75], v[48:63]
ds_read_b64_tr_b16 v[136:137], v18 offset:8192
ds_read_b64_tr_b16 v[138:139], v18 offset:8704
v_mfma_f32_32x32x16_bf16 v[64:79], v[172:175], a[72:75], v[64:79]
ds_read_b64_tr_b16 v[140:141], v19 offset:8192
ds_read_b64_tr_b16 v[142:143], v19 offset:8704
buffer_load_dwordx4 v[148:151], v33, s[4:7], s80 offen offset:1024 sc1
s_waitcnt vmcnt(63) lgkmcnt(4)
v_mfma_f32_32x32x16_bf16 v[48:63], v[184:187], a[76:79], v[48:63]
ds_read_b64_tr_b16 v[152:153], v18 offset:10240
ds_read_b64_tr_b16 v[154:155], v18 offset:10752
buffer_load_dwordx4 v26, s[84:87], s79 offen offset:1024 lds
v_mfma_f32_32x32x16_bf16 v[64:79], v[188:191], a[76:79], v[64:79]
ds_read_b64_tr_b16 v[156:157], v19 offset:10240
ds_read_b64_tr_b16 v[158:159], v19 offset:10752
s_waitcnt vmcnt(63) lgkmcnt(4)
v_mfma_f32_32x32x16_bf16 v[48:63], v[136:139], a[80:83], v[48:63]
ds_read_b64_tr_b16 v[168:169], v18 offset:12288
ds_read_b64_tr_b16 v[170:171], v18 offset:12800
v_mfma_f32_32x32x16_bf16 v[64:79], v[140:143], a[80:83], v[64:79]
ds_read_b64_tr_b16 v[172:173], v19 offset:12288
ds_read_b64_tr_b16 v[174:175], v19 offset:12800
buffer_load_dwordx4 v[176:179], v33, s[4:7], s80 offen offset:2048 sc1
s_waitcnt vmcnt(63) lgkmcnt(4)
v_mfma_f32_32x32x16_bf16 v[48:63], v[152:155], a[84:87], v[48:63]
ds_read_b64_tr_b16 v[184:185], v18 offset:14336
ds_read_b64_tr_b16 v[186:187], v18 offset:14848
buffer_load_dwordx4 v27, s[84:87], s79 offen offset:2048 lds
v_mfma_f32_32x32x16_bf16 v[64:79], v[156:159], a[84:87], v[64:79]
ds_read_b64_tr_b16 v[188:189], v19 offset:14336
ds_read_b64_tr_b16 v[190:191], v19 offset:14848
s_waitcnt vmcnt(63) lgkmcnt(4)
s_barrier
v_mfma_f32_32x32x16_bf16 v[48:63], v[168:171], a[88:91], v[48:63]
ds_read_b64_tr_b16 v[136:137], v20 offset:0
ds_read_b64_tr_b16 v[138:139], v20 offset:512
v_mfma_f32_32x32x16_bf16 v[64:79], v[172:175], a[88:91], v[64:79]
ds_read_b64_tr_b16 v[140:141], v21 offset:0
ds_read_b64_tr_b16 v[142:143], v21 offset:512
buffer_load_dwordx4 v[180:183], v33, s[4:7], s80 offen offset:3072 sc1
s_waitcnt vmcnt(63) lgkmcnt(4)
v_mfma_f32_32x32x16_bf16 v[48:63], v[184:187], a[92:95], v[48:63]
ds_read_b64_tr_b16 v[152:153], v20 offset:2048
ds_read_b64_tr_b16 v[154:155], v20 offset:2560
buffer_load_dwordx4 v28, s[84:87], s79 offen offset:3072 lds
v_mfma_f32_32x32x16_bf16 v[64:79], v[188:191], a[92:95], v[64:79]
ds_read_b64_tr_b16 v[156:157], v21 offset:2048
ds_read_b64_tr_b16 v[158:159], v21 offset:2560
v_mov_b32 v40, 98320
ds_read_b128 v[40:43], v40
s_waitcnt vmcnt(63) lgkmcnt(5)
v_mfma_f32_32x32x16_bf16 v[80:95], v[136:139], a[96:99], v[80:95]
ds_read_b64_tr_b16 v[168:169], v20 offset:4096
ds_read_b64_tr_b16 v[170:171], v20 offset:4608
s_add_u32 m0, s31, 147456
s_lshl1_add_u32 s79, s47, s39
v_mfma_f32_32x32x16_bf16 v[96:111], v[140:143], a[96:99], v[96:111]
ds_read_b64_tr_b16 v[172:173], v21 offset:4096
ds_read_b64_tr_b16 v[174:175], v21 offset:4608
buffer_load_dwordx4 v[208:211], v33, s[4:7], s81 offen offset:0 sc1
s_waitcnt vmcnt(63) lgkmcnt(5)
v_mfma_f32_32x32x16_bf16 v[80:95], v[152:155], a[100:103], v[80:95]
ds_read_b64_tr_b16 v[184:185], v20 offset:6144
ds_read_b64_tr_b16 v[186:187], v20 offset:6656
buffer_load_dwordx4 v25, s[84:87], s79 offen offset:0 lds
v_mfma_f32_32x32x16_bf16 v[96:111], v[156:159], a[100:103], v[96:111]
ds_read_b64_tr_b16 v[188:189], v21 offset:6144
ds_read_b64_tr_b16 v[190:191], v21 offset:6656
s_waitcnt vmcnt(63) lgkmcnt(4)
v_mfma_f32_32x32x16_bf16 v[80:95], v[168:171], a[104:107], v[80:95]
ds_read_b64_tr_b16 v[136:137], v20 offset:8192
ds_read_b64_tr_b16 v[138:139], v20 offset:8704
v_mfma_f32_32x32x16_bf16 v[96:111], v[172:175], a[104:107], v[96:111]
ds_read_b64_tr_b16 v[140:141], v21 offset:8192
ds_read_b64_tr_b16 v[142:143], v21 offset:8704
buffer_load_dwordx4 v[212:215], v33, s[4:7], s81 offen offset:1024 sc1
s_waitcnt vmcnt(63) lgkmcnt(4)
v_mfma_f32_32x32x16_bf16 v[80:95], v[184:187], a[108:111], v[80:95]
ds_read_b64_tr_b16 v[152:153], v20 offset:10240
ds_read_b64_tr_b16 v[154:155], v20 offset:10752
buffer_load_dwordx4 v26, s[84:87], s79 offen offset:1024 lds
v_mfma_f32_32x32x16_bf16 v[96:111], v[188:191], a[108:111], v[96:111]
ds_read_b64_tr_b16 v[156:157], v21 offset:10240
ds_read_b64_tr_b16 v[158:159], v21 offset:10752
buffer_load_dwordx4 v[240:243], v33, s[4:7], s81 offen offset:2048 sc1
s_waitcnt vmcnt(63) lgkmcnt(15)
s_waitcnt lgkmcnt(4)
v_or3_b32 v40, v40, v41, v42
v_or_b32 v40, v40, v43
s_nop 0
v_readfirstlane_b32 s62, v40
s_nop 3
s_andn2_b32 s62, s62, s25
s_cbranch_scc1 L1_redo
v_mfma_f32_32x32x16_bf16 v[80:95], v[136:139], a[112:115], v[80:95]
ds_read_b64_tr_b16 v[168:169], v20 offset:12288
ds_read_b64_tr_b16 v[170:171], v20 offset:12800
v_mfma_f32_32x32x16_bf16 v[96:111], v[140:143], a[112:115], v[96:111]
ds_read_b64_tr_b16 v[172:173], v21 offset:12288
ds_read_b64_tr_b16 v[174:175], v21 offset:12800
buffer_load_dwordx4 v[244:247], v33, s[4:7], s81 offen offset:3072 sc1
s_waitcnt vmcnt(63) lgkmcnt(4)
v_mfma_f32_32x32x16_bf16 v[80:95], v[152:155], a[116:119], v[80:95]
ds_read_b64_tr_b16 v[184:185], v20 offset:14336
ds_read_b64_tr_b16 v[186:187], v20 offset:14848
buffer_load_dwordx4 v27, s[84:87], s79 offen offset:2048 lds
v_mfma_f32_32x32x16_bf16 v[96:111], v[156:159], a[116:119], v[96:111]
ds_read_b64_tr_b16 v[188:189], v21 offset:14336
ds_read_b64_tr_b16 v[190:191], v21 offset:14848
s_waitcnt vmcnt(63) lgkmcnt(4)
s_barrier
s_cmp_lg_u32 s24, 0
s_cbranch_scc1 L_sigoddB
s_lshl_b32 s62, s92, 7
s_add_u32 s62, s62, 0x6000000
v_mov_b32 v16, s62
v_mov_b32 v17, 15
s_mov_b64 exec, 1
global_store_dword v16, v17, s[56:57] sc1
s_mov_b64 exec, -1
L_sigoddB:
v_mfma_f32_32x32x16_bf16 v[80:95], v[168:171], a[120:123], v[80:95]
ds_read_b64_tr_b16 v[136:137], v18 offset:16384
ds_read_b64_tr_b16 v[138:139], v18 offset:16896
v_mfma_f32_32x32x16_bf16 v[96:111], v[172:175], a[120:123], v[96:111]
ds_read_b64_tr_b16 v[140:141], v19 offset:16384
ds_read_b64_tr_b16 v[142:143], v19 offset:16896
s_add_u32 s80, s48, 65536
s_add_u32 s81, s48, 69632
buffer_load_dwordx4 a[128:131], v33, s[4:7], s80 offen offset:0 sc1
s_waitcnt vmcnt(63) lgkmcnt(4)
v_mfma_f32_32x32x16_bf16 v[80:95], v[184:187], a[124:127], v[80:95]
ds_read_b64_tr_b16 v[152:153], v18 offset:18432
ds_read_b64_tr_b16 v[154:155], v18 offset:18944
buffer_load_dwordx4 v28, s[84:87], s79 offen offset:3072 lds
v_mfma_f32_32x32x16_bf16 v[96:111], v[188:191], a[124:127], v[96:111]
ds_read_b64_tr_b16 v[156:157], v19 offset:18432
ds_read_b64_tr_b16 v[158:159], v19 offset:18944
s_waitcnt vmcnt(63) lgkmcnt(4)
v_mfma_f32_32x32x16_bf16 v[48:63], v[136:139], a[96:99], v[48:63]
ds_read_b64_tr_b16 v[168:169], v18 offset:20480
ds_read_b64_tr_b16 v[170:171], v18 offset:20992
s_add_u32 m0, s31, 0
s_lshl1_add_u32 s79, s48, s38
v_mfma_f32_32x32x16_bf16 v[64:79], v[140:143], a[96:99], v[64:79]
ds_read_b64_tr_b16 v[172:173], v19 offset:20480
ds_read_b64_tr_b16 v[174:175], v19 offset:20992
buffer_load_dwordx4 a[132:135], v33, s[4:7], s80 offen offset:1024 sc1
s_waitcnt vmcnt(63) lgkmcnt(4)
v_mfma_f32_32x32x16_bf16 v[48:63], v[152:155], a[100:103], v[48:63]
ds_read_b64_tr_b16 v[184:185], v18 offset:22528
ds_read_b64_tr_b16 v[186:187], v18 offset:23040
buffer_load_dwordx4 v25, s[84:87], s79 offen offset:0 lds
v_mfma_f32_32x32x16_bf16 v[64:79], v[156:159], a[100:103], v[64:79]
ds_read_b64_tr_b16 v[188:189], v19 offset:22528
ds_read_b64_tr_b16 v[190:191], v19 offset:23040
s_waitcnt vmcnt(63) lgkmcnt(4)
v_mfma_f32_32x32x16_bf16 v[48:63], v[168:171], a[104:107], v[48:63]
ds_read_b64_tr_b16 v[136:137], v18 offset:24576
ds_read_b64_tr_b16 v[138:139], v18 offset:25088
v_mfma_f32_32x32x16_bf16 v[64:79], v[172:175], a[104:107], v[64:79]
ds_read_b64_tr_b16 v[140:141], v19 offset:24576
ds_read_b64_tr_b16 v[142:143], v19 offset:25088
buffer_load_dwordx4 a[144:147], v33, s[4:7], s80 offen offset:2048 sc1
s_waitcnt vmcnt(63) lgkmcnt(4)
v_mfma_f32_32x32x16_bf16 v[48:63], v[184:187], a[108:111], v[48:63]
ds_read_b64_tr_b16 v[152:153], v18 offset:26624
ds_read_b64_tr_b16 v[154:155], v18 offset:27136
buffer_load_dwordx4 v26, s[84:87], s79 offen offset:1024 lds
v_mfma_f32_32x32x16_bf16 v[64:79], v[188:191], a[108:111], v[64:79]
ds_read_b64_tr_b16 v[156:157], v19 offset:26624
ds_read_b64_tr_b16 v[158:159], v19 offset:27136
buffer_load_dwordx4 a[148:151], v33, s[4:7], s80 offen offset:3072 sc1
s_waitcnt vmcnt(63) lgkmcnt(4)
v_mfma_f32_32x32x16_bf16 v[48:63], v[136:139], a[112:115], v[48:63]
ds_read_b64_tr_b16 v[168:169], v18 offset:28672
ds_read_b64_tr_b16 v[170:171], v18 offset:29184
v_mfma_f32_32x32x16_bf16 v[64:79], v[140:143], a[112:115], v[64:79]
ds_read_b64_tr_b16 v[172:173], v19 offset:28672
ds_read_b64_tr_b16 v[174:175], v19 offset:29184
buffer_load_dwordx4 a[160:163], v33, s[4:7], s81 offen offset:0 sc1
s_waitcnt vmcnt(63) lgkmcnt(4)
v_mfma_f32_32x32x16_bf16 v[48:63], v[152:155], a[116:119], v[48:63]
ds_read_b64_tr_b16 v[184:185], v18 offset:30720
ds_read_b64_tr_b16 v[186:187], v18 offset:31232
buffer_load_dwordx4 v27, s[84:87], s79 offen offset:2048 lds
v_mfma_f32_32x32x16_bf16 v[64:79], v[156:159], a[116:119], v[64:79]
ds_read_b64_tr_b16 v[188:189], v19 offset:30720
ds_read_b64_tr_b16 v[190:191], v19 offset:31232
s_waitcnt vmcnt(63) lgkmcnt(4)
s_barrier
v_mfma_f32_32x32x16_bf16 v[48:63], v[168:171], a[120:123], v[48:63]
ds_read_b64_tr_b16 v[136:137], v20 offset:16384
ds_read_b64_tr_b16 v[138:139], v20 offset:16896
v_mfma_f32_32x32x16_bf16 v[64:79], v[172:175], a[120:123], v[64:79]
ds_read_b64_tr_b16 v[140:141], v21 offset:16384
ds_read_b64_tr_b16 v[142:143], v21 offset:16896
buffer_load_dwordx4 a[164:167], v33, s[4:7], s81 offen offset:1024 sc1
s_waitcnt vmcnt(63) lgkmcnt(4)
v_mfma_f32_32x32x16_bf16 v[48:63], v[184:187], a[124:127], v[48:63]
ds_read_b64_tr_b16 v[152:153], v20 offset:18432
ds_read_b64_tr_b16 v[154:155], v20 offset:18944
buffer_load_dwordx4 v28, s[84:87], s79 offen offset:3072 lds
v_mfma_f32_32x32x16_bf16 v[64:79], v[188:191], a[124:127], v[64:79]
ds_read_b64_tr_b16 v[156:157], v21 offset:18432
ds_read_b64_tr_b16 v[158:159], v21 offset:18944
s_waitcnt vmcnt(63) lgkmcnt(4)
v_mfma_f32_32x32x16_bf16 v[80:95], v[136:139], a[0:3], v[80:95]
ds_read_b64_tr_b16 v[168:169], v20 offset:20480
ds_read_b64_tr_b16 v[170:171], v20 offset:20992
s_add_u32 m0, s31, 65536
s_lshl1_add_u32 s79, s49, s38
v_mfma_f32_32x32x16_bf16 v[96:111], v[140:143], a[0:3], v[96:111]
ds_read_b64_tr_b16 v[172:173], v21 offset:20480
ds_read_b64_tr_b16 v[174:175], v21 offset:20992
buffer_load_dwordx4 a[176:179], v33, s[4:7], s81 offen offset:2048 sc1
s_waitcnt vmcnt(63) lgkmcnt(4)
v_mfma_f32_32x32x16_bf16 v[80:95], v[152:155], a[4:7], v[80:95]
ds_read_b64_tr_b16 v[184:185], v20 offset:22528
ds_read_b64_tr_b16 v[186:187], v20 offset:23040
buffer_load_dwordx4 v25, s[84:87], s79 offen offset:0 lds
v_mfma_f32_32x32x16_bf16 v[96:111], v[156:159], a[4:7], v[96:111]
ds_read_b64_tr_b16 v[188:189], v21 offset:22528
ds_read_b64_tr_b16 v[190:191], v21 offset:23040
s_waitcnt vmcnt(63) lgkmcnt(4)
v_mfma_f32_32x32x16_bf16 v[80:95], v[168:171], a[8:11], v[80:95]
ds_read_b64_tr_b16 v[136:137], v20 offset:24576
ds_read_b64_tr_b16 v[138:139], v20 offset:25088
v_mfma_f32_32x32x16_bf16 v[96:111], v[172:175], a[8:11], v[96:111]
ds_read_b64_tr_b16 v[140:141], v21 offset:24576
ds_read_b64_tr_b16 v[142:143], v21 offset:25088
buffer_load_dwordx4 a[180:183], v33, s[4:7], s81 offen offset:3072 sc1
s_waitcnt vmcnt(63) lgkmcnt(4)
v_mfma_f32_32x32x16_bf16 v[80:95], v[184:187], a[12:15], v[80:95]
ds_read_b64_tr_b16 v[152:153], v20 offset:26624
ds_read_b64_tr_b16 v[154:155], v20 offset:27136
buffer_load_dwordx4 v26, s[84:87], s79 offen offset:1024 lds
v_mfma_f32_32x32x16_bf16 v[96:111], v[188:191], a[12:15], v[96:111]
ds_read_b64_tr_b16 v[156:157], v21 offset:26624
ds_read_b64_tr_b16 v[158:159], v21 offset:27136
s_add_u32 s80, s49, 65536
s_add_u32 s81, s49, 69632
buffer_load_dwordx4 a[136:139], v33, s[4:7], s80 offen offset:0 sc1
s_waitcnt vmcnt(63) lgkmcnt(4)
v_mfma_f32_32x32x16_bf16 v[80:95], v[136:139], a[16:19], v[80:95]
ds_read_b64_tr_b16 v[168:169], v20 offset:28672
ds_read_b64_tr_b16 v[170:171], v20 offset:29184
v_mfma_f32_32x32x16_bf16 v[96:111], v[140:143], a[16:19], v[96:111]
ds_read_b64_tr_b16 v[172:173], v21 offset:28672
ds_read_b64_tr_b16 v[174:175], v21 offset:29184
buffer_load_dwordx4 a[140:143], v33, s[4:7], s80 offen offset:1024 sc1
s_waitcnt vmcnt(63) lgkmcnt(4)
v_mfma_f32_32x32x16_bf16 v[80:95], v[152:155], a[20:23], v[80:95]
ds_read_b64_tr_b16 v[184:185], v20 offset:30720
ds_read_b64_tr_b16 v[186:187], v20 offset:31232
buffer_load_dwordx4 v27, s[84:87], s79 offen offset:2048 lds
v_mfma_f32_32x32x16_bf16 v[96:111], v[156:159], a[20:23], v[96:111]
ds_read_b64_tr_b16 v[188:189], v21 offset:30720
ds_read_b64_tr_b16 v[190:191], v21 offset:31232
s_waitcnt vmcnt(63) lgkmcnt(4)
s_barrier
v_mfma_f32_32x32x16_bf16 v[80:95], v[168:171], a[24:27], v[80:95]
ds_read_b64_tr_b16 v[136:137], v18 offset:49152
ds_read_b64_tr_b16 v[138:139], v18 offset:49664
v_mfma_f32_32x32x16_bf16 v[96:111], v[172:175], a[24:27], v[96:111]
ds_read_b64_tr_b16 v[140:141], v19 offset:49152
ds_read_b64_tr_b16 v[142:143], v19 offset:49664
buffer_load_dwordx4 a[152:155], v33, s[4:7], s80 offen offset:2048 sc1
s_waitcnt vmcnt(63) lgkmcnt(4)
v_mfma_f32_32x32x16_bf16 v[80:95], v[184:187], a[28:31], v[80:95]
ds_read_b64_tr_b16 v[152:153], v18 offset:51200
ds_read_b64_tr_b16 v[154:155], v18 offset:51712
buffer_load_dwordx4 v28, s[84:87], s79 offen offset:3072 lds
v_mfma_f32_32x32x16_bf16 v[96:111], v[188:191], a[28:31], v[96:111]
ds_read_b64_tr_b16 v[156:157], v19 offset:51200
ds_read_b64_tr_b16 v[158:159], v19 offset:51712
v_and_b32 v39, 3, v0
v_lshl_add_u32 v39, v39, 1, s93
v_xor_b32 v39, 1, v39
v_lshlrev_b32 v39, 7, v39
v_add_u32 v39, 0x6000000, v39
global_load_dword v38, v39, s[56:57] sc1
s_waitcnt vmcnt(63) lgkmcnt(4)
v_mfma_f32_32x32x16_bf16 v[48:63], v[136:139], a[0:3], v[48:63]
ds_read_b64_tr_b16 v[168:169], v18 offset:53248
ds_read_b64_tr_b16 v[170:171], v18 offset:53760
s_add_u32 m0, s31, 16384
s_lshl1_add_u32 s79, s50, s38
v_mfma_f32_32x32x16_bf16 v[64:79], v[140:143], a[0:3], v[64:79]
ds_read_b64_tr_b16 v[172:173], v19 offset:53248
ds_read_b64_tr_b16 v[174:175], v19 offset:53760
buffer_load_dwordx4 a[156:159], v33, s[4:7], s80 offen offset:3072 sc1
s_waitcnt vmcnt(63) lgkmcnt(4)
v_mfma_f32_32x32x16_bf16 v[48:63], v[152:155], a[4:7], v[48:63]
ds_read_b64_tr_b16 v[184:185], v18 offset:55296
ds_read_b64_tr_b16 v[186:187], v18 offset:55808
buffer_load_dwordx4 v25, s[84:87], s79 offen offset:0 lds
v_mfma_f32_32x32x16_bf16 v[64:79], v[156:159], a[4:7], v[64:79]
ds_read_b64_tr_b16 v[188:189], v19 offset:55296
ds_read_b64_tr_b16 v[190:191], v19 offset:55808
s_waitcnt vmcnt(63) lgkmcnt(4)
v_mfma_f32_32x32x16_bf16 v[48:63], v[168:171], a[8:11], v[48:63]
ds_read_b64_tr_b16 v[136:137], v18 offset:57344
ds_read_b64_tr_b16 v[138:139], v18 offset:57856
v_mfma_f32_32x32x16_bf16 v[64:79], v[172:175], a[8:11], v[64:79]
ds_read_b64_tr_b16 v[140:141], v19 offset:57344
ds_read_b64_tr_b16 v[142:143], v19 offset:57856
buffer_load_dwordx4 a[168:171], v33, s[4:7], s81 offen offset:0 sc1
s_waitcnt vmcnt(63) lgkmcnt(4)
v_mfma_f32_32x32x16_bf16 v[48:63], v[184:187], a[12:15], v[48:63]
ds_read_b64_tr_b16 v[152:153], v18 offset:59392
ds_read_b64_tr_b16 v[154:155], v18 offset:59904
buffer_load_dwordx4 v26, s[84:87], s79 offen offset:1024 lds
v_mfma_f32_32x32x16_bf16 v[64:79], v[188:191], a[12:15], v[64:79]
ds_read_b64_tr_b16 v[156:157], v19 offset:59392
ds_read_b64_tr_b16 v[158:159], v19 offset:59904
buffer_load_dwordx4 a[172:175], v33, s[4:7], s81 offen offset:1024 sc1
s_waitcnt vmcnt(63) lgkmcnt(4)
v_mfma_f32_32x32x16_bf16 v[48:63], v[136:139], a[16:19], v[48:63]
ds_read_b64_tr_b16 v[168:169], v18 offset:61440
ds_read_b64_tr_b16 v[170:171], v18 offset:61952
v_mfma_f32_32x32x16_bf16 v[64:79], v[140:143], a[16:19], v[64:79]
ds_read_b64_tr_b16 v[172:173], v19 offset:61440
ds_read_b64_tr_b16 v[174:175], v19 offset:61952
buffer_load_dwordx4 a[184:187], v33, s[4:7], s81 offen offset:2048 sc1
s_waitcnt vmcnt(63) lgkmcnt(4)
v_mfma_f32_32x32x16_bf16 v[48:63], v[152:155], a[20:23], v[48:63]
ds_read_b64_tr_b16 v[184:185], v18 offset:63488
ds_read_b64_tr_b16 v[186:187], v18 offset:64000
buffer_load_dwordx4 v27, s[84:87], s79 offen offset:2048 lds
v_mfma_f32_32x32x16_bf16 v[64:79], v[156:159], a[20:23], v[64:79]
ds_read_b64_tr_b16 v[188:189], v19 offset:63488
ds_read_b64_tr_b16 v[190:191], v19 offset:64000
s_waitcnt vmcnt(63) lgkmcnt(4)
s_barrier
v_mfma_f32_32x32x16_bf16 v[48:63], v[168:171], a[24:27], v[48:63]
ds_read_b64_tr_b16 v[136:137], v20 offset:49152
ds_read_b64_tr_b16 v[138:139], v20 offset:49664
v_mfma_f32_32x32x16_bf16 v[64:79], v[172:175], a[24:27], v[64:79]
ds_read_b64_tr_b16 v[140:141], v21 offset:49152
ds_read_b64_tr_b16 v[142:143], v21 offset:49664
buffer_load_dwordx4 a[188:191], v33, s[4:7], s81 offen offset:3072 sc1
s_waitcnt vmcnt(63) lgkmcnt(4)
v_mfma_f32_32x32x16_bf16 v[48:63], v[184:187], a[28:31], v[48:63]
ds_read_b64_tr_b16 v[152:153], v20 offset:51200
ds_read_b64_tr_b16 v[154:155], v20 offset:51712
buffer_load_dwordx4 v28, s[84:87], s79 offen offset:3072 lds
v_mfma_f32_32x32x16_bf16 v[64:79], v[188:191], a[28:31], v[64:79]
ds_read_b64_tr_b16 v[156:157], v21 offset:51200
ds_read_b64_tr_b16 v[158:159], v21 offset:51712
s_waitcnt vmcnt(9)
v_and_b32 v38, 4, v38
v_cmp_eq_u32 vcc, 4, v38
s_nop 3
s_cmp_eq_u64 vcc, -1
s_cbranch_scc1 L_okoddB
v_and_b32 v39, 3, v0
v_lshl_add_u32 v39, v39, 1, s93
v_xor_b32 v39, 1, v39
v_lshlrev_b32 v39, 7, v39
v_add_u32 v39, 0x6000000, v39
s_mov_b32 s60, 0x200000
L_spinoddB:
global_load_dword v38, v39, s[56:57] sc1
s_waitcnt vmcnt(0)
s_sub_u32 s60, s60, 1
s_cbranch_scc1 L_okoddB
v_and_b32 v38, 4, v38
v_cmp_eq_u32 vcc, 4, v38
s_nop 3
s_cmp_eq_u64 vcc, -1
s_cbranch_scc0 L_spinoddB
L_okoddB:
s_waitcnt vmcnt(63) lgkmcnt(4)
v_mfma_f32_32x32x16_bf16 v[80:95], v[136:139], a[32:35], v[80:95]
ds_read_b64_tr_b16 v[168:169], v20 offset:53248
ds_read_b64_tr_b16 v[170:171], v20 offset:53760
s_add_u32 m0, s31, 81920
s_lshl1_add_u32 s79, s51, s38
v_mfma_f32_32x32x16_bf16 v[96:111], v[140:143], a[32:35], v[96:111]
ds_read_b64_tr_b16 v[172:173], v21 offset:53248
ds_read_b64_tr_b16 v[174:175], v21 offset:53760
s_add_u32 s80, s50, 65536
s_add_u32 s81, s50, 69632
buffer_load_dwordx4 a[192:195], v33, s[4:7], s80 offen offset:0 sc1
s_waitcnt vmcnt(63) lgkmcnt(4)
v_mfma_f32_32x32x16_bf16 v[80:95], v[152:155], a[36:39], v[80:95]
ds_read_b64_tr_b16 v[184:185], v20 offset:55296
ds_read_b64_tr_b16 v[186:187], v20 offset:55808
buffer_load_dwordx4 v25, s[84:87], s79 offen offset:0 lds
v_mfma_f32_32x32x16_bf16 v[96:111], v[156:159], a[36:39], v[96:111]
ds_read_b64_tr_b16 v[188:189], v21 offset:55296
ds_read_b64_tr_b16 v[190:191], v21 offset:55808
buffer_load_dwordx4 a[196:199], v33, s[4:7], s80 offen offset:1024 sc1
s_waitcnt vmcnt(63) lgkmcnt(4)
v_mfma_f32_32x32x16_bf16 v[80:95], v[168:171], a[40:43], v[80:95]
ds_read_b64_tr_b16 v[136:137], v20 offset:57344
ds_read_b64_tr_b16 v[138:139], v20 offset:57856
v_mfma_f32_32x32x16_bf16 v[96:111], v[172:175], a[40:43], v[96:111]
ds_read_b64_tr_b16 v[140:141], v21 offset:57344
ds_read_b64_tr_b16 v[142:143], v21 offset:57856
buffer_load_dwordx4 a[200:203], v33, s[4:7], s80 offen offset:2048 sc1
s_waitcnt vmcnt(63) lgkmcnt(4)
v_mfma_f32_32x32x16_bf16 v[80:95], v[184:187], a[44:47], v[80:95]
ds_read_b64_tr_b16 v[152:153], v20 offset:59392
ds_read_b64_tr_b16 v[154:155], v20 offset:59904
buffer_load_dwordx4 v26, s[84:87], s79 offen offset:1024 lds
v_mfma_f32_32x32x16_bf16 v[96:111], v[188:191], a[44:47], v[96:111]
ds_read_b64_tr_b16 v[156:157], v21 offset:59392
ds_read_b64_tr_b16 v[158:159], v21 offset:59904
s_waitcnt vmcnt(63) lgkmcnt(4)
v_mfma_f32_32x32x16_bf16 v[80:95], v[136:139], a[48:51], v[80:95]
ds_read_b64_tr_b16 v[168:169], v20 offset:61440
ds_read_b64_tr_b16 v[170:171], v20 offset:61952
v_mfma_f32_32x32x16_bf16 v[96:111], v[140:143], a[48:51], v[96:111]
ds_read_b64_tr_b16 v[172:173], v21 offset:61440
ds_read_b64_tr_b16 v[174:175], v21 offset:61952
buffer_load_dwordx4 a[204:207], v33, s[4:7], s80 offen offset:3072 sc1
s_waitcnt vmcnt(63) lgkmcnt(4)
v_mfma_f32_32x32x16_bf16 v[80:95], v[152:155], a[52:55], v[80:95]
ds_read_b64_tr_b16 v[184:185], v20 offset:63488
ds_read_b64_tr_b16 v[186:187], v20 offset:64000
buffer_load_dwordx4 v27, s[84:87], s79 offen offset:2048 lds
v_mfma_f32_32x32x16_bf16 v[96:111], v[156:159], a[52:55], v[96:111]
ds_read_b64_tr_b16 v[188:189], v21 offset:63488
ds_read_b64_tr_b16 v[190:191], v21 offset:64000
buffer_load_dwordx4 a[208:211], v33, s[4:7], s81 offen offset:0 sc1
s_waitcnt vmcnt(63) lgkmcnt(4)
s_barrier
v_mfma_f32_32x32x16_bf16 v[80:95], v[168:171], a[56:59], v[80:95]
ds_read_b64_tr_b16 v[136:137], v18 offset:32768
ds_read_b64_tr_b16 v[138:139], v18 offset:33280
v_mfma_f32_32x32x16_bf16 v[96:111], v[172:175], a[56:59], v[96:111]
ds_read_b64_tr_b16 v[140:141], v19 offset:32768
ds_read_b64_tr_b16 v[142:143], v19 offset:33280
buffer_load_dwordx4 a[212:215], v33, s[4:7], s81 offen offset:1024 sc1
s_waitcnt vmcnt(63) lgkmcnt(4)
v_mfma_f32_32x32x16_bf16 v[80:95], v[184:187], a[60:63], v[80:95]
ds_read_b64_tr_b16 v[152:153], v18 offset:34816
ds_read_b64_tr_b16 v[154:155], v18 offset:35328
buffer_load_dwordx4 v28, s[84:87], s79 offen offset:3072 lds
v_mfma_f32_32x32x16_bf16 v[96:111], v[188:191], a[60:63], v[96:111]
ds_read_b64_tr_b16 v[156:157], v19 offset:34816
ds_read_b64_tr_b16 v[158:159], v19 offset:35328
s_waitcnt vmcnt(63) lgkmcnt(4)
v_mfma_f32_32x32x16_bf16 v[48:63], v[136:139], a[32:35], v[48:63]
ds_read_b64_tr_b16 v[168:169], v18 offset:36864
ds_read_b64_tr_b16 v[170:171], v18 offset:37376
s_add_u32 m0, s31, 49152
s_lshl1_add_u32 s79, s52, s38
v_mfma_f32_32x32x16_bf16 v[64:79], v[140:143], a[32:35], v[64:79]
ds_read_b64_tr_b16 v[172:173], v19 offset:36864
ds_read_b64_tr_b16 v[174:175], v19 offset:37376
buffer_load_dwordx4 a[216:219], v33, s[4:7], s81 offen offset:2048 sc1
s_waitcnt vmcnt(63) lgkmcnt(4)
v_mfma_f32_32x32x16_bf16 v[48:63], v[152:155], a[36:39], v[48:63]
ds_read_b64_tr_b16 v[184:185], v18 offset:38912
ds_read_b64_tr_b16 v[186:187], v18 offset:39424
buffer_load_dwordx4 v25, s[84:87], s79 offen offset:0 lds
v_mfma_f32_32x32x16_bf16 v[64:79], v[156:159], a[36:39], v[64:79]
ds_read_b64_tr_b16 v[188:189], v19 offset:38912
ds_read_b64_tr_b16 v[190:191], v19 offset:39424
buffer_load_dwordx4 a[220:223], v33, s[4:7], s81 offen offset:3072 sc1
s_waitcnt vmcnt(63) lgkmcnt(4)
v_mfma_f32_32x32x16_bf16 v[48:63], v[168:171], a[40:43], v[48:63]
ds_read_b64_tr_b16 v[136:137], v18 offset:40960
ds_read_b64_tr_b16 v[138:139], v18 offset:41472
v_mfma_f32_32x32x16_bf16 v[64:79], v[172:175], a[40:43], v[64:79]
ds_read_b64_tr_b16 v[140:141], v19 offset:40960
ds_read_b64_tr_b16 v[142:143], v19 offset:41472
s_add_u32 s80, s51, 65536
s_add_u32 s81, s51, 69632
buffer_load_dwordx4 a[224:227], v33, s[4:7], s80 offen offset:0 sc1
s_waitcnt vmcnt(63) lgkmcnt(4)
v_mfma_f32_32x32x16_bf16 v[48:63], v[184:187], a[44:47], v[48:63]
ds_read_b64_tr_b16 v[152:153], v18 offset:43008
ds_read_b64_tr_b16 v[154:155], v18 offset:43520
buffer_load_dwordx4 v26, s[84:87], s79 offen offset:1024 lds
v_mfma_f32_32x32x16_bf16 v[64:79], v[188:191], a[44:47], v[64:79]
ds_read_b64_tr_b16 v[156:157], v19 offset:43008
ds_read_b64_tr_b16 v[158:159], v19 offset:43520
s_waitcnt vmcnt(63) lgkmcnt(4)
v_mfma_f32_32x32x16_bf16 v[48:63], v[136:139], a[48:51], v[48:63]
ds_read_b64_tr_b16 v[168:169], v18 offset:45056
ds_read_b64_tr_b16 v[170:171], v18 offset:45568
v_mfma_f32_32x32x16_bf16 v[64:79], v[140:143], a[48:51], v[64:79]
ds_read_b64_tr_b16 v[172:173], v19 offset:45056
ds_read_b64_tr_b16 v[174:175], v19 offset:45568
buffer_load_dwordx4 a[228:231], v33, s[4:7], s80 offen offset:1024 sc1
s_waitcnt vmcnt(63) lgkmcnt(4)
v_mfma_f32_32x32x16_bf16 v[48:63], v[152:155], a[52:55], v[48:63]
ds_read_b64_tr_b16 v[184:185], v18 offset:47104
ds_read_b64_tr_b16 v[186:187], v18 offset:47616
buffer_load_dwordx4 v27, s[84:87], s79 offen offset:2048 lds
v_mfma_f32_32x32x16_bf16 v[64:79], v[156:159], a[52:55], v[64:79]
ds_read_b64_tr_b16 v[188:189], v19 offset:47104
ds_read_b64_tr_b16 v[190:191], v19 offset:47616
buffer_load_dwordx4 a[232:235], v33, s[4:7], s80 offen offset:2048 sc1
s_waitcnt vmcnt(63) lgkmcnt(4)
s_barrier
v_mfma_f32_32x32x16_bf16 v[48:63], v[168:171], a[56:59], v[48:63]
ds_read_b64_tr_b16 v[136:137], v29 offset:0
ds_read_b64_tr_b16 v[138:139], v29 offset:512
v_mfma_f32_32x32x16_bf16 v[64:79], v[172:175], a[56:59], v[64:79]
ds_read_b64_tr_b16 v[140:141], v30 offset:0
ds_read_b64_tr_b16 v[142:143], v30 offset:512
buffer_load_dwordx4 a[236:239], v33, s[4:7], s80 offen offset:3072 sc1
s_waitcnt vmcnt(63) lgkmcnt(4)
v_mfma_f32_32x32x16_bf16 v[48:63], v[184:187], a[60:63], v[48:63]
ds_read_b64_tr_b16 v[152:153], v29 offset:2048
ds_read_b64_tr_b16 v[154:155], v29 offset:2560
buffer_load_dwordx4 v28, s[84:87], s79 offen offset:3072 lds
v_mfma_f32_32x32x16_bf16 v[64:79], v[188:191], a[60:63], v[64:79]
ds_read_b64_tr_b16 v[156:157], v30 offset:2048
ds_read_b64_tr_b16 v[158:159], v30 offset:2560
s_waitcnt vmcnt(63) lgkmcnt(4)
v_mfma_f32_32x32x16_bf16 v[80:95], v[136:139], v[144:147], v[80:95]
ds_read_b64_tr_b16 v[168:169], v29 offset:4096
ds_read_b64_tr_b16 v[170:171], v29 offset:4608
s_add_u32 m0, s31, 114688
s_lshl1_add_u32 s79, s53, s38
v_mfma_f32_32x32x16_bf16 v[96:111], v[140:143], v[144:147], v[96:111]
ds_read_b64_tr_b16 v[172:173], v30 offset:4096
ds_read_b64_tr_b16 v[174:175], v30 offset:4608
buffer_load_dwordx4 a[240:243], v33, s[4:7], s81 offen offset:0 sc1
s_waitcnt vmcnt(63) lgkmcnt(4)
v_mfma_f32_32x32x16_bf16 v[80:95], v[152:155], v[148:151], v[80:95]
ds_read_b64_tr_b16 v[184:185], v29 offset:6144
ds_read_b64_tr_b16 v[186:187], v29 offset:6656
buffer_load_dwordx4 v25, s[84:87], s79 offen offset:0 lds
v_mfma_f32_32x32x16_bf16 v[96:111], v[156:159], v[148:151], v[96:111]
ds_read_b64_tr_b16 v[188:189], v30 offset:6144
ds_read_b64_tr_b16 v[190:191], v30 offset:6656
s_waitcnt vmcnt(63) lgkmcnt(4)
v_mfma_f32_32x32x16_bf16 v[80:95], v[168:171], v[176:179], v[80:95]
ds_read_b64_tr_b16 v[136:137], v29 offset:8192
ds_read_b64_tr_b16 v[138:139], v29 offset:8704
v_mfma_f32_32x32x16_bf16 v[96:111], v[172:175], v[176:179], v[96:111]
ds_read_b64_tr_b16 v[140:141], v30 offset:8192
ds_read_b64_tr_b16 v[142:143], v30 offset:8704
buffer_load_dwordx4 a[244:247], v33, s[4:7], s81 offen offset:1024 sc1
s_waitcnt vmcnt(63) lgkmcnt(4)
v_mfma_f32_32x32x16_bf16 v[80:95], v[184:187], v[180:183], v[80:95]
ds_read_b64_tr_b16 v[152:153], v29 offset:10240
ds_read_b64_tr_b16 v[154:155], v29 offset:10752
buffer_load_dwordx4 v26, s[84:87], s79 offen offset:1024 lds
v_mfma_f32_32x32x16_bf16 v[96:111], v[188:191], v[180:183], v[96:111]
ds_read_b64_tr_b16 v[156:157], v30 offset:10240
ds_read_b64_tr_b16 v[158:159], v30 offset:10752
buffer_load_dwordx4 a[248:251], v33, s[4:7], s81 offen offset:2048 sc1
s_waitcnt vmcnt(63) lgkmcnt(4)
v_mfma_f32_32x32x16_bf16 v[80:95], v[136:139], v[208:211], v[80:95]
ds_read_b64_tr_b16 v[168:169], v29 offset:12288
ds_read_b64_tr_b16 v[170:171], v29 offset:12800
v_mfma_f32_32x32x16_bf16 v[96:111], v[140:143], v[208:211], v[96:111]
ds_read_b64_tr_b16 v[172:173], v30 offset:12288
ds_read_b64_tr_b16 v[174:175], v30 offset:12800
buffer_load_dwordx4 a[252:255], v33, s[4:7], s81 offen offset:3072 sc1
s_waitcnt vmcnt(63) lgkmcnt(4)
v_mfma_f32_32x32x16_bf16 v[80:95], v[152:155], v[212:215], v[80:95]
ds_read_b64_tr_b16 v[184:185], v29 offset:14336
ds_read_b64_tr_b16 v[186:187], v29 offset:14848
buffer_load_dwordx4 v27, s[84:87], s79 offen offset:2048 lds
v_mfma_f32_32x32x16_bf16 v[96:111], v[156:159], v[212:215], v[96:111]
ds_read_b64_tr_b16 v[188:189], v30 offset:14336
ds_read_b64_tr_b16 v[190:191], v30 offset:14848
s_waitcnt vmcnt(63) lgkmcnt(4)
s_barrier
v_mfma_f32_32x32x16_bf16 v[80:95], v[168:171], v[240:243], v[80:95]
ds_read_b64_tr_b16 v[136:137], v29 offset:16384
ds_read_b64_tr_b16 v[138:139], v29 offset:16896
v_mfma_f32_32x32x16_bf16 v[96:111], v[172:175], v[240:243], v[96:111]
ds_read_b64_tr_b16 v[140:141], v30 offset:16384
ds_read_b64_tr_b16 v[142:143], v30 offset:16896
s_add_u32 s80, s52, 65536
s_add_u32 s81, s52, 69632
buffer_load_dwordx4 a[64:67], v33, s[4:7], s80 offen offset:0 sc1
s_waitcnt vmcnt(63) lgkmcnt(4)
v_mfma_f32_32x32x16_bf16 v[80:95], v[184:187], v[244:247], v[80:95]
ds_read_b64_tr_b16 v[152:153], v29 offset:18432
ds_read_b64_tr_b16 v[154:155], v29 offset:18944
buffer_load_dwordx4 v28, s[84:87], s79 offen offset:3072 lds
v_mfma_f32_32x32x16_bf16 v[96:111], v[188:191], v[244:247], v[96:111]
ds_read_b64_tr_b16 v[156:157], v30 offset:18432
ds_read_b64_tr_b16 v[158:159], v30 offset:18944
s_waitcnt vmcnt(63) lgkmcnt(4)
v_mfma_f32_32x32x16_bf16 v[48:63], v[136:139], v[144:147], v[48:63]
ds_read_b64_tr_b16 v[168:169], v29 offset:20480
ds_read_b64_tr_b16 v[170:171], v29 offset:20992
s_add_u32 m0, s31, 32768
s_lshl1_add_u32 s79, s48, s39
v_mfma_f32_32x32x16_bf16 v[64:79], v[140:143], v[144:147], v[64:79]
ds_read_b64_tr_b16 v[172:173], v30 offset:20480
ds_read_b64_tr_b16 v[174:175], v30 offset:20992
buffer_load_dwordx4 a[68:71], v33, s[4:7], s80 offen offset:1024 sc1
s_waitcnt vmcnt(63) lgkmcnt(4)
v_mfma_f32_32x32x16_bf16 v[48:63], v[152:155], v[148:151], v[48:63]
ds_read_b64_tr_b16 v[184:185], v29 offset:22528
ds_read_b64_tr_b16 v[186:187], v29 offset:23040
buffer_load_dwordx4 v25, s[84:87], s79 offen offset:0 lds
v_mfma_f32_32x32x16_bf16 v[64:79], v[156:159], v[148:151], v[64:79]
ds_read_b64_tr_b16 v[188:189], v30 offset:22528
ds_read_b64_tr_b16 v[190:191], v30 offset:23040
s_waitcnt vmcnt(63) lgkmcnt(4)
v_mfma_f32_32x32x16_bf16 v[48:63], v[168:171], v[176:179], v[48:63]
ds_read_b64_tr_b16 v[136:137], v29 offset:24576
ds_read_b64_tr_b16 v[138:139], v29 offset:25088
v_mfma_f32_32x32x16_bf16 v[64:79], v[172:175], v[176:179], v[64:79]
ds_read_b64_tr_b16 v[140:141], v30 offset:24576
ds_read_b64_tr_b16 v[142:143], v30 offset:25088
buffer_load_dwordx4 a[72:75], v33, s[4:7], s80 offen offset:2048 sc1
s_waitcnt vmcnt(63) lgkmcnt(4)
v_mfma_f32_32x32x16_bf16 v[48:63], v[184:187], v[180:183], v[48:63]
ds_read_b64_tr_b16 v[152:153], v29 offset:26624
ds_read_b64_tr_b16 v[154:155], v29 offset:27136
buffer_load_dwordx4 v26, s[84:87], s79 offen offset:1024 lds
v_mfma_f32_32x32x16_bf16 v[64:79], v[188:191], v[180:183], v[64:79]
ds_read_b64_tr_b16 v[156:157], v30 offset:26624
ds_read_b64_tr_b16 v[158:159], v30 offset:27136
buffer_load_dwordx4 a[76:79], v33, s[4:7], s80 offen offset:3072 sc1
s_waitcnt vmcnt(63) lgkmcnt(4)
v_mfma_f32_32x32x16_bf16 v[48:63], v[136:139], v[208:211], v[48:63]
ds_read_b64_tr_b16 v[168:169], v29 offset:28672
ds_read_b64_tr_b16 v[170:171], v29 offset:29184
v_mfma_f32_32x32x16_bf16 v[64:79], v[140:143], v[208:211], v[64:79]
ds_read_b64_tr_b16 v[172:173], v30 offset:28672
ds_read_b64_tr_b16 v[174:175], v30 offset:29184
buffer_load_dwordx4 a[80:83], v33, s[4:7], s81 offen offset:0 sc1
s_waitcnt vmcnt(63) lgkmcnt(4)
v_mfma_f32_32x32x16_bf16 v[48:63], v[152:155], v[212:215], v[48:63]
ds_read_b64_tr_b16 v[184:185], v29 offset:30720
ds_read_b64_tr_b16 v[186:187], v29 offset:31232
buffer_load_dwordx4 v27, s[84:87], s79 offen offset:2048 lds
v_mfma_f32_32x32x16_bf16 v[64:79], v[156:159], v[212:215], v[64:79]
ds_read_b64_tr_b16 v[188:189], v30 offset:30720
ds_read_b64_tr_b16 v[190:191], v30 offset:31232
s_waitcnt vmcnt(63) lgkmcnt(4)
s_barrier
v_mfma_f32_32x32x16_bf16 v[48:63], v[168:171], v[240:243], v[48:63]
ds_read_b64_tr_b16 v[136:137], v18 offset:0
ds_read_b64_tr_b16 v[138:139], v18 offset:512
v_mfma_f32_32x32x16_bf16 v[64:79], v[172:175], v[240:243], v[64:79]
ds_read_b64_tr_b16 v[140:141], v19 offset:0
ds_read_b64_tr_b16 v[142:143], v19 offset:512
buffer_load_dwordx4 a[84:87], v33, s[4:7], s81 offen offset:1024 sc1
s_waitcnt vmcnt(63) lgkmcnt(4)
v_mfma_f32_32x32x16_bf16 v[48:63], v[184:187], v[244:247], v[48:63]
ds_read_b64_tr_b16 v[152:153], v18 offset:2048
ds_read_b64_tr_b16 v[154:155], v18 offset:2560
buffer_load_dwordx4 v28, s[84:87], s79 offen offset:3072 lds
v_mfma_f32_32x32x16_bf16 v[64:79], v[188:191], v[244:247], v[64:79]
ds_read_b64_tr_b16 v[156:157], v19 offset:2048
ds_read_b64_tr_b16 v[158:159], v19 offset:2560
s_waitcnt vmcnt(63) lgkmcnt(4)
v_mfma_f32_32x32x16_bf16 v[80:95], v[136:139], a[128:131], v[80:95]
ds_read_b64_tr_b16 v[168:169], v18 offset:4096
ds_read_b64_tr_b16 v[170:171], v18 offset:4608
s_add_u32 m0, s31, 131072
s_lshl1_add_u32 s79, s49, s39
v_mfma_f32_32x32x16_bf16 v[96:111], v[140:143], a[128:131], v[96:111]
ds_read_b64_tr_b16 v[172:173], v19 offset:4096
ds_read_b64_tr_b16 v[174:175], v19 offset:4608
buffer_load_dwordx4 a[88:91], v33, s[4:7], s81 offen offset:2048 sc1
s_waitcnt vmcnt(63) lgkmcnt(4)
v_mfma_f32_32x32x16_bf16 v[80:95], v[152:155], a[132:135], v[80:95]
ds_read_b64_tr_b16 v[184:185], v18 offset:6144
ds_read_b64_tr_b16 v[186:187], v18 offset:6656
buffer_load_dwordx4 v25, s[84:87], s79 offen offset:0 lds
v_mfma_f32_32x32x16_bf16 v[96:111], v[156:159], a[132:135], v[96:111]
ds_read_b64_tr_b16 v[188:189], v19 offset:6144
ds_read_b64_tr_b16 v[190:191], v19 offset:6656
s_waitcnt vmcnt(63) lgkmcnt(4)
v_mfma_f32_32x32x16_bf16 v[80:95], v[168:171], a[144:147], v[80:95]
ds_read_b64_tr_b16 v[136:137], v18 offset:8192
ds_read_b64_tr_b16 v[138:139], v18 offset:8704
v_mfma_f32_32x32x16_bf16 v[96:111], v[172:175], a[144:147], v[96:111]
ds_read_b64_tr_b16 v[140:141], v19 offset:8192
ds_read_b64_tr_b16 v[142:143], v19 offset:8704
buffer_load_dwordx4 a[92:95], v33, s[4:7], s81 offen offset:3072 sc1
s_waitcnt vmcnt(63) lgkmcnt(4)
v_mfma_f32_32x32x16_bf16 v[80:95], v[184:187], a[148:151], v[80:95]
ds_read_b64_tr_b16 v[152:153], v18 offset:10240
ds_read_b64_tr_b16 v[154:155], v18 offset:10752
buffer_load_dwordx4 v26, s[84:87], s79 offen offset:1024 lds
v_mfma_f32_32x32x16_bf16 v[96:111], v[188:191], a[148:151], v[96:111]
ds_read_b64_tr_b16 v[156:157], v19 offset:10240
ds_read_b64_tr_b16 v[158:159], v19 offset:10752
s_add_u32 s80, s53, 65536
s_add_u32 s81, s53, 69632
buffer_load_dwordx4 a[96:99], v33, s[4:7], s80 offen offset:0 sc1
s_waitcnt vmcnt(63) lgkmcnt(4)
v_mfma_f32_32x32x16_bf16 v[80:95], v[136:139], a[160:163], v[80:95]
ds_read_b64_tr_b16 v[168:169], v18 offset:12288
ds_read_b64_tr_b16 v[170:171], v18 offset:12800
v_mfma_f32_32x32x16_bf16 v[96:111], v[140:143], a[160:163], v[96:111]
ds_read_b64_tr_b16 v[172:173], v19 offset:12288
ds_read_b64_tr_b16 v[174:175], v19 offset:12800
buffer_load_dwordx4 a[100:103], v33, s[4:7], s80 offen offset:1024 sc1
s_waitcnt vmcnt(63) lgkmcnt(4)
v_mfma_f32_32x32x16_bf16 v[80:95], v[152:155], a[164:167], v[80:95]
ds_read_b64_tr_b16 v[184:185], v18 offset:14336
ds_read_b64_tr_b16 v[186:187], v18 offset:14848
buffer_load_dwordx4 v27, s[84:87], s79 offen offset:2048 lds
v_mfma_f32_32x32x16_bf16 v[96:111], v[156:159], a[164:167], v[96:111]
ds_read_b64_tr_b16 v[188:189], v19 offset:14336
ds_read_b64_tr_b16 v[190:191], v19 offset:14848
s_waitcnt vmcnt(63) lgkmcnt(4)
s_barrier
v_mfma_f32_32x32x16_bf16 v[80:95], v[168:171], a[176:179], v[80:95]
ds_read_b64_tr_b16 v[136:137], v20 offset:0
ds_read_b64_tr_b16 v[138:139], v20 offset:512
v_mfma_f32_32x32x16_bf16 v[96:111], v[172:175], a[176:179], v[96:111]
ds_read_b64_tr_b16 v[140:141], v21 offset:0
ds_read_b64_tr_b16 v[142:143], v21 offset:512
buffer_load_dwordx4 a[104:107], v33, s[4:7], s80 offen offset:2048 sc1
s_waitcnt vmcnt(63) lgkmcnt(4)
v_mfma_f32_32x32x16_bf16 v[80:95], v[184:187], a[180:183], v[80:95]
ds_read_b64_tr_b16 v[152:153], v20 offset:2048
ds_read_b64_tr_b16 v[154:155], v20 offset:2560
buffer_load_dwordx4 v28, s[84:87], s79 offen offset:3072 lds
v_mfma_f32_32x32x16_bf16 v[96:111], v[188:191], a[180:183], v[96:111]
ds_read_b64_tr_b16 v[156:157], v21 offset:2048
ds_read_b64_tr_b16 v[158:159], v21 offset:2560
s_waitcnt vmcnt(63) lgkmcnt(4)
v_mfma_f32_32x32x16_bf16 v[80:95], v[136:139], a[136:139], v[80:95]
ds_read_b64_tr_b16 v[168:169], v20 offset:4096
ds_read_b64_tr_b16 v[170:171], v20 offset:4608
s_add_u32 m0, s31, 147456
s_lshl1_add_u32 s79, s50, s39
v_mfma_f32_32x32x16_bf16 v[96:111], v[140:143], a[136:139], v[96:111]
ds_read_b64_tr_b16 v[172:173], v21 offset:4096
ds_read_b64_tr_b16 v[174:175], v21 offset:4608
buffer_load_dwordx4 a[108:111], v33, s[4:7], s80 offen offset:3072 sc1
s_waitcnt vmcnt(63) lgkmcnt(4)
v_mfma_f32_32x32x16_bf16 v[80:95], v[152:155], a[140:143], v[80:95]
ds_read_b64_tr_b16 v[184:185], v20 offset:6144
ds_read_b64_tr_b16 v[186:187], v20 offset:6656
buffer_load_dwordx4 v25, s[84:87], s79 offen offset:0 lds
v_mfma_f32_32x32x16_bf16 v[96:111], v[156:159], a[140:143], v[96:111]
ds_read_b64_tr_b16 v[188:189], v21 offset:6144
ds_read_b64_tr_b16 v[190:191], v21 offset:6656
s_waitcnt vmcnt(63) lgkmcnt(4)
v_mfma_f32_32x32x16_bf16 v[80:95], v[168:171], a[152:155], v[80:95]
ds_read_b64_tr_b16 v[136:137], v20 offset:8192
ds_read_b64_tr_b16 v[138:139], v20 offset:8704
v_mfma_f32_32x32x16_bf16 v[96:111], v[172:175], a[152:155], v[96:111]
ds_read_b64_tr_b16 v[140:141], v21 offset:8192
ds_read_b64_tr_b16 v[142:143], v21 offset:8704
buffer_load_dwordx4 a[112:115], v33, s[4:7], s81 offen offset:0 sc1
s_waitcnt vmcnt(58) lgkmcnt(4)
v_mfma_f32_32x32x16_bf16 v[80:95], v[184:187], a[156:159], v[80:95]
ds_read_b64_tr_b16 v[152:153], v20 offset:10240
ds_read_b64_tr_b16 v[154:155], v20 offset:10752
buffer_load_dwordx4 v26, s[84:87], s79 offen offset:1024 lds
v_mfma_f32_32x32x16_bf16 v[96:111], v[188:191], a[156:159], v[96:111]
ds_read_b64_tr_b16 v[156:157], v21 offset:10240
ds_read_b64_tr_b16 v[158:159], v21 offset:10752
buffer_load_dwordx4 a[116:119], v33, s[4:7], s81 offen offset:1024 sc1
s_waitcnt vmcnt(58) lgkmcnt(4)
v_mfma_f32_32x32x16_bf16 v[80:95], v[136:139], a[168:171], v[80:95]
ds_read_b64_tr_b16 v[168:169], v20 offset:12288
ds_read_b64_tr_b16 v[170:171], v20 offset:12800
v_mfma_f32_32x32x16_bf16 v[96:111], v[140:143], a[168:171], v[96:111]
ds_read_b64_tr_b16 v[172:173], v21 offset:12288
ds_read_b64_tr_b16 v[174:175], v21 offset:12800
buffer_load_dwordx4 a[120:123], v33, s[4:7], s81 offen offset:2048 sc1
s_waitcnt vmcnt(57) lgkmcnt(4)
v_mfma_f32_32x32x16_bf16 v[80:95], v[152:155], a[172:175], v[80:95]
ds_read_b64_tr_b16 v[184:185], v20 offset:14336
ds_read_b64_tr_b16 v[186:187], v20 offset:14848
buffer_load_dwordx4 v27, s[84:87], s79 offen offset:2048 lds
v_mfma_f32_32x32x16_bf16 v[96:111], v[156:159], a[172:175], v[96:111]
ds_read_b64_tr_b16 v[188:189], v21 offset:14336
ds_read_b64_tr_b16 v[190:191], v21 offset:14848
s_waitcnt vmcnt(54) lgkmcnt(4)
s_barrier
v_mfma_f32_32x32x16_bf16 v[80:95], v[168:171], a[184:187], v[80:95]
ds_read_b64_tr_b16 v[136:137], v18 offset:16384
ds_read_b64_tr_b16 v[138:139], v18 offset:16896
v_mfma_f32_32x32x16_bf16 v[96:111], v[172:175], a[184:187], v[96:111]
ds_read_b64_tr_b16 v[140:141], v19 offset:16384
ds_read_b64_tr_b16 v[142:143], v19 offset:16896
buffer_load_dwordx4 a[124:127], v33, s[4:7], s81 offen offset:3072 sc1
s_waitcnt vmcnt(55) lgkmcnt(4)
v_mfma_f32_32x32x16_bf16 v[80:95], v[184:187], a[188:191], v[80:95]
ds_read_b64_tr_b16 v[152:153], v18 offset:18432
ds_read_b64_tr_b16 v[154:155], v18 offset:18944
buffer_load_dwordx4 v28, s[84:87], s79 offen offset:3072 lds
v_mfma_f32_32x32x16_bf16 v[96:111], v[188:191], a[188:191], v[96:111]
ds_read_b64_tr_b16 v[156:157], v19 offset:18432
ds_read_b64_tr_b16 v[158:159], v19 offset:18944
s_waitcnt vmcnt(55) lgkmcnt(4)
v_mfma_f32_32x32x16_bf16 v[80:95], v[136:139], a[192:195], v[80:95]
ds_read_b64_tr_b16 v[168:169], v18 offset:20480
ds_read_b64_tr_b16 v[170:171], v18 offset:20992
s_add_u32 m0, s31, 0
s_lshl1_add_u32 s79, s51, s39
v_mfma_f32_32x32x16_bf16 v[96:111], v[140:143], a[192:195], v[96:111]
ds_read_b64_tr_b16 v[172:173], v19 offset:20480
ds_read_b64_tr_b16 v[174:175], v19 offset:20992
s_waitcnt vmcnt(53) lgkmcnt(4)
v_mfma_f32_32x32x16_bf16 v[80:95], v[152:155], a[196:199], v[80:95]
ds_read_b64_tr_b16 v[184:185], v18 offset:22528
ds_read_b64_tr_b16 v[186:187], v18 offset:23040
buffer_load_dwordx4 v25, s[84:87], s79 offen offset:0 lds
v_mfma_f32_32x32x16_bf16 v[96:111], v[156:159], a[196:199], v[96:111]
ds_read_b64_tr_b16 v[188:189], v19 offset:22528
ds_read_b64_tr_b16 v[190:191], v19 offset:23040
s_waitcnt vmcnt(53) lgkmcnt(4)
v_mfma_f32_32x32x16_bf16 v[80:95], v[168:171], a[200:203], v[80:95]
ds_read_b64_tr_b16 v[136:137], v18 offset:24576
ds_read_b64_tr_b16 v[138:139], v18 offset:25088
v_mfma_f32_32x32x16_bf16 v[96:111], v[172:175], a[200:203], v[96:111]
ds_read_b64_tr_b16 v[140:141], v19 offset:24576
ds_read_b64_tr_b16 v[142:143], v19 offset:25088
s_waitcnt vmcnt(51) lgkmcnt(4)
v_mfma_f32_32x32x16_bf16 v[80:95], v[184:187], a[204:207], v[80:95]
ds_read_b64_tr_b16 v[152:153], v18 offset:26624
ds_read_b64_tr_b16 v[154:155], v18 offset:27136
buffer_load_dwordx4 v26, s[84:87], s79 offen offset:1024 lds
v_mfma_f32_32x32x16_bf16 v[96:111], v[188:191], a[204:207], v[96:111]
ds_read_b64_tr_b16 v[156:157], v19 offset:26624
ds_read_b64_tr_b16 v[158:159], v19 offset:27136
s_waitcnt vmcnt(50) lgkmcnt(4)
v_mfma_f32_32x32x16_bf16 v[80:95], v[136:139], a[208:211], v[80:95]
ds_read_b64_tr_b16 v[168:169], v18 offset:28672
ds_read_b64_tr_b16 v[170:171], v18 offset:29184
v_mfma_f32_32x32x16_bf16 v[96:111], v[140:143], a[208:211], v[96:111]
ds_read_b64_tr_b16 v[172:173], v19 offset:28672
ds_read_b64_tr_b16 v[174:175], v19 offset:29184
s_waitcnt vmcnt(49) lgkmcnt(4)
v_mfma_f32_32x32x16_bf16 v[80:95], v[152:155], a[212:215], v[80:95]
ds_read_b64_tr_b16 v[184:185], v18 offset:30720
ds_read_b64_tr_b16 v[186:187], v18 offset:31232
buffer_load_dwordx4 v27, s[84:87], s79 offen offset:2048 lds
v_mfma_f32_32x32x16_bf16 v[96:111], v[156:159], a[212:215], v[96:111]
ds_read_b64_tr_b16 v[188:189], v19 offset:30720
ds_read_b64_tr_b16 v[190:191], v19 offset:31232
s_waitcnt vmcnt(48) lgkmcnt(4)
s_barrier
v_mfma_f32_32x32x16_bf16 v[80:95], v[168:171], a[216:219], v[80:95]
ds_read_b64_tr_b16 v[136:137], v20 offset:16384
ds_read_b64_tr_b16 v[138:139], v20 offset:16896
v_mfma_f32_32x32x16_bf16 v[96:111], v[172:175], a[216:219], v[96:111]
ds_read_b64_tr_b16 v[140:141], v21 offset:16384
ds_read_b64_tr_b16 v[142:143], v21 offset:16896
s_waitcnt vmcnt(46) lgkmcnt(4)
v_mfma_f32_32x32x16_bf16 v[80:95], v[184:187], a[220:223], v[80:95]
ds_read_b64_tr_b16 v[152:153], v20 offset:18432
ds_read_b64_tr_b16 v[154:155], v20 offset:18944
buffer_load_dwordx4 v28, s[84:87], s79 offen offset:3072 lds
v_mfma_f32_32x32x16_bf16 v[96:111], v[188:191], a[220:223], v[96:111]
ds_read_b64_tr_b16 v[156:157], v21 offset:18432
ds_read_b64_tr_b16 v[158:159], v21 offset:18944
s_waitcnt vmcnt(46) lgkmcnt(4)
v_mfma_f32_32x32x16_bf16 v[80:95], v[136:139], a[224:227], v[80:95]
ds_read_b64_tr_b16 v[168:169], v20 offset:20480
ds_read_b64_tr_b16 v[170:171], v20 offset:20992
s_add_u32 m0, s31, 65536
s_lshl1_add_u32 s79, s52, s39
v_mfma_f32_32x32x16_bf16 v[96:111], v[140:143], a[224:227], v[96:111]
ds_read_b64_tr_b16 v[172:173], v21 offset:20480
ds_read_b64_tr_b16 v[174:175], v21 offset:20992
s_waitcnt vmcnt(44) lgkmcnt(4)
v_mfma_f32_32x32x16_bf16 v[80:95], v[152:155], a[228:231], v[80:95]
ds_read_b64_tr_b16 v[184:185], v20 offset:22528
ds_read_b64_tr_b16 v[186:187], v20 offset:23040
buffer_load_dwordx4 v25, s[84:87], s79 offen offset:0 lds
v_mfma_f32_32x32x16_bf16 v[96:111], v[156:159], a[228:231], v[96:111]
ds_read_b64_tr_b16 v[188:189], v21 offset:22528
ds_read_b64_tr_b16 v[190:191], v21 offset:23040
s_waitcnt vmcnt(43) lgkmcnt(4)
v_mfma_f32_32x32x16_bf16 v[80:95], v[168:171], a[232:235], v[80:95]
ds_read_b64_tr_b16 v[136:137], v20 offset:24576
ds_read_b64_tr_b16 v[138:139], v20 offset:25088
v_mfma_f32_32x32x16_bf16 v[96:111], v[172:175], a[232:235], v[96:111]
ds_read_b64_tr_b16 v[140:141], v21 offset:24576
ds_read_b64_tr_b16 v[142:143], v21 offset:25088
s_waitcnt vmcnt(42) lgkmcnt(4)
v_mfma_f32_32x32x16_bf16 v[80:95], v[184:187], a[236:239], v[80:95]
ds_read_b64_tr_b16 v[152:153], v20 offset:26624
ds_read_b64_tr_b16 v[154:155], v20 offset:27136
buffer_load_dwordx4 v26, s[84:87], s79 offen offset:1024 lds
v_mfma_f32_32x32x16_bf16 v[96:111], v[188:191], a[236:239], v[96:111]
ds_read_b64_tr_b16 v[156:157], v21 offset:26624
ds_read_b64_tr_b16 v[158:159], v21 offset:27136
s_waitcnt vmcnt(41) lgkmcnt(4)
v_mfma_f32_32x32x16_bf16 v[80:95], v[136:139], a[240:243], v[80:95]
ds_read_b64_tr_b16 v[168:169], v20 offset:28672
ds_read_b64_tr_b16 v[170:171], v20 offset:29184
v_mfma_f32_32x32x16_bf16 v[96:111], v[140:143], a[240:243], v[96:111]
ds_read_b64_tr_b16 v[172:173], v21 offset:28672
ds_read_b64_tr_b16 v[174:175], v21 offset:29184
s_waitcnt vmcnt(39) lgkmcnt(4)
v_mfma_f32_32x32x16_bf16 v[80:95], v[152:155], a[244:247], v[80:95]
ds_read_b64_tr_b16 v[184:185], v20 offset:30720
ds_read_b64_tr_b16 v[186:187], v20 offset:31232
buffer_load_dwordx4 v27, s[84:87], s79 offen offset:2048 lds
v_mfma_f32_32x32x16_bf16 v[96:111], v[156:159], a[244:247], v[96:111]
ds_read_b64_tr_b16 v[188:189], v21 offset:30720
ds_read_b64_tr_b16 v[190:191], v21 offset:31232
s_waitcnt vmcnt(38) lgkmcnt(4)
s_barrier
v_mfma_f32_32x32x16_bf16 v[80:95], v[168:171], a[248:251], v[80:95]
ds_read_b64_tr_b16 v[136:137], v18 offset:49152
ds_read_b64_tr_b16 v[138:139], v18 offset:49664
v_mfma_f32_32x32x16_bf16 v[96:111], v[172:175], a[248:251], v[96:111]
ds_read_b64_tr_b16 v[140:141], v19 offset:49152
ds_read_b64_tr_b16 v[142:143], v19 offset:49664
s_waitcnt vmcnt(37) lgkmcnt(4)
v_mfma_f32_32x32x16_bf16 v[80:95], v[184:187], a[252:255], v[80:95]
ds_read_b64_tr_b16 v[152:153], v18 offset:51200
ds_read_b64_tr_b16 v[154:155], v18 offset:51712
buffer_load_dwordx4 v28, s[84:87], s79 offen offset:3072 lds
v_mfma_f32_32x32x16_bf16 v[96:111], v[188:191], a[252:255], v[96:111]
ds_read_b64_tr_b16 v[156:157], v19 offset:51200
ds_read_b64_tr_b16 v[158:159], v19 offset:51712
s_waitcnt vmcnt(36) lgkmcnt(4)
v_mfma_f32_32x32x16_bf16 v[80:95], v[136:139], a[64:67], v[80:95]
ds_read_b64_tr_b16 v[168:169], v18 offset:53248
ds_read_b64_tr_b16 v[170:171], v18 offset:53760
s_add_u32 m0, s31, 16384
s_lshl1_add_u32 s79, s53, s39
v_mfma_f32_32x32x16_bf16 v[96:111], v[140:143], a[64:67], v[96:111]
ds_read_b64_tr_b16 v[172:173], v19 offset:53248
ds_read_b64_tr_b16 v[174:175], v19 offset:53760
s_waitcnt vmcnt(34) lgkmcnt(4)
v_mfma_f32_32x32x16_bf16 v[80:95], v[152:155], a[68:71], v[80:95]
ds_read_b64_tr_b16 v[184:185], v18 offset:55296
ds_read_b64_tr_b16 v[186:187], v18 offset:55808
buffer_load_dwordx4 v25, s[84:87], s79 offen offset:0 lds
v_mfma_f32_32x32x16_bf16 v[96:111], v[156:159], a[68:71], v[96:111]
ds_read_b64_tr_b16 v[188:189], v19 offset:55296
ds_read_b64_tr_b16 v[190:191], v19 offset:55808
s_waitcnt vmcnt(33) lgkmcnt(4)
v_mfma_f32_32x32x16_bf16 v[80:95], v[168:171], a[72:75], v[80:95]
ds_read_b64_tr_b16 v[136:137], v18 offset:57344
ds_read_b64_tr_b16 v[138:139], v18 offset:57856
v_mfma_f32_32x32x16_bf16 v[96:111], v[172:175], a[72:75], v[96:111]
ds_read_b64_tr_b16 v[140:141], v19 offset:57344
ds_read_b64_tr_b16 v[142:143], v19 offset:57856
s_waitcnt vmcnt(31) lgkmcnt(4)
v_mfma_f32_32x32x16_bf16 v[80:95], v[184:187], a[76:79], v[80:95]
ds_read_b64_tr_b16 v[152:153], v18 offset:59392
ds_read_b64_tr_b16 v[154:155], v18 offset:59904
buffer_load_dwordx4 v26, s[84:87], s79 offen offset:1024 lds
v_mfma_f32_32x32x16_bf16 v[96:111], v[188:191], a[76:79], v[96:111]
ds_read_b64_tr_b16 v[156:157], v19 offset:59392
ds_read_b64_tr_b16 v[158:159], v19 offset:59904
s_waitcnt vmcnt(31) lgkmcnt(4)
v_mfma_f32_32x32x16_bf16 v[80:95], v[136:139], a[80:83], v[80:95]
ds_read_b64_tr_b16 v[168:169], v18 offset:61440
ds_read_b64_tr_b16 v[170:171], v18 offset:61952
v_mfma_f32_32x32x16_bf16 v[96:111], v[140:143], a[80:83], v[96:111]
ds_read_b64_tr_b16 v[172:173], v19 offset:61440
ds_read_b64_tr_b16 v[174:175], v19 offset:61952
s_waitcnt vmcnt(29) lgkmcnt(4)
v_mfma_f32_32x32x16_bf16 v[80:95], v[152:155], a[84:87], v[80:95]
ds_read_b64_tr_b16 v[184:185], v18 offset:63488
ds_read_b64_tr_b16 v[186:187], v18 offset:64000
buffer_load_dwordx4 v27, s[84:87], s79 offen offset:2048 lds
v_mfma_f32_32x32x16_bf16 v[96:111], v[156:159], a[84:87], v[96:111]
ds_read_b64_tr_b16 v[188:189], v19 offset:63488
ds_read_b64_tr_b16 v[190:191], v19 offset:64000
s_waitcnt vmcnt(28) lgkmcnt(4)
s_barrier
v_mfma_f32_32x32x16_bf16 v[80:95], v[168:171], a[88:91], v[80:95]
ds_read_b64_tr_b16 v[136:137], v20 offset:49152
ds_read_b64_tr_b16 v[138:139], v20 offset:49664
v_mfma_f32_32x32x16_bf16 v[96:111], v[172:175], a[88:91], v[96:111]
ds_read_b64_tr_b16 v[140:141], v21 offset:49152
ds_read_b64_tr_b16 v[142:143], v21 offset:49664
s_waitcnt vmcnt(26) lgkmcnt(4)
v_mfma_f32_32x32x16_bf16 v[80:95], v[184:187], a[92:95], v[80:95]
ds_read_b64_tr_b16 v[152:153], v20 offset:51200
ds_read_b64_tr_b16 v[154:155], v20 offset:51712
buffer_load_dwordx4 v28, s[84:87], s79 offen offset:3072 lds
v_mfma_f32_32x32x16_bf16 v[96:111], v[188:191], a[92:95], v[96:111]
ds_read_b64_tr_b16 v[156:157], v21 offset:51200
ds_read_b64_tr_b16 v[158:159], v21 offset:51712
s_waitcnt vmcnt(25) lgkmcnt(4)
v_mfma_f32_32x32x16_bf16 v[80:95], v[136:139], a[96:99], v[80:95]
ds_read_b64_tr_b16 v[168:169], v20 offset:53248
ds_read_b64_tr_b16 v[170:171], v20 offset:53760
v_mfma_f32_32x32x16_bf16 v[96:111], v[140:143], a[96:99], v[96:111]
ds_read_b64_tr_b16 v[172:173], v21 offset:53248
ds_read_b64_tr_b16 v[174:175], v21 offset:53760
s_waitcnt vmcnt(24) lgkmcnt(4)
v_mfma_f32_32x32x16_bf16 v[80:95], v[152:155], a[100:103], v[80:95]
ds_read_b64_tr_b16 v[184:185], v20 offset:55296
ds_read_b64_tr_b16 v[186:187], v20 offset:55808
v_mfma_f32_32x32x16_bf16 v[96:111], v[156:159], a[100:103], v[96:111]
ds_read_b64_tr_b16 v[188:189], v21 offset:55296
ds_read_b64_tr_b16 v[190:191], v21 offset:55808
s_waitcnt vmcnt(22) lgkmcnt(4)
v_mfma_f32_32x32x16_bf16 v[80:95], v[168:171], a[104:107], v[80:95]
ds_read_b64_tr_b16 v[136:137], v20 offset:57344
ds_read_b64_tr_b16 v[138:139], v20 offset:57856
v_mfma_f32_32x32x16_bf16 v[96:111], v[172:175], a[104:107], v[96:111]
ds_read_b64_tr_b16 v[140:141], v21 offset:57344
ds_read_b64_tr_b16 v[142:143], v21 offset:57856
s_waitcnt vmcnt(20) lgkmcnt(4)
v_mfma_f32_32x32x16_bf16 v[80:95], v[184:187], a[108:111], v[80:95]
ds_read_b64_tr_b16 v[152:153], v20 offset:59392
ds_read_b64_tr_b16 v[154:155], v20 offset:59904
v_mfma_f32_32x32x16_bf16 v[96:111], v[188:191], a[108:111], v[96:111]
ds_read_b64_tr_b16 v[156:157], v21 offset:59392
ds_read_b64_tr_b16 v[158:159], v21 offset:59904
s_waitcnt vmcnt(18) lgkmcnt(4)
v_mfma_f32_32x32x16_bf16 v[80:95], v[136:139], a[112:115], v[80:95]
ds_read_b64_tr_b16 v[168:169], v20 offset:61440
ds_read_b64_tr_b16 v[170:171], v20 offset:61952
v_mfma_f32_32x32x16_bf16 v[96:111], v[140:143], a[112:115], v[96:111]
ds_read_b64_tr_b16 v[172:173], v21 offset:61440
ds_read_b64_tr_b16 v[174:175], v21 offset:61952
s_waitcnt vmcnt(16) lgkmcnt(4)
v_mfma_f32_32x32x16_bf16 v[80:95], v[152:155], a[116:119], v[80:95]
ds_read_b64_tr_b16 v[184:185], v20 offset:63488
ds_read_b64_tr_b16 v[186:187], v20 offset:64000
v_mfma_f32_32x32x16_bf16 v[96:111], v[156:159], a[116:119], v[96:111]
ds_read_b64_tr_b16 v[188:189], v21 offset:63488
ds_read_b64_tr_b16 v[190:191], v21 offset:64000
s_waitcnt vmcnt(15) lgkmcnt(4)
s_barrier
v_mfma_f32_32x32x16_bf16 v[80:95], v[168:171], a[120:123], v[80:95]
ds_read_b64_tr_b16 v[136:137], v18 offset:32768
ds_read_b64_tr_b16 v[138:139], v18 offset:33280
v_mfma_f32_32x32x16_bf16 v[96:111], v[172:175], a[120:123], v[96:111]
ds_read_b64_tr_b16 v[140:141], v19 offset:32768
ds_read_b64_tr_b16 v[142:143], v19 offset:33280
s_waitcnt vmcnt(13) lgkmcnt(4)
v_mfma_f32_32x32x16_bf16 v[80:95], v[184:187], a[124:127], v[80:95]
ds_read_b64_tr_b16 v[152:153], v18 offset:34816
ds_read_b64_tr_b16 v[154:155], v18 offset:35328
v_mfma_f32_32x32x16_bf16 v[96:111], v[188:191], a[124:127], v[96:111]
ds_read_b64_tr_b16 v[156:157], v19 offset:34816
ds_read_b64_tr_b16 v[158:159], v19 offset:35328
s_waitcnt vmcnt(63) lgkmcnt(4)
v_mfma_f32_32x32x16_bf16 v[48:63], v[136:139], a[128:131], v[48:63]
ds_read_b64_tr_b16 v[168:169], v18 offset:36864
ds_read_b64_tr_b16 v[170:171], v18 offset:37376
v_mfma_f32_32x32x16_bf16 v[64:79], v[140:143], a[128:131], v[64:79]
ds_read_b64_tr_b16 v[172:173], v19 offset:36864
ds_read_b64_tr_b16 v[174:175], v19 offset:37376
s_waitcnt vmcnt(63) lgkmcnt(4)
v_mfma_f32_32x32x16_bf16 v[48:63], v[152:155], a[132:135], v[48:63]
ds_read_b64_tr_b16 v[184:185], v18 offset:38912
ds_read_b64_tr_b16 v[186:187], v18 offset:39424
v_cvt_pk_bf16_f32 v80, v80, v81
v_cvt_pk_bf16_f32 v81, v82, v83
v_cvt_pk_bf16_f32 v82, v84, v85
v_cvt_pk_bf16_f32 v83, v86, v87
buffer_store_dwordx4 v[80:83], v33, s[12:15], s82 offen offset:0 sc1
v_mfma_f32_32x32x16_bf16 v[64:79], v[156:159], a[132:135], v[64:79]
ds_read_b64_tr_b16 v[188:189], v19 offset:38912
ds_read_b64_tr_b16 v[190:191], v19 offset:39424
s_waitcnt vmcnt(63) lgkmcnt(4)
v_mfma_f32_32x32x16_bf16 v[48:63], v[168:171], a[144:147], v[48:63]
ds_read_b64_tr_b16 v[136:137], v18 offset:40960
ds_read_b64_tr_b16 v[138:139], v18 offset:41472
v_cvt_pk_bf16_f32 v84, v88, v89
v_cvt_pk_bf16_f32 v85, v90, v91
v_cvt_pk_bf16_f32 v86, v92, v93
v_cvt_pk_bf16_f32 v87, v94, v95
buffer_store_dwordx4 v[84:87], v33, s[12:15], s82 offen offset:1024 sc1
v_mfma_f32_32x32x16_bf16 v[64:79], v[172:175], a[144:147], v[64:79]
ds_read_b64_tr_b16 v[140:141], v19 offset:40960
ds_read_b64_tr_b16 v[142:143], v19 offset:41472
s_waitcnt vmcnt(63) lgkmcnt(4)
v_mfma_f32_32x32x16_bf16 v[48:63], v[184:187], a[148:151], v[48:63]
ds_read_b64_tr_b16 v[152:153], v18 offset:43008
ds_read_b64_tr_b16 v[154:155], v18 offset:43520
v_cvt_pk_bf16_f32 v88, v96, v97
v_cvt_pk_bf16_f32 v89, v98, v99
v_cvt_pk_bf16_f32 v90, v100, v101
v_cvt_pk_bf16_f32 v91, v102, v103
buffer_store_dwordx4 v[88:91], v33, s[12:15], s82 offen offset:2048 sc1
v_mfma_f32_32x32x16_bf16 v[64:79], v[188:191], a[148:151], v[64:79]
ds_read_b64_tr_b16 v[156:157], v19 offset:43008
ds_read_b64_tr_b16 v[158:159], v19 offset:43520
s_waitcnt vmcnt(63) lgkmcnt(4)
v_mfma_f32_32x32x16_bf16 v[48:63], v[136:139], a[160:163], v[48:63]
ds_read_b64_tr_b16 v[168:169], v18 offset:45056
ds_read_b64_tr_b16 v[170:171], v18 offset:45568
v_cvt_pk_bf16_f32 v92, v104, v105
v_cvt_pk_bf16_f32 v93, v106, v107
v_cvt_pk_bf16_f32 v94, v108, v109
v_cvt_pk_bf16_f32 v95, v110, v111
buffer_store_dwordx4 v[92:95], v33, s[12:15], s82 offen offset:3072 sc1
v_mfma_f32_32x32x16_bf16 v[64:79], v[140:143], a[160:163], v[64:79]
ds_read_b64_tr_b16 v[172:173], v19 offset:45056
ds_read_b64_tr_b16 v[174:175], v19 offset:45568
s_waitcnt vmcnt(63) lgkmcnt(4)
v_mfma_f32_32x32x16_bf16 v[48:63], v[152:155], a[164:167], v[48:63]
ds_read_b64_tr_b16 v[184:185], v18 offset:47104
ds_read_b64_tr_b16 v[186:187], v18 offset:47616
v_mfma_f32_32x32x16_bf16 v[64:79], v[156:159], a[164:167], v[64:79]
ds_read_b64_tr_b16 v[188:189], v19 offset:47104
ds_read_b64_tr_b16 v[190:191], v19 offset:47616
s_waitcnt vmcnt(63) lgkmcnt(4)
s_barrier
v_mfma_f32_32x32x16_bf16 v[48:63], v[168:171], a[176:179], v[48:63]
ds_read_b64_tr_b16 v[136:137], v29 offset:0
ds_read_b64_tr_b16 v[138:139], v29 offset:512
v_mfma_f32_32x32x16_bf16 v[64:79], v[172:175], a[176:179], v[64:79]
ds_read_b64_tr_b16 v[140:141], v30 offset:0
ds_read_b64_tr_b16 v[142:143], v30 offset:512
s_waitcnt vmcnt(63) lgkmcnt(4)
v_mfma_f32_32x32x16_bf16 v[48:63], v[184:187], a[180:183], v[48:63]
ds_read_b64_tr_b16 v[152:153], v29 offset:2048
ds_read_b64_tr_b16 v[154:155], v29 offset:2560
v_mfma_f32_32x32x16_bf16 v[64:79], v[188:191], a[180:183], v[64:79]
ds_read_b64_tr_b16 v[156:157], v30 offset:2048
ds_read_b64_tr_b16 v[158:159], v30 offset:2560
s_waitcnt vmcnt(63) lgkmcnt(4)
v_mfma_f32_32x32x16_bf16 v[48:63], v[136:139], a[136:139], v[48:63]
ds_read_b64_tr_b16 v[168:169], v29 offset:4096
ds_read_b64_tr_b16 v[170:171], v29 offset:4608
v_mfma_f32_32x32x16_bf16 v[64:79], v[140:143], a[136:139], v[64:79]
ds_read_b64_tr_b16 v[172:173], v30 offset:4096
ds_read_b64_tr_b16 v[174:175], v30 offset:4608
s_waitcnt vmcnt(63) lgkmcnt(4)
v_mfma_f32_32x32x16_bf16 v[48:63], v[152:155], a[140:143], v[48:63]
ds_read_b64_tr_b16 v[184:185], v29 offset:6144
ds_read_b64_tr_b16 v[186:187], v29 offset:6656
v_mfma_f32_32x32x16_bf16 v[64:79], v[156:159], a[140:143], v[64:79]
ds_read_b64_tr_b16 v[188:189], v30 offset:6144
ds_read_b64_tr_b16 v[190:191], v30 offset:6656
s_waitcnt vmcnt(63) lgkmcnt(4)
v_mfma_f32_32x32x16_bf16 v[48:63], v[168:171], a[152:155], v[48:63]
ds_read_b64_tr_b16 v[136:137], v29 offset:8192
ds_read_b64_tr_b16 v[138:139], v29 offset:8704
v_mfma_f32_32x32x16_bf16 v[64:79], v[172:175], a[152:155], v[64:79]
ds_read_b64_tr_b16 v[140:141], v30 offset:8192
ds_read_b64_tr_b16 v[142:143], v30 offset:8704
s_waitcnt vmcnt(63) lgkmcnt(4)
v_mfma_f32_32x32x16_bf16 v[48:63], v[184:187], a[156:159], v[48:63]
ds_read_b64_tr_b16 v[152:153], v29 offset:10240
ds_read_b64_tr_b16 v[154:155], v29 offset:10752
v_mfma_f32_32x32x16_bf16 v[64:79], v[188:191], a[156:159], v[64:79]
ds_read_b64_tr_b16 v[156:157], v30 offset:10240
ds_read_b64_tr_b16 v[158:159], v30 offset:10752
s_waitcnt vmcnt(63) lgkmcnt(4)
v_mfma_f32_32x32x16_bf16 v[48:63], v[136:139], a[168:171], v[48:63]
ds_read_b64_tr_b16 v[168:169], v29 offset:12288
ds_read_b64_tr_b16 v[170:171], v29 offset:12800
v_mfma_f32_32x32x16_bf16 v[64:79], v[140:143], a[168:171], v[64:79]
ds_read_b64_tr_b16 v[172:173], v30 offset:12288
ds_read_b64_tr_b16 v[174:175], v30 offset:12800
s_waitcnt vmcnt(63) lgkmcnt(4)
v_mfma_f32_32x32x16_bf16 v[48:63], v[152:155], a[172:175], v[48:63]
ds_read_b64_tr_b16 v[184:185], v29 offset:14336
ds_read_b64_tr_b16 v[186:187], v29 offset:14848
v_mfma_f32_32x32x16_bf16 v[64:79], v[156:159], a[172:175], v[64:79]
ds_read_b64_tr_b16 v[188:189], v30 offset:14336
ds_read_b64_tr_b16 v[190:191], v30 offset:14848
s_waitcnt vmcnt(16) lgkmcnt(4)
s_barrier
v_mfma_f32_32x32x16_bf16 v[48:63], v[168:171], a[184:187], v[48:63]
ds_read_b64_tr_b16 v[136:137], v29 offset:16384
ds_read_b64_tr_b16 v[138:139], v29 offset:16896
v_mfma_f32_32x32x16_bf16 v[64:79], v[172:175], a[184:187], v[64:79]
ds_read_b64_tr_b16 v[140:141], v30 offset:16384
ds_read_b64_tr_b16 v[142:143], v30 offset:16896
s_waitcnt vmcnt(16) lgkmcnt(4)
v_mfma_f32_32x32x16_bf16 v[48:63], v[184:187], a[188:191], v[48:63]
ds_read_b64_tr_b16 v[152:153], v29 offset:18432
ds_read_b64_tr_b16 v[154:155], v29 offset:18944
v_mfma_f32_32x32x16_bf16 v[64:79], v[188:191], a[188:191], v[64:79]
ds_read_b64_tr_b16 v[156:157], v30 offset:18432
ds_read_b64_tr_b16 v[158:159], v30 offset:18944
s_waitcnt vmcnt(63) lgkmcnt(4)
v_mfma_f32_32x32x16_bf16 v[48:63], v[136:139], a[192:195], v[48:63]
ds_read_b64_tr_b16 v[168:169], v29 offset:20480
ds_read_b64_tr_b16 v[170:171], v29 offset:20992
v_mfma_f32_32x32x16_bf16 v[64:79], v[140:143], a[192:195], v[64:79]
ds_read_b64_tr_b16 v[172:173], v30 offset:20480
ds_read_b64_tr_b16 v[174:175], v30 offset:20992
s_waitcnt vmcnt(63) lgkmcnt(4)
v_mfma_f32_32x32x16_bf16 v[48:63], v[152:155], a[196:199], v[48:63]
ds_read_b64_tr_b16 v[184:185], v29 offset:22528
ds_read_b64_tr_b16 v[186:187], v29 offset:23040
v_mfma_f32_32x32x16_bf16 v[64:79], v[156:159], a[196:199], v[64:79]
ds_read_b64_tr_b16 v[188:189], v30 offset:22528
ds_read_b64_tr_b16 v[190:191], v30 offset:23040
s_waitcnt vmcnt(63) lgkmcnt(4)
v_mfma_f32_32x32x16_bf16 v[48:63], v[168:171], a[200:203], v[48:63]
ds_read_b64_tr_b16 v[136:137], v29 offset:24576
ds_read_b64_tr_b16 v[138:139], v29 offset:25088
v_mfma_f32_32x32x16_bf16 v[64:79], v[172:175], a[200:203], v[64:79]
ds_read_b64_tr_b16 v[140:141], v30 offset:24576
ds_read_b64_tr_b16 v[142:143], v30 offset:25088
s_waitcnt vmcnt(63) lgkmcnt(4)
v_mfma_f32_32x32x16_bf16 v[48:63], v[184:187], a[204:207], v[48:63]
ds_read_b64_tr_b16 v[152:153], v29 offset:26624
ds_read_b64_tr_b16 v[154:155], v29 offset:27136
v_mfma_f32_32x32x16_bf16 v[64:79], v[188:191], a[204:207], v[64:79]
ds_read_b64_tr_b16 v[156:157], v30 offset:26624
ds_read_b64_tr_b16 v[158:159], v30 offset:27136
s_waitcnt vmcnt(63) lgkmcnt(4)
v_mfma_f32_32x32x16_bf16 v[48:63], v[136:139], a[208:211], v[48:63]
ds_read_b64_tr_b16 v[168:169], v29 offset:28672
ds_read_b64_tr_b16 v[170:171], v29 offset:29184
v_mfma_f32_32x32x16_bf16 v[64:79], v[140:143], a[208:211], v[64:79]
ds_read_b64_tr_b16 v[172:173], v30 offset:28672
ds_read_b64_tr_b16 v[174:175], v30 offset:29184
s_waitcnt vmcnt(63) lgkmcnt(4)
v_mfma_f32_32x32x16_bf16 v[48:63], v[152:155], a[212:215], v[48:63]
ds_read_b64_tr_b16 v[184:185], v29 offset:30720
ds_read_b64_tr_b16 v[186:187], v29 offset:31232
v_mfma_f32_32x32x16_bf16 v[64:79], v[156:159], a[212:215], v[64:79]
ds_read_b64_tr_b16 v[188:189], v30 offset:30720
ds_read_b64_tr_b16 v[190:191], v30 offset:31232
s_waitcnt vmcnt(12) lgkmcnt(4)
s_barrier
v_mfma_f32_32x32x16_bf16 v[48:63], v[168:171], a[216:219], v[48:63]
ds_read_b64_tr_b16 v[136:137], v18 offset:0
ds_read_b64_tr_b16 v[138:139], v18 offset:512
v_mfma_f32_32x32x16_bf16 v[64:79], v[172:175], a[216:219], v[64:79]
ds_read_b64_tr_b16 v[140:141], v19 offset:0
ds_read_b64_tr_b16 v[142:143], v19 offset:512
s_waitcnt vmcnt(12) lgkmcnt(4)
v_mfma_f32_32x32x16_bf16 v[48:63], v[184:187], a[220:223], v[48:63]
ds_read_b64_tr_b16 v[152:153], v18 offset:2048
ds_read_b64_tr_b16 v[154:155], v18 offset:2560
v_mfma_f32_32x32x16_bf16 v[64:79], v[188:191], a[220:223], v[64:79]
ds_read_b64_tr_b16 v[156:157], v19 offset:2048
ds_read_b64_tr_b16 v[158:159], v19 offset:2560
s_waitcnt vmcnt(63) lgkmcnt(4)
v_mfma_f32_32x32x16_bf16 v[48:63], v[136:139], a[224:227], v[48:63]
ds_read_b64_tr_b16 v[168:169], v18 offset:4096
ds_read_b64_tr_b16 v[170:171], v18 offset:4608
v_mfma_f32_32x32x16_bf16 v[64:79], v[140:143], a[224:227], v[64:79]
ds_read_b64_tr_b16 v[172:173], v19 offset:4096
ds_read_b64_tr_b16 v[174:175], v19 offset:4608
buffer_load_dwordx4 v[112:115], v33, s[12:15], s32 offen offset:0 sc1
s_waitcnt vmcnt(63) lgkmcnt(4)
v_mfma_f32_32x32x16_bf16 v[48:63], v[152:155], a[228:231], v[48:63]
ds_read_b64_tr_b16 v[184:185], v18 offset:6144
ds_read_b64_tr_b16 v[186:187], v18 offset:6656
v_mfma_f32_32x32x16_bf16 v[64:79], v[156:159], a[228:231], v[64:79]
ds_read_b64_tr_b16 v[188:189], v19 offset:6144
ds_read_b64_tr_b16 v[190:191], v19 offset:6656
buffer_load_dwordx4 v[116:119], v33, s[12:15], s32 offen offset:1024 sc1
s_waitcnt vmcnt(63) lgkmcnt(4)
v_mfma_f32_32x32x16_bf16 v[48:63], v[168:171], a[232:235], v[48:63]
ds_read_b64_tr_b16 v[136:137], v18 offset:8192
ds_read_b64_tr_b16 v[138:139], v18 offset:8704
v_mfma_f32_32x32x16_bf16 v[64:79], v[172:175], a[232:235], v[64:79]
ds_read_b64_tr_b16 v[140:141], v19 offset:8192
ds_read_b64_tr_b16 v[142:143], v19 offset:8704
buffer_load_dwordx4 v[120:123], v33, s[12:15], s32 offen offset:2048 sc1
s_waitcnt vmcnt(63) lgkmcnt(4)
v_mfma_f32_32x32x16_bf16 v[48:63], v[184:187], a[236:239], v[48:63]
ds_read_b64_tr_b16 v[152:153], v18 offset:10240
ds_read_b64_tr_b16 v[154:155], v18 offset:10752
v_mfma_f32_32x32x16_bf16 v[64:79], v[188:191], a[236:239], v[64:79]
ds_read_b64_tr_b16 v[156:157], v19 offset:10240
ds_read_b64_tr_b16 v[158:159], v19 offset:10752
buffer_load_dwordx4 v[124:127], v33, s[12:15], s32 offen offset:3072 sc1
s_waitcnt vmcnt(63) lgkmcnt(4)
v_mfma_f32_32x32x16_bf16 v[48:63], v[136:139], a[240:243], v[48:63]
ds_read_b64_tr_b16 v[168:169], v18 offset:12288
ds_read_b64_tr_b16 v[170:171], v18 offset:12800
v_mfma_f32_32x32x16_bf16 v[64:79], v[140:143], a[240:243], v[64:79]
ds_read_b64_tr_b16 v[172:173], v19 offset:12288
ds_read_b64_tr_b16 v[174:175], v19 offset:12800
s_waitcnt vmcnt(63) lgkmcnt(4)
v_mfma_f32_32x32x16_bf16 v[48:63], v[152:155], a[244:247], v[48:63]
ds_read_b64_tr_b16 v[184:185], v18 offset:14336
ds_read_b64_tr_b16 v[186:187], v18 offset:14848
v_mfma_f32_32x32x16_bf16 v[64:79], v[156:159], a[244:247], v[64:79]
ds_read_b64_tr_b16 v[188:189], v19 offset:14336
ds_read_b64_tr_b16 v[190:191], v19 offset:14848
s_waitcnt vmcnt(12) lgkmcnt(4)
s_barrier
v_mfma_f32_32x32x16_bf16 v[48:63], v[168:171], a[248:251], v[48:63]
ds_read_b64_tr_b16 v[136:137], v20 offset:0
ds_read_b64_tr_b16 v[138:139], v20 offset:512
v_mfma_f32_32x32x16_bf16 v[64:79], v[172:175], a[248:251], v[64:79]
ds_read_b64_tr_b16 v[140:141], v21 offset:0
ds_read_b64_tr_b16 v[142:143], v21 offset:512
s_waitcnt vmcnt(12) lgkmcnt(4)
v_mfma_f32_32x32x16_bf16 v[48:63], v[184:187], a[252:255], v[48:63]
ds_read_b64_tr_b16 v[152:153], v20 offset:2048
ds_read_b64_tr_b16 v[154:155], v20 offset:2560
v_mfma_f32_32x32x16_bf16 v[64:79], v[188:191], a[252:255], v[64:79]
ds_read_b64_tr_b16 v[156:157], v21 offset:2048
ds_read_b64_tr_b16 v[158:159], v21 offset:2560
s_waitcnt vmcnt(63) lgkmcnt(4)
v_mfma_f32_32x32x16_bf16 v[48:63], v[136:139], a[64:67], v[48:63]
ds_read_b64_tr_b16 v[168:169], v20 offset:4096
ds_read_b64_tr_b16 v[170:171], v20 offset:4608
s_mov_b32 s10, 491520
s_mov_b32 s11, 0x20000
v_mfma_f32_32x32x16_bf16 v[64:79], v[140:143], a[64:67], v[64:79]
ds_read_b64_tr_b16 v[172:173], v21 offset:4096
ds_read_b64_tr_b16 v[174:175], v21 offset:4608
s_bfe_u32 s62, s92, 0x30004
s_mul_i32 s62, s62, 491520
s_waitcnt vmcnt(63) lgkmcnt(4)
v_mfma_f32_32x32x16_bf16 v[48:63], v[152:155], a[68:71], v[48:63]
ds_read_b64_tr_b16 v[184:185], v20 offset:6144
ds_read_b64_tr_b16 v[186:187], v20 offset:6656
s_add_u32 s8, s88, s62
s_addc_u32 s9, s89, 0
v_mfma_f32_32x32x16_bf16 v[64:79], v[156:159], a[68:71], v[64:79]
ds_read_b64_tr_b16 v[188:189], v21 offset:6144
ds_read_b64_tr_b16 v[190:191], v21 offset:6656
s_and_b32 s62, s78, 1
s_lshl_b32 s63, s24, 1
s_waitcnt vmcnt(63) lgkmcnt(4)
v_mfma_f32_32x32x16_bf16 v[48:63], v[168:171], a[72:75], v[48:63]
ds_read_b64_tr_b16 v[136:137], v20 offset:8192
ds_read_b64_tr_b16 v[138:139], v20 offset:8704
s_add_u32 s62, s62, s63
s_lshl_b32 s62, s62, 16
v_mfma_f32_32x32x16_bf16 v[64:79], v[172:175], a[72:75], v[64:79]
ds_read_b64_tr_b16 v[140:141], v21 offset:8192
ds_read_b64_tr_b16 v[142:143], v21 offset:8704
s_bfe_u32 s63, s2, 0x10002
s_lshl_b32 s63, s63, 10
s_waitcnt vmcnt(63) lgkmcnt(4)
v_mfma_f32_32x32x16_bf16 v[48:63], v[184:187], a[76:79], v[48:63]
ds_read_b64_tr_b16 v[152:153], v20 offset:10240
ds_read_b64_tr_b16 v[154:155], v20 offset:10752
s_add_u32 s62, s62, s63
s_add_u32 s62, s62, s37
v_mfma_f32_32x32x16_bf16 v[64:79], v[188:191], a[76:79], v[64:79]
ds_read_b64_tr_b16 v[156:157], v21 offset:10240
ds_read_b64_tr_b16 v[158:159], v21 offset:10752
v_and_b32 v36, 31, v0
v_lshlrev_b32 v36, 11, v36
s_waitcnt vmcnt(63) lgkmcnt(4)
v_mfma_f32_32x32x16_bf16 v[48:63], v[136:139], a[80:83], v[48:63]
ds_read_b64_tr_b16 v[168:169], v20 offset:12288
ds_read_b64_tr_b16 v[170:171], v20 offset:12800
v_bfe_u32 v37, v0, 5, 1
v_lshl_or_b32 v36, v37, 4, v36
v_mfma_f32_32x32x16_bf16 v[64:79], v[140:143], a[80:83], v[64:79]
ds_read_b64_tr_b16 v[172:173], v21 offset:12288
ds_read_b64_tr_b16 v[174:175], v21 offset:12800
v_add_u32 v36, s62, v36
s_mov_b32 s94, 0xffff0000
s_waitcnt vmcnt(63) lgkmcnt(4)
v_mfma_f32_32x32x16_bf16 v[48:63], v[152:155], a[84:87], v[48:63]
ds_read_b64_tr_b16 v[184:185], v20 offset:14336
ds_read_b64_tr_b16 v[186:187], v20 offset:14848
v_mfma_f32_32x32x16_bf16 v[64:79], v[156:159], a[84:87], v[64:79]
ds_read_b64_tr_b16 v[188:189], v21 offset:14336
ds_read_b64_tr_b16 v[190:191], v21 offset:14848
s_waitcnt vmcnt(8) lgkmcnt(4)
s_barrier
v_mfma_f32_32x32x16_bf16 v[48:63], v[168:171], a[88:91], v[48:63]
ds_read_b64_tr_b16 v[136:137], v18 offset:16384
ds_read_b64_tr_b16 v[138:139], v18 offset:16896
v_mfma_f32_32x32x16_bf16 v[64:79], v[172:175], a[88:91], v[64:79]
ds_read_b64_tr_b16 v[140:141], v19 offset:16384
ds_read_b64_tr_b16 v[142:143], v19 offset:16896
s_waitcnt vmcnt(8) lgkmcnt(4)
v_mfma_f32_32x32x16_bf16 v[48:63], v[184:187], a[92:95], v[48:63]
ds_read_b64_tr_b16 v[152:153], v18 offset:18432
ds_read_b64_tr_b16 v[154:155], v18 offset:18944
v_mfma_f32_32x32x16_bf16 v[64:79], v[188:191], a[92:95], v[64:79]
ds_read_b64_tr_b16 v[156:157], v19 offset:18432
ds_read_b64_tr_b16 v[158:159], v19 offset:18944
s_waitcnt vmcnt(0) lgkmcnt(4)
v_mfma_f32_32x32x16_bf16 v[48:63], v[136:139], a[96:99], v[48:63]
ds_read_b64_tr_b16 v[168:169], v18 offset:20480
ds_read_b64_tr_b16 v[170:171], v18 offset:20992
v_max3_u32 v38, v112, v113, v114
v_max3_u32 v39, v115, v116, v117
v_max3_u32 v38, v38, v118, v119
v_mfma_f32_32x32x16_bf16 v[64:79], v[140:143], a[96:99], v[64:79]
ds_read_b64_tr_b16 v[172:173], v19 offset:20480
ds_read_b64_tr_b16 v[174:175], v19 offset:20992
v_max3_u32 v39, v39, v120, v121
v_max3_u32 v38, v38, v122, v123
v_max3_u32 v39, v39, v124, v125
s_waitcnt vmcnt(63) lgkmcnt(4)
v_mfma_f32_32x32x16_bf16 v[48:63], v[152:155], a[100:103], v[48:63]
ds_read_b64_tr_b16 v[184:185], v18 offset:22528
ds_read_b64_tr_b16 v[186:187], v18 offset:23040
v_max3_u32 v38, v38, v126, v127
v_max3_u32 v38, v38, v39, v39
v_cmp_eq_u32 vcc, -1, v38
v_mfma_f32_32x32x16_bf16 v[64:79], v[156:159], a[100:103], v[64:79]
ds_read_b64_tr_b16 v[188:189], v19 offset:22528
ds_read_b64_tr_b16 v[190:191], v19 offset:23040
s_waitcnt vmcnt(63) lgkmcnt(4)
v_mfma_f32_32x32x16_bf16 v[48:63], v[168:171], a[104:107], v[48:63]
ds_read_b64_tr_b16 v[136:137], v18 offset:24576
ds_read_b64_tr_b16 v[138:139], v18 offset:25088
s_cbranch_vccnz L_waitpart
L_okpart:
v_mfma_f32_32x32x16_bf16 v[64:79], v[172:175], a[104:107], v[64:79]
ds_read_b64_tr_b16 v[140:141], v19 offset:24576
ds_read_b64_tr_b16 v[142:143], v19 offset:25088
s_waitcnt vmcnt(63) lgkmcnt(4)
v_mfma_f32_32x32x16_bf16 v[48:63], v[184:187], a[108:111], v[48:63]
ds_read_b64_tr_b16 v[152:153], v18 offset:26624
ds_read_b64_tr_b16 v[154:155], v18 offset:27136
v_lshlrev_b32 v80, 16, v112
v_and_b32 v81, s94, v112
v_mfma_f32_32x32x16_bf16 v[64:79], v[188:191], a[108:111], v[64:79]
ds_read_b64_tr_b16 v[156:157], v19 offset:26624
ds_read_b64_tr_b16 v[158:159], v19 offset:27136
v_lshlrev_b32 v82, 16, v113
v_and_b32 v83, s94, v113
s_waitcnt vmcnt(63) lgkmcnt(4)
v_mfma_f32_32x32x16_bf16 v[48:63], v[136:139], a[112:115], v[48:63]
ds_read_b64_tr_b16 v[168:169], v18 offset:28672
ds_read_b64_tr_b16 v[170:171], v18 offset:29184
v_lshlrev_b32 v84, 16, v114
v_and_b32 v85, s94, v114
v_mfma_f32_32x32x16_bf16 v[64:79], v[140:143], a[112:115], v[64:79]
ds_read_b64_tr_b16 v[172:173], v19 offset:28672
ds_read_b64_tr_b16 v[174:175], v19 offset:29184
v_lshlrev_b32 v86, 16, v115
v_and_b32 v87, s94, v115
s_waitcnt vmcnt(63) lgkmcnt(4)
v_mfma_f32_32x32x16_bf16 v[48:63], v[152:155], a[116:119], v[48:63]
ds_read_b64_tr_b16 v[184:185], v18 offset:30720
ds_read_b64_tr_b16 v[186:187], v18 offset:31232
v_lshlrev_b32 v88, 16, v116
v_and_b32 v89, s94, v116
v_mfma_f32_32x32x16_bf16 v[64:79], v[156:159], a[116:119], v[64:79]
ds_read_b64_tr_b16 v[188:189], v19 offset:30720
ds_read_b64_tr_b16 v[190:191], v19 offset:31232
v_lshlrev_b32 v90, 16, v117
v_and_b32 v91, s94, v117
s_waitcnt vmcnt(63) lgkmcnt(4)
v_mfma_f32_32x32x16_bf16 v[48:63], v[168:171], a[120:123], v[48:63]
v_lshlrev_b32 v92, 16, v118
v_and_b32 v93, s94, v118
v_lshlrev_b32 v94, 16, v119
v_and_b32 v95, s94, v119
v_mfma_f32_32x32x16_bf16 v[64:79], v[172:175], a[120:123], v[64:79]
v_lshlrev_b32 v96, 16, v120
v_and_b32 v97, s94, v120
v_lshlrev_b32 v98, 16, v121
v_and_b32 v99, s94, v121
s_waitcnt vmcnt(63) lgkmcnt(0)
v_mfma_f32_32x32x16_bf16 v[48:63], v[184:187], a[124:127], v[48:63]
v_mfma_f32_32x32x16_bf16 v[64:79], v[188:191], a[124:127], v[64:79]
v_lshlrev_b32 v100, 16, v122
v_and_b32 v101, s94, v122
v_lshlrev_b32 v102, 16, v123
v_and_b32 v103, s94, v123
v_lshlrev_b32 v104, 16, v124
v_and_b32 v105, s94, v124
v_lshlrev_b32 v106, 16, v125
v_and_b32 v107, s94, v125
v_lshlrev_b32 v108, 16, v126
v_and_b32 v109, s94, v126
v_lshlrev_b32 v110, 16, v127
v_and_b32 v111, s94, v127
v_pk_add_f32 v[48:49], v[48:49], v[80:81]
v_pk_add_f32 v[50:51], v[50:51], v[82:83]
v_pk_add_f32 v[52:53], v[52:53], v[84:85]
v_pk_add_f32 v[54:55], v[54:55], v[86:87]
v_pk_add_f32 v[56:57], v[56:57], v[88:89]
v_pk_add_f32 v[58:59], v[58:59], v[90:91]
v_pk_add_f32 v[60:61], v[60:61], v[92:93]
v_pk_add_f32 v[62:63], v[62:63], v[94:95]
v_cvt_pk_bf16_f32 v128, v48, v49
v_cvt_pk_bf16_f32 v129, v50, v51
v_cvt_pk_bf16_f32 v130, v52, v53
v_cvt_pk_bf16_f32 v131, v54, v55
v_cvt_pk_bf16_f32 v132, v56, v57
v_cvt_pk_bf16_f32 v133, v58, v59
v_cvt_pk_bf16_f32 v134, v60, v61
v_cvt_pk_bf16_f32 v135, v62, v63
buffer_store_dwordx4 v[128:131], v36, s[8:11], 0 offen offset:0 nt
buffer_store_dwordx4 v[132:135], v36, s[8:11], 0 offen offset:32 nt
v_pk_add_f32 v[64:65], v[64:65], v[96:97]
v_pk_add_f32 v[66:67], v[66:67], v[98:99]
v_pk_add_f32 v[68:69], v[68:69], v[100:101]
v_pk_add_f32 v[70:71], v[70:71], v[102:103]
v_pk_add_f32 v[72:73], v[72:73], v[104:105]
v_pk_add_f32 v[74:75], v[74:75], v[106:107]
v_pk_add_f32 v[76:77], v[76:77], v[108:109]
v_pk_add_f32 v[78:79], v[78:79], v[110:111]
v_cvt_pk_bf16_f32 v136, v64, v65
v_cvt_pk_bf16_f32 v137, v66, v67
v_cvt_pk_bf16_f32 v138, v68, v69
v_cvt_pk_bf16_f32 v139, v70, v71
v_cvt_pk_bf16_f32 v140, v72, v73
v_cvt_pk_bf16_f32 v141, v74, v75
v_cvt_pk_bf16_f32 v142, v76, v77
v_cvt_pk_bf16_f32 v143, v78, v79
buffer_store_dwordx4 v[136:139], v36, s[8:11], 0 offen offset:64 nt
buffer_store_dwordx4 v[140:143], v36, s[8:11], 0 offen offset:96 nt
L1_end:
s_endpgm
L1_slow:
s_waitcnt lgkmcnt(0)
s_nop 7
v_mul_f32 v48, s35, v144
v_mul_f32 v49, s35, v145
v_mul_f32 v50, s35, v146
v_mul_f32 v51, s35, v147
v_mul_f32 v52, s35, v148
v_mul_f32 v53, s35, v149
v_mul_f32 v54, s35, v150
v_mul_f32 v55, s35, v151
v_mul_f32 v56, s35, v152
v_mul_f32 v57, s35, v153
v_mul_f32 v58, s35, v154
v_mul_f32 v59, s35, v155
v_mul_f32 v60, s35, v156
v_mul_f32 v61, s35, v157
v_mul_f32 v62, s35, v158
v_mul_f32 v63, s35, v159
v_cvt_pk_bf16_f32 v48, v48, v49
v_cvt_pk_bf16_f32 v49, v50, v51
v_cvt_pk_bf16_f32 v50, v52, v53
v_cvt_pk_bf16_f32 v51, v54, v55
v_cvt_pk_bf16_f32 v52, v56, v57
v_cvt_pk_bf16_f32 v53, v58, v59
v_cvt_pk_bf16_f32 v54, v60, v61
v_cvt_pk_bf16_f32 v55, v62, v63
v_accvgpr_write_b32 a4, v48
v_accvgpr_write_b32 a5, v49
v_accvgpr_write_b32 a6, v50
v_accvgpr_write_b32 a7, v51
v_accvgpr_write_b32 a12, v52
v_accvgpr_write_b32 a13, v53
v_accvgpr_write_b32 a14, v54
v_accvgpr_write_b32 a15, v55
v_mul_f32 v48, s35, v176
v_mul_f32 v49, s35, v177
v_mul_f32 v50, s35, v178
v_mul_f32 v51, s35, v179
v_mul_f32 v52, s35, v180
v_mul_f32 v53, s35, v181
v_mul_f32 v54, s35, v182
v_mul_f32 v55, s35, v183
v_mul_f32 v56, s35, v184
v_mul_f32 v57, s35, v185
v_mul_f32 v58, s35, v186
v_mul_f32 v59, s35, v187
v_mul_f32 v60, s35, v188
v_mul_f32 v61, s35, v189
v_mul_f32 v62, s35, v190
v_mul_f32 v63, s35, v191
v_cvt_pk_bf16_f32 v48, v48, v49
v_cvt_pk_bf16_f32 v49, v50, v51
v_cvt_pk_bf16_f32 v50, v52, v53
v_cvt_pk_bf16_f32 v51, v54, v55
v_cvt_pk_bf16_f32 v52, v56, v57
v_cvt_pk_bf16_f32 v53, v58, v59
v_cvt_pk_bf16_f32 v54, v60, v61
v_cvt_pk_bf16_f32 v55, v62, v63
v_accvgpr_write_b32 a20, v48
v_accvgpr_write_b32 a21, v49
v_accvgpr_write_b32 a22, v50
v_accvgpr_write_b32 a23, v51
v_accvgpr_write_b32 a28, v52
v_accvgpr_write_b32 a29, v53
v_accvgpr_write_b32 a30, v54
v_accvgpr_write_b32 a31, v55
v_mul_f32 v48, s35, v208
v_mul_f32 v49, s35, v209
v_mul_f32 v50, s35, v210
v_mul_f32 v51, s35, v211
v_mul_f32 v52, s35, v212
v_mul_f32 v53, s35, v213
v_mul_f32 v54, s35, v214
v_mul_f32 v55, s35, v215
v_mul_f32 v56, s35, v216
v_mul_f32 v57, s35, v217
v_mul_f32 v58, s35, v218
v_mul_f32 v59, s35, v219
v_mul_f32 v60, s35, v220
v_mul_f32 v61, s35, v221
v_mul_f32 v62, s35, v222
v_mul_f32 v63, s35, v223
v_cvt_pk_bf16_f32 v48, v48, v49
v_cvt_pk_bf16_f32 v49, v50, v51
v_cvt_pk_bf16_f32 v50, v52, v53
v_cvt_pk_bf16_f32 v51, v54, v55
v_cvt_pk_bf16_f32 v52, v56, v57
v_cvt_pk_bf16_f32 v53, v58, v59
v_cvt_pk_bf16_f32 v54, v60, v61
v_cvt_pk_bf16_f32 v55, v62, v63
v_accvgpr_write_b32 a36, v48
v_accvgpr_write_b32 a37, v49
v_accvgpr_write_b32 a38, v50
v_accvgpr_write_b32 a39, v51
v_accvgpr_write_b32 a44, v52
v_accvgpr_write_b32 a45, v53
v_accvgpr_write_b32 a46, v54
v_accvgpr_write_b32 a47, v55
v_mul_f32 v48, s35, v240
v_mul_f32 v49, s35, v241
v_mul_f32 v50, s35, v242
v_mul_f32 v51, s35, v243
v_mul_f32 v52, s35, v244
v_mul_f32 v53, s35, v245
v_mul_f32 v54, s35, v246
v_mul_f32 v55, s35, v247
v_mul_f32 v56, s35, v248
v_mul_f32 v57, s35, v249
v_mul_f32 v58, s35, v250
v_mul_f32 v59, s35, v251
v_mul_f32 v60, s35, v252
v_mul_f32 v61, s35, v253
v_mul_f32 v62, s35, v254
v_mul_f32 v63, s35, v255
v_cvt_pk_bf16_f32 v48, v48, v49
v_cvt_pk_bf16_f32 v49, v50, v51
v_cvt_pk_bf16_f32 v50, v52, v53
v_cvt_pk_bf16_f32 v51, v54, v55
v_cvt_pk_bf16_f32 v52, v56, v57
v_cvt_pk_bf16_f32 v53, v58, v59
v_cvt_pk_bf16_f32 v54, v60, v61
v_cvt_pk_bf16_f32 v55, v62, v63
v_accvgpr_write_b32 a52, v48
v_accvgpr_write_b32 a53, v49
v_accvgpr_write_b32 a54, v50
v_accvgpr_write_b32 a55, v51
v_accvgpr_write_b32 a60, v52
v_accvgpr_write_b32 a61, v53
v_accvgpr_write_b32 a62, v54
v_accvgpr_write_b32 a63, v55
s_nop 1
v_and_b32 v37, 63, v0
v_and_b32 v36, 0x13, v37
v_and_b32 v40, 4, v37
v_lshl_or_b32 v36, v40, 1, v36
v_and_b32 v40, 8, v37
v_lshrrev_b32 v40, 1, v40
v_or_b32 v36, v36, v40
v_lshrrev_b32 v37, 5, v37
v_lshlrev_b32 v37, 4, v37
v_lshl_or_b32 v36, v36, 8, v37
v_mov_b32 v38, 0xff800000
v_mov_b32 v39, 0xff800000
s_mov_b32 s62, 0
s_mov_b32 s60, 16
L1_maxloop0:
buffer_load_dwordx4 a[64:67], v36, s[12:15], s62 offen offset:0
buffer_load_dwordx4 a[68:71], v36, s[12:15], s62 offen offset:32
buffer_load_dwordx4 a[72:75], v36, s[12:15], s62 offen offset:64
buffer_load_dwordx4 a[76:79], v36, s[12:15], s62 offen offset:96
buffer_load_dwordx4 a[80:83], v36, s[12:15], s62 offen offset:128
buffer_load_dwordx4 a[84:87], v36, s[12:15], s62 offen offset:160
buffer_load_dwordx4 a[88:91], v36, s[12:15], s62 offen offset:192
buffer_load_dwordx4 a[92:95], v36, s[12:15], s62 offen offset:224
s_waitcnt vmcnt(0)
v_mfma_f32_32x32x16_bf16 v[48:63], a[64:67], a[0:3], 0
v_mfma_f32_32x32x16_bf16 v[48:63], a[68:71], a[8:11], v[48:63]
v_mfma_f32_32x32x16_bf16 v[48:63], a[72:75], a[16:19], v[48:63]
v_mfma_f32_32x32x16_bf16 v[48:63], a[76:79], a[24:27], v[48:63]
v_mfma_f32_32x32x16_bf16 v[48:63], a[80:83], a[32:35], v[48:63]
v_mfma_f32_32x32x16_bf16 v[48:63], a[84:87], a[40:43], v[48:63]
v_mfma_f32_32x32x16_bf16 v[48:63], a[88:91], a[48:51], v[48:63]
v_mfma_f32_32x32x16_bf16 v[48:63], a[92:95], a[56:59], v[48:63]
v_mfma_f32_32x32x16_bf16 v[64:79], a[64:67], a[4:7], 0
v_mfma_f32_32x32x16_bf16 v[64:79], a[68:71], a[12:15], v[64:79]
v_mfma_f32_32x32x16_bf16 v[64:79], a[72:75], a[20:23], v[64:79]
v_mfma_f32_32x32x16_bf16 v[64:79], a[76:79], a[28:31], v[64:79]
v_mfma_f32_32x32x16_bf16 v[64:79], a[80:83], a[36:39], v[64:79]
v_mfma_f32_32x32x16_bf16 v[64:79], a[84:87], a[44:47], v[64:79]
v_mfma_f32_32x32x16_bf16 v[64:79], a[88:91], a[52:55], v[64:79]
v_mfma_f32_32x32x16_bf16 v[64:79], a[92:95], a[60:63], v[64:79]
s_nop 15
v_max3_f32 v38, v48, v49, v38
v_max3_f32 v38, v50, v51, v38
v_max3_f32 v38, v52, v53, v38
v_max3_f32 v38, v54, v55, v38
v_max3_f32 v38, v56, v57, v38
v_max3_f32 v38, v58, v59, v38
v_max3_f32 v38, v60, v61, v38
v_max3_f32 v38, v62, v63, v38
v_max3_f32 v39, v64, v65, v39
v_max3_f32 v39, v66, v67, v39
v_max3_f32 v39, v68, v69, v39
v_max3_f32 v39, v70, v71, v39
v_max3_f32 v39, v72, v73, v39
v_max3_f32 v39, v74, v75, v39
v_max3_f32 v39, v76, v77, v39
v_max3_f32 v39, v78, v79, v39
s_add_u32 s62, s62, 8192
s_sub_u32 s60, s60, 1
s_cmp_lg_u32 s60, 0
s_cbranch_scc1 L1_maxloop0
v_mov_b32 v40, v38
s_nop 1
v_permlane32_swap_b32 v40, v38
s_nop 1
v_max_f32 v38, v38, v40
v_sub_f32 v96, 0, v38
v_sub_f32 v97, 0, v38
v_sub_f32 v98, 0, v38
v_sub_f32 v99, 0, v38
v_sub_f32 v100, 0, v38
v_sub_f32 v101, 0, v38
v_sub_f32 v102, 0, v38
v_sub_f32 v103, 0, v38
v_sub_f32 v104, 0, v38
v_sub_f32 v105, 0, v38
v_sub_f32 v106, 0, v38
v_sub_f32 v107, 0, v38
v_sub_f32 v108, 0, v38
v_sub_f32 v109, 0, v38
v_sub_f32 v110, 0, v38
v_sub_f32 v111, 0, v38
v_mov_b32 v40, v39
s_nop 1
v_permlane32_swap_b32 v40, v39
s_nop 1
v_max_f32 v39, v39, v40
v_sub_f32 v112, 0, v39
v_sub_f32 v113, 0, v39
v_sub_f32 v114, 0, v39
v_sub_f32 v115, 0, v39
v_sub_f32 v116, 0, v39
v_sub_f32 v117, 0, v39
v_sub_f32 v118, 0, v39
v_sub_f32 v119, 0, v39
v_sub_f32 v120, 0, v39
v_sub_f32 v121, 0, v39
v_sub_f32 v122, 0, v39
v_sub_f32 v123, 0, v39
v_sub_f32 v124, 0, v39
v_sub_f32 v125, 0, v39
v_sub_f32 v126, 0, v39
v_sub_f32 v127, 0, v39
v_accvgpr_read_b32 v48, a128
v_accvgpr_read_b32 v49, a129
v_accvgpr_read_b32 v50, a130
v_accvgpr_read_b32 v51, a131
v_accvgpr_read_b32 v52, a132
v_accvgpr_read_b32 v53, a133
v_accvgpr_read_b32 v54, a134
v_accvgpr_read_b32 v55, a135
v_accvgpr_read_b32 v56, a136
v_accvgpr_read_b32 v57, a137
v_accvgpr_read_b32 v58, a138
v_accvgpr_read_b32 v59, a139
v_accvgpr_read_b32 v60, a140
v_accvgpr_read_b32 v61, a141
v_accvgpr_read_b32 v62, a142
v_accvgpr_read_b32 v63, a143
v_mul_f32 v48, s35, v48
v_mul_f32 v49, s35, v49
v_mul_f32 v50, s35, v50
v_mul_f32 v51, s35, v51
v_mul_f32 v52, s35, v52
v_mul_f32 v53, s35, v53
v_mul_f32 v54, s35, v54
v_mul_f32 v55, s35, v55
v_mul_f32 v56, s35, v56
v_mul_f32 v57, s35, v57
v_mul_f32 v58, s35, v58
v_mul_f32 v59, s35, v59
v_mul_f32 v60, s35, v60
v_mul_f32 v61, s35, v61
v_mul_f32 v62, s35, v62
v_mul_f32 v63, s35, v63
v_cvt_pk_bf16_f32 v128, v48, v49
v_cvt_pk_bf16_f32 v129, v50, v51
v_cvt_pk_bf16_f32 v130, v52, v53
v_cvt_pk_bf16_f32 v131, v54, v55
v_cvt_pk_bf16_f32 v132, v56, v57
v_cvt_pk_bf16_f32 v133, v58, v59
v_cvt_pk_bf16_f32 v134, v60, v61
v_cvt_pk_bf16_f32 v135, v62, v63
v_accvgpr_read_b32 v48, a160
v_accvgpr_read_b32 v49, a161
v_accvgpr_read_b32 v50, a162
v_accvgpr_read_b32 v51, a163
v_accvgpr_read_b32 v52, a164
v_accvgpr_read_b32 v53, a165
v_accvgpr_read_b32 v54, a166
v_accvgpr_read_b32 v55, a167
v_accvgpr_read_b32 v56, a168
v_accvgpr_read_b32 v57, a169
v_accvgpr_read_b32 v58, a170
v_accvgpr_read_b32 v59, a171
v_accvgpr_read_b32 v60, a172
v_accvgpr_read_b32 v61, a173
v_accvgpr_read_b32 v62, a174
v_accvgpr_read_b32 v63, a175
v_mul_f32 v48, s35, v48
v_mul_f32 v49, s35, v49
v_mul_f32 v50, s35, v50
v_mul_f32 v51, s35, v51
v_mul_f32 v52, s35, v52
v_mul_f32 v53, s35, v53
v_mul_f32 v54, s35, v54
v_mul_f32 v55, s35, v55
v_mul_f32 v56, s35, v56
v_mul_f32 v57, s35, v57
v_mul_f32 v58, s35, v58
v_mul_f32 v59, s35, v59
v_mul_f32 v60, s35, v60
v_mul_f32 v61, s35, v61
v_mul_f32 v62, s35, v62
v_mul_f32 v63, s35, v63
v_cvt_pk_bf16_f32 v160, v48, v49
v_cvt_pk_bf16_f32 v161, v50, v51
v_cvt_pk_bf16_f32 v162, v52, v53
v_cvt_pk_bf16_f32 v163, v54, v55
v_cvt_pk_bf16_f32 v164, v56, v57
v_cvt_pk_bf16_f32 v165, v58, v59
v_cvt_pk_bf16_f32 v166, v60, v61
v_cvt_pk_bf16_f32 v167, v62, v63
v_accvgpr_read_b32 v48, a192
v_accvgpr_read_b32 v49, a193
v_accvgpr_read_b32 v50, a194
v_accvgpr_read_b32 v51, a195
v_accvgpr_read_b32 v52, a196
v_accvgpr_read_b32 v53, a197
v_accvgpr_read_b32 v54, a198
v_accvgpr_read_b32 v55, a199
v_accvgpr_read_b32 v56, a200
v_accvgpr_read_b32 v57, a201
v_accvgpr_read_b32 v58, a202
v_accvgpr_read_b32 v59, a203
v_accvgpr_read_b32 v60, a204
v_accvgpr_read_b32 v61, a205
v_accvgpr_read_b32 v62, a206
v_accvgpr_read_b32 v63, a207
v_mul_f32 v48, s35, v48
v_mul_f32 v49, s35, v49
v_mul_f32 v50, s35, v50
v_mul_f32 v51, s35, v51
v_mul_f32 v52, s35, v52
v_mul_f32 v53, s35, v53
v_mul_f32 v54, s35, v54
v_mul_f32 v55, s35, v55
v_mul_f32 v56, s35, v56
v_mul_f32 v57, s35, v57
v_mul_f32 v58, s35, v58
v_mul_f32 v59, s35, v59
v_mul_f32 v60, s35, v60
v_mul_f32 v61, s35, v61
v_mul_f32 v62, s35, v62
v_mul_f32 v63, s35, v63
v_cvt_pk_bf16_f32 v192, v48, v49
v_cvt_pk_bf16_f32 v193, v50, v51
v_cvt_pk_bf16_f32 v194, v52, v53
v_cvt_pk_bf16_f32 v195, v54, v55
v_cvt_pk_bf16_f32 v196, v56, v57
v_cvt_pk_bf16_f32 v197, v58, v59
v_cvt_pk_bf16_f32 v198, v60, v61
v_cvt_pk_bf16_f32 v199, v62, v63
v_accvgpr_read_b32 v48, a224
v_accvgpr_read_b32 v49, a225
v_accvgpr_read_b32 v50, a226
v_accvgpr_read_b32 v51, a227
v_accvgpr_read_b32 v52, a228
v_accvgpr_read_b32 v53, a229
v_accvgpr_read_b32 v54, a230
v_accvgpr_read_b32 v55, a231
v_accvgpr_read_b32 v56, a232
v_accvgpr_read_b32 v57, a233
v_accvgpr_read_b32 v58, a234
v_accvgpr_read_b32 v59, a235
v_accvgpr_read_b32 v60, a236
v_accvgpr_read_b32 v61, a237
v_accvgpr_read_b32 v62, a238
v_accvgpr_read_b32 v63, a239
v_mul_f32 v48, s35, v48
v_mul_f32 v49, s35, v49
v_mul_f32 v50, s35, v50
v_mul_f32 v51, s35, v51
v_mul_f32 v52, s35, v52
v_mul_f32 v53, s35, v53
v_mul_f32 v54, s35, v54
v_mul_f32 v55, s35, v55
v_mul_f32 v56, s35, v56
v_mul_f32 v57, s35, v57
v_mul_f32 v58, s35, v58
v_mul_f32 v59, s35, v59
v_mul_f32 v60, s35, v60
v_mul_f32 v61, s35, v61
v_mul_f32 v62, s35, v62
v_mul_f32 v63, s35, v63
v_cvt_pk_bf16_f32 v224, v48, v49
v_cvt_pk_bf16_f32 v225, v50, v51
v_cvt_pk_bf16_f32 v226, v52, v53
v_cvt_pk_bf16_f32 v227, v54, v55
v_cvt_pk_bf16_f32 v228, v56, v57
v_cvt_pk_bf16_f32 v229, v58, v59
v_cvt_pk_bf16_f32 v230, v60, v61
v_cvt_pk_bf16_f32 v231, v62, v63
v_accvgpr_read_b32 v48, a144
v_accvgpr_read_b32 v49, a145
v_accvgpr_read_b32 v50, a146
v_accvgpr_read_b32 v51, a147
v_accvgpr_read_b32 v52, a148
v_accvgpr_read_b32 v53, a149
v_accvgpr_read_b32 v54, a150
v_accvgpr_read_b32 v55, a151
v_accvgpr_read_b32 v56, a152
v_accvgpr_read_b32 v57, a153
v_accvgpr_read_b32 v58, a154
v_accvgpr_read_b32 v59, a155
v_accvgpr_read_b32 v60, a156
v_accvgpr_read_b32 v61, a157
v_accvgpr_read_b32 v62, a158
v_accvgpr_read_b32 v63, a159
v_mul_f32 v48, s35, v48
v_mul_f32 v49, s35, v49
v_mul_f32 v50, s35, v50
v_mul_f32 v51, s35, v51
v_mul_f32 v52, s35, v52
v_mul_f32 v53, s35, v53
v_mul_f32 v54, s35, v54
v_mul_f32 v55, s35, v55
v_mul_f32 v56, s35, v56
v_mul_f32 v57, s35, v57
v_mul_f32 v58, s35, v58
v_mul_f32 v59, s35, v59
v_mul_f32 v60, s35, v60
v_mul_f32 v61, s35, v61
v_mul_f32 v62, s35, v62
v_mul_f32 v63, s35, v63
v_cvt_pk_bf16_f32 v136, v48, v49
v_cvt_pk_bf16_f32 v137, v50, v51
v_cvt_pk_bf16_f32 v138, v52, v53
v_cvt_pk_bf16_f32 v139, v54, v55
v_cvt_pk_bf16_f32 v140, v56, v57
v_cvt_pk_bf16_f32 v141, v58, v59
v_cvt_pk_bf16_f32 v142, v60, v61
v_cvt_pk_bf16_f32 v143, v62, v63
v_accvgpr_read_b32 v48, a176
v_accvgpr_read_b32 v49, a177
v_accvgpr_read_b32 v50, a178
v_accvgpr_read_b32 v51, a179
v_accvgpr_read_b32 v52, a180
v_accvgpr_read_b32 v53, a181
v_accvgpr_read_b32 v54, a182
v_accvgpr_read_b32 v55, a183
v_accvgpr_read_b32 v56, a184
v_accvgpr_read_b32 v57, a185
v_accvgpr_read_b32 v58, a186
v_accvgpr_read_b32 v59, a187
v_accvgpr_read_b32 v60, a188
v_accvgpr_read_b32 v61, a189
v_accvgpr_read_b32 v62, a190
v_accvgpr_read_b32 v63, a191
v_mul_f32 v48, s35, v48
v_mul_f32 v49, s35, v49
v_mul_f32 v50, s35, v50
v_mul_f32 v51, s35, v51
v_mul_f32 v52, s35, v52
v_mul_f32 v53, s35, v53
v_mul_f32 v54, s35, v54
v_mul_f32 v55, s35, v55
v_mul_f32 v56, s35, v56
v_mul_f32 v57, s35, v57
v_mul_f32 v58, s35, v58
v_mul_f32 v59, s35, v59
v_mul_f32 v60, s35, v60
v_mul_f32 v61, s35, v61
v_mul_f32 v62, s35, v62
v_mul_f32 v63, s35, v63
v_cvt_pk_bf16_f32 v168, v48, v49
v_cvt_pk_bf16_f32 v169, v50, v51
v_cvt_pk_bf16_f32 v170, v52, v53
v_cvt_pk_bf16_f32 v171, v54, v55
v_cvt_pk_bf16_f32 v172, v56, v57
v_cvt_pk_bf16_f32 v173, v58, v59
v_cvt_pk_bf16_f32 v174, v60, v61
v_cvt_pk_bf16_f32 v175, v62, v63
v_accvgpr_read_b32 v48, a208
v_accvgpr_read_b32 v49, a209
v_accvgpr_read_b32 v50, a210
v_accvgpr_read_b32 v51, a211
v_accvgpr_read_b32 v52, a212
v_accvgpr_read_b32 v53, a213
v_accvgpr_read_b32 v54, a214
v_accvgpr_read_b32 v55, a215
v_accvgpr_read_b32 v56, a216
v_accvgpr_read_b32 v57, a217
v_accvgpr_read_b32 v58, a218
v_accvgpr_read_b32 v59, a219
v_accvgpr_read_b32 v60, a220
v_accvgpr_read_b32 v61, a221
v_accvgpr_read_b32 v62, a222
v_accvgpr_read_b32 v63, a223
v_mul_f32 v48, s35, v48
v_mul_f32 v49, s35, v49
v_mul_f32 v50, s35, v50
v_mul_f32 v51, s35, v51
v_mul_f32 v52, s35, v52
v_mul_f32 v53, s35, v53
v_mul_f32 v54, s35, v54
v_mul_f32 v55, s35, v55
v_mul_f32 v56, s35, v56
v_mul_f32 v57, s35, v57
v_mul_f32 v58, s35, v58
v_mul_f32 v59, s35, v59
v_mul_f32 v60, s35, v60
v_mul_f32 v61, s35, v61
v_mul_f32 v62, s35, v62
v_mul_f32 v63, s35, v63
v_cvt_pk_bf16_f32 v200, v48, v49
v_cvt_pk_bf16_f32 v201, v50, v51
v_cvt_pk_bf16_f32 v202, v52, v53
v_cvt_pk_bf16_f32 v203, v54, v55
v_cvt_pk_bf16_f32 v204, v56, v57
v_cvt_pk_bf16_f32 v205, v58, v59
v_cvt_pk_bf16_f32 v206, v60, v61
v_cvt_pk_bf16_f32 v207, v62, v63
v_accvgpr_read_b32 v48, a240
v_accvgpr_read_b32 v49, a241
v_accvgpr_read_b32 v50, a242
v_accvgpr_read_b32 v51, a243
v_accvgpr_read_b32 v52, a244
v_accvgpr_read_b32 v53, a245
v_accvgpr_read_b32 v54, a246
v_accvgpr_read_b32 v55, a247
v_accvgpr_read_b32 v56, a248
v_accvgpr_read_b32 v57, a249
v_accvgpr_read_b32 v58, a250
v_accvgpr_read_b32 v59, a251
v_accvgpr_read_b32 v60, a252
v_accvgpr_read_b32 v61, a253
v_accvgpr_read_b32 v62, a254
v_accvgpr_read_b32 v63, a255
v_mul_f32 v48, s35, v48
v_mul_f32 v49, s35, v49
v_mul_f32 v50, s35, v50
v_mul_f32 v51, s35, v51
v_mul_f32 v52, s35, v52
v_mul_f32 v53, s35, v53
v_mul_f32 v54, s35, v54
v_mul_f32 v55, s35, v55
v_mul_f32 v56, s35, v56
v_mul_f32 v57, s35, v57
v_mul_f32 v58, s35, v58
v_mul_f32 v59, s35, v59
v_mul_f32 v60, s35, v60
v_mul_f32 v61, s35, v61
v_mul_f32 v62, s35, v62
v_mul_f32 v63, s35, v63
v_cvt_pk_bf16_f32 v232, v48, v49
v_cvt_pk_bf16_f32 v233, v50, v51
v_cvt_pk_bf16_f32 v234, v52, v53
v_cvt_pk_bf16_f32 v235, v54, v55
v_cvt_pk_bf16_f32 v236, v56, v57
v_cvt_pk_bf16_f32 v237, v58, v59
v_cvt_pk_bf16_f32 v238, v60, v61
v_cvt_pk_bf16_f32 v239, v62, v63
s_nop 1
v_and_b32 v37, 63, v0
v_and_b32 v36, 0x13, v37
v_and_b32 v40, 4, v37
v_lshl_or_b32 v36, v40, 1, v36
v_and_b32 v40, 8, v37
v_lshrrev_b32 v40, 1, v40
v_or_b32 v36, v36, v40
v_lshrrev_b32 v37, 5, v37
v_lshlrev_b32 v37, 4, v37
v_lshl_or_b32 v36, v36, 8, v37
v_mov_b32 v38, 0xff800000
v_mov_b32 v39, 0xff800000
s_mov_b32 s62, 131072
s_mov_b32 s60, 16
L1_maxloop1:
buffer_load_dwordx4 a[64:67], v36, s[12:15], s62 offen offset:0
buffer_load_dwordx4 a[68:71], v36, s[12:15], s62 offen offset:32
buffer_load_dwordx4 a[72:75], v36, s[12:15], s62 offen offset:64
buffer_load_dwordx4 a[76:79], v36, s[12:15], s62 offen offset:96
buffer_load_dwordx4 a[80:83], v36, s[12:15], s62 offen offset:128
buffer_load_dwordx4 a[84:87], v36, s[12:15], s62 offen offset:160
buffer_load_dwordx4 a[88:91], v36, s[12:15], s62 offen offset:192
buffer_load_dwordx4 a[92:95], v36, s[12:15], s62 offen offset:224
s_waitcnt vmcnt(0)
v_mfma_f32_32x32x16_bf16 v[48:63], a[64:67], v[128:131], 0
v_mfma_f32_32x32x16_bf16 v[48:63], a[68:71], v[132:135], v[48:63]
v_mfma_f32_32x32x16_bf16 v[48:63], a[72:75], v[160:163], v[48:63]
v_mfma_f32_32x32x16_bf16 v[48:63], a[76:79], v[164:167], v[48:63]
v_mfma_f32_32x32x16_bf16 v[48:63], a[80:83], v[192:195], v[48:63]
v_mfma_f32_32x32x16_bf16 v[48:63], a[84:87], v[196:199], v[48:63]
v_mfma_f32_32x32x16_bf16 v[48:63], a[88:91], v[224:227], v[48:63]
v_mfma_f32_32x32x16_bf16 v[48:63], a[92:95], v[228:231], v[48:63]
v_mfma_f32_32x32x16_bf16 v[64:79], a[64:67], v[136:139], 0
v_mfma_f32_32x32x16_bf16 v[64:79], a[68:71], v[140:143], v[64:79]
v_mfma_f32_32x32x16_bf16 v[64:79], a[72:75], v[168:171], v[64:79]
v_mfma_f32_32x32x16_bf16 v[64:79], a[76:79], v[172:175], v[64:79]
v_mfma_f32_32x32x16_bf16 v[64:79], a[80:83], v[200:203], v[64:79]
v_mfma_f32_32x32x16_bf16 v[64:79], a[84:87], v[204:207], v[64:79]
v_mfma_f32_32x32x16_bf16 v[64:79], a[88:91], v[232:235], v[64:79]
v_mfma_f32_32x32x16_bf16 v[64:79], a[92:95], v[236:239], v[64:79]
s_nop 15
v_max3_f32 v38, v48, v49, v38
v_max3_f32 v38, v50, v51, v38
v_max3_f32 v38, v52, v53, v38
v_max3_f32 v38, v54, v55, v38
v_max3_f32 v38, v56, v57, v38
v_max3_f32 v38, v58, v59, v38
v_max3_f32 v38, v60, v61, v38
v_max3_f32 v38, v62, v63, v38
v_max3_f32 v39, v64, v65, v39
v_max3_f32 v39, v66, v67, v39
v_max3_f32 v39, v68, v69, v39
v_max3_f32 v39, v70, v71, v39
v_max3_f32 v39, v72, v73, v39
v_max3_f32 v39, v74, v75, v39
v_max3_f32 v39, v76, v77, v39
v_max3_f32 v39, v78, v79, v39
s_add_u32 s62, s62, 8192
s_sub_u32 s60, s60, 1
s_cmp_lg_u32 s60, 0
s_cbranch_scc1 L1_maxloop1
v_mov_b32 v40, v38
s_nop 1
v_permlane32_swap_b32 v40, v38
s_nop 1
v_max_f32 v38, v38, v40
v_sub_f32 v46, 0, v38
v_mov_b32 v40, v39
s_nop 1
v_permlane32_swap_b32 v40, v39
s_nop 1
v_max_f32 v39, v39, v40
v_sub_f32 v43, 0, v39
ds_read_b128 a[64:67], v2
ds_read_b128 a[68:71], v3
ds_read_b128 a[72:75], v4
ds_read_b128 a[76:79], v5
ds_read_b128 a[80:83], v6
ds_read_b128 a[84:87], v7
ds_read_b128 a[88:91], v8
ds_read_b128 a[92:95], v9
s_waitcnt lgkmcnt(0)
s_branch L1_fast
L_waitpart:
s_mov_b32 s60, 0x40000
L_spinpart:
buffer_load_dwordx4 v[112:115], v33, s[12:15], s32 offen offset:0 sc1
buffer_load_dwordx4 v[116:119], v33, s[12:15], s32 offen offset:1024 sc1
buffer_load_dwordx4 v[120:123], v33, s[12:15], s32 offen offset:2048 sc1
buffer_load_dwordx4 v[124:127], v33, s[12:15], s32 offen offset:3072 sc1
s_waitcnt vmcnt(0)
s_sub_u32 s60, s60, 1
s_cbranch_scc1 L_okpart
v_max3_u32 v38, v112, v113, v114
v_max3_u32 v39, v115, v116, v117
v_max3_u32 v38, v38, v118, v119
v_max3_u32 v39, v39, v120, v121
v_max3_u32 v38, v38, v122, v123
v_max3_u32 v39, v39, v124, v125
v_max3_u32 v38, v38, v126, v127
v_max3_u32 v38, v38, v39, v39
v_cmp_eq_u32 vcc, -1, v38
s_nop 3
s_cbranch_vccnz L_spinpart
s_branch L_okpart
L1_redo:
s_waitcnt vmcnt(0) lgkmcnt(0)
s_barrier
s_mov_b32 s25, 1
s_branch L1_again
.section .rodata,"a"
.p2align 6
.amdhsa_kernel concat_heads__mha_block_cached__mha_block_cached__near_ridge_kernel
  .amdhsa_next_free_vgpr 512
  .amdhsa_next_free_sgpr 102
  .amdhsa_accum_offset 256
  .amdhsa_group_segment_fixed_size 0
  .amdhsa_kernarg_size 104
  .amdhsa_user_sgpr_count 2
  .amdhsa_user_sgpr_kernarg_segment_ptr 1
  .amdhsa_system_sgpr_workgroup_id_x 1
.end_amdhsa_kernel
```
